```python
import torch

def _softmax(x, axis=-1):
    return torch.softmax(x, dim=axis)
def _gelu(x):
    return torch.nn.functional.gelu(x, approximate="tanh")
def _silu(x):
    return torch.nn.functional.silu(x)
def _sigmoid(x):
    return torch.sigmoid(x)
def _layernorm(x, axis=-1, eps=1e-5):
    m = x.mean(dim=axis, keepdim=True)
    v = x.var(dim=axis, keepdim=True, unbiased=False)
    return (x - m) / torch.sqrt(v + eps)
def _scatter_add(tgt, idx, src, axis=0):
    return tgt.clone().index_add_(axis, idx, src)
def _segment_sum(src, seg, n):
    out = torch.zeros((n,) + src.shape[1:], dtype=src.dtype)
    return out.index_add_(0, seg, src)
def _pad(x, pw):
    flat = tuple(v for pair in reversed(pw) for v in pair)
    return torch.nn.functional.pad(x, flat)

kernel_name = 'concat_heads__mha_block_cached__mha_block_cached__near_ridge'

def setup_inputs():

    _w = (lambda a: (lambda t: t.to(torch.bfloat16) if t.is_floating_point() else t)(torch.as_tensor(a)))
    def _A_setup():
        B, Sq, D = 8, 144, 448
        H, Sk, Dh = 16, 512, 256
        return {
            "x": _w((lambda *s: torch.randn(*s, dtype=torch.bfloat16) * 0.8)(B, Sq, D)),
            "k_cache": _w((lambda *s: torch.randn(*s, dtype=torch.bfloat16) * 0.8)(B, H, Sk, Dh)),
            "v_cache": _w((lambda *s: torch.randn(*s, dtype=torch.bfloat16) * 0.05)(B, H, Sk, Dh)),
            "wq": _w((lambda *s: torch.randn(*s, dtype=torch.bfloat16) * 0.8)(D, H * Dh) * (D ** -0.5)),
            "wo": _w((lambda *s: torch.randn(*s, dtype=torch.bfloat16) * 0.05)(H * Dh, D) * ((H * Dh) ** -0.5)),
        }
    _A_in = _A_setup()

    def _B_setup():
        B, Sq, D = 8, 144, 448
        H, Sk, Dh = 16, 512, 256
        return {
            "x": _w((lambda *s: torch.randn(*s, dtype=torch.bfloat16) * 0.8)(B, Sq, D)),
            "k_cache": _w((lambda *s: torch.randn(*s, dtype=torch.bfloat16) * 0.8)(B, H, Sk, Dh)),
            "v_cache": _w((lambda *s: torch.randn(*s, dtype=torch.bfloat16) * 0.05)(B, H, Sk, Dh)),
            "wq": _w((lambda *s: torch.randn(*s, dtype=torch.bfloat16) * 0.8)(D, H * Dh) * (D ** -0.5)),
            "wo": _w((lambda *s: torch.randn(*s, dtype=torch.bfloat16) * 0.05)(H * Dh, D) * ((H * Dh) ** -0.5)),
        }
    _B_in = _B_setup()

    return {
        "A_x": _A_in["x"],
        "A_k_cache": _A_in["k_cache"],
        "A_v_cache": _A_in["v_cache"],
        "A_wq": _A_in["wq"],
        "A_wo": _A_in["wo"],
        "B_x": _B_in["x"],
        "B_k_cache": _B_in["k_cache"],
        "B_v_cache": _B_in["v_cache"],
        "B_wq": _B_in["wq"],
        "B_wo": _B_in["wo"],
    }

def reference(A_x, A_k_cache, A_v_cache, A_wq, A_wo, B_x, B_k_cache, B_v_cache, B_wq, B_wo):
    def _A_ref(x, k_cache, v_cache, wq, wo):
        B, Sq, D = x.shape
        H, Dh = 16, 256
        q = (lambda x, *d: x.permute(*d))((x @ wq).reshape(B, Sq, H, Dh), 0, 2, 1, 3)
        scores = torch.einsum("bhqd,bhkd->bhqk", q, k_cache) * (Dh ** -0.5)
        p = _softmax(scores, axis=-1)
        o = torch.einsum("bhqk,bhkd->bhqd", p, v_cache)
        return (lambda x, *d: x.permute(*d))(o, 0, 2, 1, 3).reshape(B, Sq, H * Dh) @ wo

    def _B_ref(x, k_cache, v_cache, wq, wo):
        B, Sq, D = x.shape
        H, Dh = 16, 256
        q = (lambda x, *d: x.permute(*d))((x @ wq).reshape(B, Sq, H, Dh), 0, 2, 1, 3)
        scores = torch.einsum("bhqd,bhkd->bhqk", q, k_cache) * (Dh ** -0.5)
        p = _softmax(scores, axis=-1)
        o = torch.einsum("bhqk,bhkd->bhqd", p, v_cache)
        return (lambda x, *d: x.permute(*d))(o, 0, 2, 1, 3).reshape(B, Sq, H * Dh) @ wo

    a = _A_ref(A_x, A_k_cache, A_v_cache, A_wq, A_wo)
    b = _B_ref(B_x, B_k_cache, B_v_cache, B_wq, B_wo)
    return torch.concatenate([a, b], axis=-1)
```

```asm
; @launch kernel=attn_kernel grid=(256,1,1) block=(256,1,1) lds=135168
; @launch kernel=oproj_kernel grid=(256,1,1) block=(256,1,1) lds=131072
.amdgcn_target "amdgcn-amd-amdhsa--gfx950"
.text
.globl attn_kernel
.p2align 8
.type attn_kernel,@function
attn_kernel:
  s_cmp_ge_u32 s2, 256
  s_cbranch_scc1 L_k2_end
  s_load_dwordx2 s[40:41], s[0:1], 96
  s_lshr_b32 s4, s2, 7
  s_mul_i32 s5, s4, 40
  s_add_u32 s0, s0, s5
  s_addc_u32 s1, s1, 0
  s_load_dwordx8 s[32:39], s[0:1], 0
  s_and_b32 s6, s2, 15
  s_lshr_b32 s7, s2, 4
  s_and_b32 s7, s7, 7
  s_mul_i32 s43, s2, 1
  s_lshr_b32 s43, s43, 0
  s_and_b32 s43, s43, 7
  v_and_b32 v1, 63, v0
  v_lshrrev_b32 v4, 6, v0
  s_nop 1
  v_readfirstlane_b32 s28, v4
  v_lshrrev_b32 v2, 4, v1
  v_and_b32 v3, 15, v1
  s_nop 3
  s_lshl_b32 s29, s28, 13
  s_mov_b32 s30, 0x3db8aa3b
  s_waitcnt lgkmcnt(0)
  s_lshl_b32 s5, s7, 4
  s_add_u32 s5, s5, s6
  s_lshl_b32 s5, s5, 18
  s_add_u32 s8, s34, s5
  s_addc_u32 s9, s35, 0
  s_and_b32 s9, s9, 0xffff
  s_mov_b32 s10, 262144
  s_mov_b32 s11, 0x00020000
  s_add_u32 s12, s36, s5
  s_addc_u32 s13, s37, 0
  s_and_b32 s13, s13, 0xffff
  s_mov_b32 s14, 262144
  s_mov_b32 s15, 0x00020000
  s_lshl_b32 s5, s6, 9
  s_add_u32 s16, s38, s5
  s_addc_u32 s17, s39, 0
  s_and_b32 s17, s17, 0xffff
  s_sub_u32 s18, 3670016, s5
  s_mov_b32 s19, 0x00020000
  s_mul_i32 s5, s7, 129024
  s_add_u32 s20, s32, s5
  s_addc_u32 s21, s33, 0
  s_and_b32 s21, s21, 0xffff
  s_mov_b32 s22, 129024
  s_mov_b32 s23, 0x00020000
  s_mul_i32 s5, s4, 9732096
  s_add_u32 s24, s40, s5
  s_addc_u32 s25, s41, 0
  s_and_b32 s25, s25, 0xffff
  s_mov_b32 s26, 9732096
  s_mov_b32 s27, 0x00020000
  s_lshl_b32 s5, s28, 5
  s_add_u32 s5, s5, 0
  v_add_u32 v5, s5, v3
  s_movk_i32 s5, 896
  v_mul_lo_u32 v5, v5, s5
  v_lshl_add_u32 v6, v2, 4, v5
  s_lshl_b32 s5, s28, 5
  s_add_u32 s5, s5, 16
  v_add_u32 v5, s5, v3
  s_movk_i32 s5, 896
  v_mul_lo_u32 v5, v5, s5
  v_lshl_add_u32 v7, v2, 4, v5
  v_add_u32 v5, 128, v3
  s_movk_i32 s5, 896
  v_mul_lo_u32 v5, v5, s5
  v_lshl_add_u32 v8, v2, 4, v5
  buffer_load_dwordx4 a[0:3], v6, s[20:23], 0 offen
  buffer_load_dwordx4 a[4:7], v7, s[20:23], 0 offen
  buffer_load_dwordx4 a[8:11], v8, s[20:23], 0 offen
  buffer_load_dwordx4 a[12:15], v6, s[20:23], 0 offen offset:64
  buffer_load_dwordx4 a[16:19], v7, s[20:23], 0 offen offset:64
  buffer_load_dwordx4 a[20:23], v8, s[20:23], 0 offen offset:64
  buffer_load_dwordx4 a[24:27], v6, s[20:23], 0 offen offset:128
  buffer_load_dwordx4 a[28:31], v7, s[20:23], 0 offen offset:128
  buffer_load_dwordx4 a[32:35], v8, s[20:23], 0 offen offset:128
  buffer_load_dwordx4 a[36:39], v6, s[20:23], 0 offen offset:192
  buffer_load_dwordx4 a[40:43], v7, s[20:23], 0 offen offset:192
  buffer_load_dwordx4 a[44:47], v8, s[20:23], 0 offen offset:192
  buffer_load_dwordx4 a[48:51], v6, s[20:23], 0 offen offset:256
  buffer_load_dwordx4 a[52:55], v7, s[20:23], 0 offen offset:256
  buffer_load_dwordx4 a[56:59], v8, s[20:23], 0 offen offset:256
  buffer_load_dwordx4 a[60:63], v6, s[20:23], 0 offen offset:320
  buffer_load_dwordx4 a[64:67], v7, s[20:23], 0 offen offset:320
  buffer_load_dwordx4 a[68:71], v8, s[20:23], 0 offen offset:320
  buffer_load_dwordx4 a[72:75], v6, s[20:23], 0 offen offset:384
  buffer_load_dwordx4 a[76:79], v7, s[20:23], 0 offen offset:384
  buffer_load_dwordx4 a[80:83], v8, s[20:23], 0 offen offset:384
  buffer_load_dwordx4 a[84:87], v6, s[20:23], 0 offen offset:448
  buffer_load_dwordx4 a[88:91], v7, s[20:23], 0 offen offset:448
  buffer_load_dwordx4 a[92:95], v8, s[20:23], 0 offen offset:448
  buffer_load_dwordx4 a[96:99], v6, s[20:23], 0 offen offset:512
  buffer_load_dwordx4 a[100:103], v7, s[20:23], 0 offen offset:512
  buffer_load_dwordx4 a[104:107], v8, s[20:23], 0 offen offset:512
  buffer_load_dwordx4 a[108:111], v6, s[20:23], 0 offen offset:576
  buffer_load_dwordx4 a[112:115], v7, s[20:23], 0 offen offset:576
  buffer_load_dwordx4 a[116:119], v8, s[20:23], 0 offen offset:576
  buffer_load_dwordx4 a[120:123], v6, s[20:23], 0 offen offset:640
  buffer_load_dwordx4 a[124:127], v7, s[20:23], 0 offen offset:640
  buffer_load_dwordx4 a[128:131], v8, s[20:23], 0 offen offset:640
  buffer_load_dwordx4 a[132:135], v6, s[20:23], 0 offen offset:704
  buffer_load_dwordx4 a[136:139], v7, s[20:23], 0 offen offset:704
  buffer_load_dwordx4 a[140:143], v8, s[20:23], 0 offen offset:704
  buffer_load_dwordx4 a[144:147], v6, s[20:23], 0 offen offset:768
  buffer_load_dwordx4 a[148:151], v7, s[20:23], 0 offen offset:768
  buffer_load_dwordx4 a[152:155], v8, s[20:23], 0 offen offset:768
  buffer_load_dwordx4 a[156:159], v6, s[20:23], 0 offen offset:832
  buffer_load_dwordx4 a[160:163], v7, s[20:23], 0 offen offset:832
  buffer_load_dwordx4 a[164:167], v8, s[20:23], 0 offen offset:832
  v_lshrrev_b32 v9, 5, v1
  v_and_b32 v10, 31, v1
  v_xor_b32 v24, v10, v9
  v_lshlrev_b32 v11, 1, v9
  v_xor_b32 v25, v10, v11
  v_lshlrev_b32 v11, 2, v9
  v_xor_b32 v26, v10, v11
  s_lshl_b32 s5, s28, 4
  v_add_u32 v11, s5, v9
  v_lshlrev_b32 v27, 9, v11
  v_lshlrev_b32 v28, 13, v11
  v_xor_b32 v11, 16, v1
  v_lshlrev_b32 v29, 2, v11
  v_xor_b32 v11, 32, v1
  v_lshlrev_b32 v30, 2, v11
  v_xor_b32 v12, 0, v26
  v_lshl_add_u32 v12, v12, 4, v28
  v_add_u32 v16, 0, v12
  v_xor_b32 v12, 8, v26
  v_lshl_add_u32 v12, v12, 4, v28
  v_add_u32 v17, 16384, v12
  v_xor_b32 v12, 0, v26
  v_lshl_add_u32 v12, v12, 4, v28
  v_add_u32 v18, 32768, v12
  v_xor_b32 v12, 8, v26
  v_lshl_add_u32 v12, v12, 4, v28
  v_add_u32 v19, 49152, v12
  v_xor_b32 v12, 0, v26
  v_lshl_add_u32 v12, v12, 4, v28
  v_add_u32 v20, 65536, v12
  v_xor_b32 v12, 8, v26
  v_lshl_add_u32 v12, v12, 4, v28
  v_add_u32 v21, 81920, v12
  v_xor_b32 v12, 0, v26
  v_lshl_add_u32 v12, v12, 4, v28
  v_add_u32 v22, 98304, v12
  v_xor_b32 v12, 8, v26
  v_lshl_add_u32 v12, v12, 4, v28
  v_add_u32 v23, 114688, v12
  s_mov_b32 s31, 0
  s_add_u32 m0, s29, 0
  s_nop 0
  buffer_load_dwordx4 v16, s[16:19], s31 offen lds
  s_add_u32 m0, s29, 1024
  s_nop 0
  buffer_load_dwordx4 v17, s[16:19], s31 offen lds
  s_add_u32 m0, s29, 2048
  s_nop 0
  buffer_load_dwordx4 v18, s[16:19], s31 offen lds
  s_add_u32 m0, s29, 3072
  s_nop 0
  buffer_load_dwordx4 v19, s[16:19], s31 offen lds
  s_add_u32 m0, s29, 4096
  s_nop 0
  buffer_load_dwordx4 v20, s[16:19], s31 offen lds
  s_add_u32 m0, s29, 5120
  s_nop 0
  buffer_load_dwordx4 v21, s[16:19], s31 offen lds
  s_add_u32 m0, s29, 6144
  s_nop 0
  buffer_load_dwordx4 v22, s[16:19], s31 offen lds
  s_add_u32 m0, s29, 7168
  s_nop 0
  buffer_load_dwordx4 v23, s[16:19], s31 offen lds
  s_mov_b32 s42, 524288
  s_add_u32 m0, s29, 32768
  s_nop 0
  buffer_load_dwordx4 v16, s[16:19], s42 offen lds
  s_add_u32 m0, s29, 33792
  s_nop 0
  buffer_load_dwordx4 v17, s[16:19], s42 offen lds
  s_add_u32 m0, s29, 34816
  s_nop 0
  buffer_load_dwordx4 v18, s[16:19], s42 offen lds
  s_add_u32 m0, s29, 35840
  s_nop 0
  buffer_load_dwordx4 v19, s[16:19], s42 offen lds
  s_add_u32 m0, s29, 36864
  s_nop 0
  buffer_load_dwordx4 v20, s[16:19], s42 offen lds
  s_add_u32 m0, s29, 37888
  s_nop 0
  buffer_load_dwordx4 v21, s[16:19], s42 offen lds
  s_add_u32 m0, s29, 38912
  s_nop 0
  buffer_load_dwordx4 v22, s[16:19], s42 offen lds
  s_add_u32 m0, s29, 39936
  s_nop 0
  buffer_load_dwordx4 v23, s[16:19], s42 offen lds
  s_mov_b32 s31, 1048576
  s_add_u32 m0, s29, 65536
  s_nop 0
  buffer_load_dwordx4 v16, s[16:19], s31 offen lds
  s_add_u32 m0, s29, 66560
  s_nop 0
  buffer_load_dwordx4 v17, s[16:19], s31 offen lds
  s_add_u32 m0, s29, 67584
  s_nop 0
  buffer_load_dwordx4 v18, s[16:19], s31 offen lds
  s_add_u32 m0, s29, 68608
  s_nop 0
  buffer_load_dwordx4 v19, s[16:19], s31 offen lds
  s_add_u32 m0, s29, 69632
  s_nop 0
  buffer_load_dwordx4 v20, s[16:19], s31 offen lds
  s_add_u32 m0, s29, 70656
  s_nop 0
  buffer_load_dwordx4 v21, s[16:19], s31 offen lds
  s_add_u32 m0, s29, 71680
  s_nop 0
  buffer_load_dwordx4 v22, s[16:19], s31 offen lds
  s_add_u32 m0, s29, 72704
  s_nop 0
  buffer_load_dwordx4 v23, s[16:19], s31 offen lds
  v_lshrrev_b32 v4, 2, v3
  v_and_b32 v5, 3, v3
  v_lshl_add_u32 v6, v2, 3, v4
  v_lshlrev_b32 v6, 9, v6
  v_xor_b32 v7, 0, v4
  v_lshl_add_u32 v7, v7, 2, v5
  v_lshl_add_u32 v40, v7, 4, v6
  v_add_u32 v41, 0x10000, v40
  v_xor_b32 v7, 1, v4
  v_lshl_add_u32 v7, v7, 2, v5
  v_lshl_add_u32 v42, v7, 4, v6
  v_add_u32 v43, 0x10000, v42
  v_xor_b32 v7, 2, v4
  v_lshl_add_u32 v7, v7, 2, v5
  v_lshl_add_u32 v44, v7, 4, v6
  v_add_u32 v45, 0x10000, v44
  v_xor_b32 v7, 3, v4
  v_lshl_add_u32 v7, v7, 2, v5
  v_lshl_add_u32 v46, v7, 4, v6
  v_add_u32 v47, 0x10000, v46
  s_waitcnt vmcnt(16)
  s_barrier
  ds_read_b64_tr_b16 a[192:193], v40 offset:0
  ds_read_b64_tr_b16 a[194:195], v40 offset:2048
  ds_read_b64_tr_b16 a[196:197], v40 offset:8
  ds_read_b64_tr_b16 a[198:199], v40 offset:2056
  ds_read_b64_tr_b16 a[200:201], v42 offset:0
  ds_read_b64_tr_b16 a[202:203], v42 offset:2048
  ds_read_b64_tr_b16 a[204:205], v42 offset:8
  ds_read_b64_tr_b16 a[206:207], v42 offset:2056
  ds_read_b64_tr_b16 a[208:209], v44 offset:0
  ds_read_b64_tr_b16 a[210:211], v44 offset:2048
  ds_read_b64_tr_b16 a[212:213], v44 offset:8
  ds_read_b64_tr_b16 a[214:215], v44 offset:2056
  ds_read_b64_tr_b16 a[216:217], v46 offset:0
  ds_read_b64_tr_b16 a[218:219], v46 offset:2048
  s_waitcnt lgkmcnt(12)
  v_mfma_f32_16x16x32_bf16 v[64:67], a[192:195], a[0:3], 0
  v_mfma_f32_16x16x32_bf16 v[128:131], a[192:195], a[4:7], 0
  v_mfma_f32_16x16x32_bf16 v[192:195], a[192:195], a[8:11], 0
  ds_read_b64_tr_b16 a[220:221], v46 offset:8
  ds_read_b64_tr_b16 a[222:223], v46 offset:2056
  s_waitcnt lgkmcnt(12)
  v_mfma_f32_16x16x32_bf16 v[68:71], a[196:199], a[0:3], 0
  v_mfma_f32_16x16x32_bf16 v[132:135], a[196:199], a[4:7], 0
  v_mfma_f32_16x16x32_bf16 v[196:199], a[196:199], a[8:11], 0
  ds_read_b64_tr_b16 a[224:225], v40 offset:256
  ds_read_b64_tr_b16 a[226:227], v40 offset:2304
  s_waitcnt lgkmcnt(12)
  v_mfma_f32_16x16x32_bf16 v[72:75], a[200:203], a[0:3], 0
  v_mfma_f32_16x16x32_bf16 v[136:139], a[200:203], a[4:7], 0
  v_mfma_f32_16x16x32_bf16 v[200:203], a[200:203], a[8:11], 0
  ds_read_b64_tr_b16 a[228:229], v40 offset:264
  ds_read_b64_tr_b16 a[230:231], v40 offset:2312
  s_waitcnt lgkmcnt(12)
  v_mfma_f32_16x16x32_bf16 v[76:79], a[204:207], a[0:3], 0
  s_mov_b32 s42, 1572864
  v_mfma_f32_16x16x32_bf16 v[140:143], a[204:207], a[4:7], 0
  v_mfma_f32_16x16x32_bf16 v[204:207], a[204:207], a[8:11], 0
  ds_read_b64_tr_b16 a[232:233], v42 offset:256
  ds_read_b64_tr_b16 a[234:235], v42 offset:2304
  s_waitcnt lgkmcnt(12)
  v_mfma_f32_16x16x32_bf16 v[80:83], a[208:211], a[0:3], 0
  v_mfma_f32_16x16x32_bf16 v[144:147], a[208:211], a[4:7], 0
  v_mfma_f32_16x16x32_bf16 v[208:211], a[208:211], a[8:11], 0
  ds_read_b64_tr_b16 a[236:237], v42 offset:264
  ds_read_b64_tr_b16 a[238:239], v42 offset:2312
  s_waitcnt lgkmcnt(12)
  v_mfma_f32_16x16x32_bf16 v[84:87], a[212:215], a[0:3], 0
  v_mfma_f32_16x16x32_bf16 v[148:151], a[212:215], a[4:7], 0
  v_mfma_f32_16x16x32_bf16 v[212:215], a[212:215], a[8:11], 0
  ds_read_b64_tr_b16 a[240:241], v44 offset:256
  ds_read_b64_tr_b16 a[242:243], v44 offset:2304
  s_waitcnt lgkmcnt(12)
  v_mfma_f32_16x16x32_bf16 v[88:91], a[216:219], a[0:3], 0
  v_mfma_f32_16x16x32_bf16 v[152:155], a[216:219], a[4:7], 0
  s_add_u32 m0, s29, 98304
  s_nop 0
  buffer_load_dwordx4 v16, s[16:19], s42 offen lds
  v_mfma_f32_16x16x32_bf16 v[216:219], a[216:219], a[8:11], 0
  ds_read_b64_tr_b16 a[244:245], v44 offset:264
  ds_read_b64_tr_b16 a[246:247], v44 offset:2312
  s_waitcnt lgkmcnt(12)
  v_mfma_f32_16x16x32_bf16 v[92:95], a[220:223], a[0:3], 0
  v_mfma_f32_16x16x32_bf16 v[156:159], a[220:223], a[4:7], 0
  v_mfma_f32_16x16x32_bf16 v[220:223], a[220:223], a[8:11], 0
  ds_read_b64_tr_b16 a[248:249], v46 offset:256
  ds_read_b64_tr_b16 a[250:251], v46 offset:2304
  s_waitcnt lgkmcnt(12)
  v_mfma_f32_16x16x32_bf16 v[96:99], a[224:227], a[0:3], 0
  v_mfma_f32_16x16x32_bf16 v[160:163], a[224:227], a[4:7], 0
  v_mfma_f32_16x16x32_bf16 v[224:227], a[224:227], a[8:11], 0
  ds_read_b64_tr_b16 a[252:253], v46 offset:264
  ds_read_b64_tr_b16 a[254:255], v46 offset:2312
  s_waitcnt lgkmcnt(12)
  v_mfma_f32_16x16x32_bf16 v[100:103], a[228:231], a[0:3], 0
  v_mfma_f32_16x16x32_bf16 v[164:167], a[228:231], a[4:7], 0
  v_mfma_f32_16x16x32_bf16 v[228:231], a[228:231], a[8:11], 0
  s_add_u32 m0, s29, 99328
  s_nop 0
  buffer_load_dwordx4 v17, s[16:19], s42 offen lds
  ds_read_b64_tr_b16 a[192:193], v40 offset:16384
  ds_read_b64_tr_b16 a[194:195], v40 offset:18432
  s_waitcnt lgkmcnt(12)
  v_mfma_f32_16x16x32_bf16 v[104:107], a[232:235], a[0:3], 0
  v_mfma_f32_16x16x32_bf16 v[168:171], a[232:235], a[4:7], 0
  v_mfma_f32_16x16x32_bf16 v[232:235], a[232:235], a[8:11], 0
  ds_read_b64_tr_b16 a[196:197], v40 offset:16392
  ds_read_b64_tr_b16 a[198:199], v40 offset:18440
  s_waitcnt lgkmcnt(12)
  v_mfma_f32_16x16x32_bf16 v[108:111], a[236:239], a[0:3], 0
  v_mfma_f32_16x16x32_bf16 v[172:175], a[236:239], a[4:7], 0
  v_mfma_f32_16x16x32_bf16 v[236:239], a[236:239], a[8:11], 0
  ds_read_b64_tr_b16 a[200:201], v42 offset:16384
  ds_read_b64_tr_b16 a[202:203], v42 offset:18432
  s_waitcnt lgkmcnt(12)
  v_mfma_f32_16x16x32_bf16 v[112:115], a[240:243], a[0:3], 0
  v_mfma_f32_16x16x32_bf16 v[176:179], a[240:243], a[4:7], 0
  v_mfma_f32_16x16x32_bf16 v[240:243], a[240:243], a[8:11], 0
  ds_read_b64_tr_b16 a[204:205], v42 offset:16392
  ds_read_b64_tr_b16 a[206:207], v42 offset:18440
  s_waitcnt lgkmcnt(12)
  v_mfma_f32_16x16x32_bf16 v[116:119], a[244:247], a[0:3], 0
  s_add_u32 m0, s29, 100352
  s_nop 0
  buffer_load_dwordx4 v18, s[16:19], s42 offen lds
  v_mfma_f32_16x16x32_bf16 v[180:183], a[244:247], a[4:7], 0
  v_mfma_f32_16x16x32_bf16 v[244:247], a[244:247], a[8:11], 0
  ds_read_b64_tr_b16 a[208:209], v44 offset:16384
  ds_read_b64_tr_b16 a[210:211], v44 offset:18432
  s_waitcnt lgkmcnt(12)
  v_mfma_f32_16x16x32_bf16 v[120:123], a[248:251], a[0:3], 0
  v_mfma_f32_16x16x32_bf16 v[184:187], a[248:251], a[4:7], 0
  v_mfma_f32_16x16x32_bf16 v[248:251], a[248:251], a[8:11], 0
  ds_read_b64_tr_b16 a[212:213], v44 offset:16392
  ds_read_b64_tr_b16 a[214:215], v44 offset:18440
  s_waitcnt lgkmcnt(12)
  v_mfma_f32_16x16x32_bf16 v[124:127], a[252:255], a[0:3], 0
  v_mfma_f32_16x16x32_bf16 v[188:191], a[252:255], a[4:7], 0
  v_mfma_f32_16x16x32_bf16 v[252:255], a[252:255], a[8:11], 0
  ds_read_b64_tr_b16 a[216:217], v46 offset:16384
  ds_read_b64_tr_b16 a[218:219], v46 offset:18432
  s_waitcnt lgkmcnt(12)
  v_mfma_f32_16x16x32_bf16 v[64:67], a[192:195], a[12:15], v[64:67]
  v_mfma_f32_16x16x32_bf16 v[128:131], a[192:195], a[16:19], v[128:131]
  s_add_u32 m0, s29, 101376
  s_nop 0
  buffer_load_dwordx4 v19, s[16:19], s42 offen lds
  v_mfma_f32_16x16x32_bf16 v[192:195], a[192:195], a[20:23], v[192:195]
  ds_read_b64_tr_b16 a[220:221], v46 offset:16392
  ds_read_b64_tr_b16 a[222:223], v46 offset:18440
  s_waitcnt lgkmcnt(12)
  v_mfma_f32_16x16x32_bf16 v[68:71], a[196:199], a[12:15], v[68:71]
  v_mfma_f32_16x16x32_bf16 v[132:135], a[196:199], a[16:19], v[132:135]
  v_mfma_f32_16x16x32_bf16 v[196:199], a[196:199], a[20:23], v[196:199]
  ds_read_b64_tr_b16 a[224:225], v40 offset:16640
  ds_read_b64_tr_b16 a[226:227], v40 offset:18688
  s_waitcnt lgkmcnt(12)
  v_mfma_f32_16x16x32_bf16 v[72:75], a[200:203], a[12:15], v[72:75]
  v_mfma_f32_16x16x32_bf16 v[136:139], a[200:203], a[16:19], v[136:139]
  v_mfma_f32_16x16x32_bf16 v[200:203], a[200:203], a[20:23], v[200:203]
  ds_read_b64_tr_b16 a[228:229], v40 offset:16648
  ds_read_b64_tr_b16 a[230:231], v40 offset:18696
  s_waitcnt lgkmcnt(12)
  v_mfma_f32_16x16x32_bf16 v[76:79], a[204:207], a[12:15], v[76:79]
  v_mfma_f32_16x16x32_bf16 v[140:143], a[204:207], a[16:19], v[140:143]
  v_mfma_f32_16x16x32_bf16 v[204:207], a[204:207], a[20:23], v[204:207]
  s_add_u32 m0, s29, 102400
  s_nop 0
  buffer_load_dwordx4 v20, s[16:19], s42 offen lds
  ds_read_b64_tr_b16 a[232:233], v42 offset:16640
  ds_read_b64_tr_b16 a[234:235], v42 offset:18688
  s_waitcnt lgkmcnt(12)
  v_mfma_f32_16x16x32_bf16 v[80:83], a[208:211], a[12:15], v[80:83]
  v_mfma_f32_16x16x32_bf16 v[144:147], a[208:211], a[16:19], v[144:147]
  v_mfma_f32_16x16x32_bf16 v[208:211], a[208:211], a[20:23], v[208:211]
  ds_read_b64_tr_b16 a[236:237], v42 offset:16648
  ds_read_b64_tr_b16 a[238:239], v42 offset:18696
  s_waitcnt lgkmcnt(12)
  v_mfma_f32_16x16x32_bf16 v[84:87], a[212:215], a[12:15], v[84:87]
  v_mfma_f32_16x16x32_bf16 v[148:151], a[212:215], a[16:19], v[148:151]
  v_mfma_f32_16x16x32_bf16 v[212:215], a[212:215], a[20:23], v[212:215]
  ds_read_b64_tr_b16 a[240:241], v44 offset:16640
  ds_read_b64_tr_b16 a[242:243], v44 offset:18688
  s_waitcnt lgkmcnt(12)
  v_mfma_f32_16x16x32_bf16 v[88:91], a[216:219], a[12:15], v[88:91]
  v_mfma_f32_16x16x32_bf16 v[152:155], a[216:219], a[16:19], v[152:155]
  v_mfma_f32_16x16x32_bf16 v[216:219], a[216:219], a[20:23], v[216:219]
  ds_read_b64_tr_b16 a[244:245], v44 offset:16648
  ds_read_b64_tr_b16 a[246:247], v44 offset:18696
  s_waitcnt lgkmcnt(12)
  v_mfma_f32_16x16x32_bf16 v[92:95], a[220:223], a[12:15], v[92:95]
  s_add_u32 m0, s29, 103424
  s_nop 0
  buffer_load_dwordx4 v21, s[16:19], s42 offen lds
  v_mfma_f32_16x16x32_bf16 v[156:159], a[220:223], a[16:19], v[156:159]
  v_mfma_f32_16x16x32_bf16 v[220:223], a[220:223], a[20:23], v[220:223]
  ds_read_b64_tr_b16 a[248:249], v46 offset:16640
  ds_read_b64_tr_b16 a[250:251], v46 offset:18688
  s_waitcnt lgkmcnt(12)
  v_mfma_f32_16x16x32_bf16 v[96:99], a[224:227], a[12:15], v[96:99]
  v_mfma_f32_16x16x32_bf16 v[160:163], a[224:227], a[16:19], v[160:163]
  v_mfma_f32_16x16x32_bf16 v[224:227], a[224:227], a[20:23], v[224:227]
  ds_read_b64_tr_b16 a[252:253], v46 offset:16648
  ds_read_b64_tr_b16 a[254:255], v46 offset:18696
  s_waitcnt lgkmcnt(12)
  v_mfma_f32_16x16x32_bf16 v[100:103], a[228:231], a[12:15], v[100:103]
  v_mfma_f32_16x16x32_bf16 v[164:167], a[228:231], a[16:19], v[164:167]
  v_mfma_f32_16x16x32_bf16 v[228:231], a[228:231], a[20:23], v[228:231]
  s_waitcnt lgkmcnt(10)
  v_mfma_f32_16x16x32_bf16 v[104:107], a[232:235], a[12:15], v[104:107]
  v_mfma_f32_16x16x32_bf16 v[168:171], a[232:235], a[16:19], v[168:171]
  s_add_u32 m0, s29, 104448
  s_nop 0
  buffer_load_dwordx4 v22, s[16:19], s42 offen lds
  v_mfma_f32_16x16x32_bf16 v[232:235], a[232:235], a[20:23], v[232:235]
  s_waitcnt lgkmcnt(8)
  v_mfma_f32_16x16x32_bf16 v[108:111], a[236:239], a[12:15], v[108:111]
  v_mfma_f32_16x16x32_bf16 v[172:175], a[236:239], a[16:19], v[172:175]
  v_mfma_f32_16x16x32_bf16 v[236:239], a[236:239], a[20:23], v[236:239]
  s_waitcnt lgkmcnt(6)
  v_mfma_f32_16x16x32_bf16 v[112:115], a[240:243], a[12:15], v[112:115]
  v_mfma_f32_16x16x32_bf16 v[176:179], a[240:243], a[16:19], v[176:179]
  v_mfma_f32_16x16x32_bf16 v[240:243], a[240:243], a[20:23], v[240:243]
  s_waitcnt lgkmcnt(4)
  v_mfma_f32_16x16x32_bf16 v[116:119], a[244:247], a[12:15], v[116:119]
  v_mfma_f32_16x16x32_bf16 v[180:183], a[244:247], a[16:19], v[180:183]
  v_mfma_f32_16x16x32_bf16 v[244:247], a[244:247], a[20:23], v[244:247]
  s_add_u32 m0, s29, 105472
  s_nop 0
  buffer_load_dwordx4 v23, s[16:19], s42 offen lds
  s_waitcnt lgkmcnt(2)
  v_mfma_f32_16x16x32_bf16 v[120:123], a[248:251], a[12:15], v[120:123]
  v_mfma_f32_16x16x32_bf16 v[184:187], a[248:251], a[16:19], v[184:187]
  v_mfma_f32_16x16x32_bf16 v[248:251], a[248:251], a[20:23], v[248:251]
  s_waitcnt lgkmcnt(0)
  v_mfma_f32_16x16x32_bf16 v[124:127], a[252:255], a[12:15], v[124:127]
  v_mfma_f32_16x16x32_bf16 v[188:191], a[252:255], a[16:19], v[188:191]
  v_mfma_f32_16x16x32_bf16 v[252:255], a[252:255], a[20:23], v[252:255]
  s_waitcnt vmcnt(16)
  s_barrier
  ds_read_b64_tr_b16 a[192:193], v40 offset:32768
  ds_read_b64_tr_b16 a[194:195], v40 offset:34816
  ds_read_b64_tr_b16 a[196:197], v40 offset:32776
  ds_read_b64_tr_b16 a[198:199], v40 offset:34824
  ds_read_b64_tr_b16 a[200:201], v42 offset:32768
  ds_read_b64_tr_b16 a[202:203], v42 offset:34816
  ds_read_b64_tr_b16 a[204:205], v42 offset:32776
  ds_read_b64_tr_b16 a[206:207], v42 offset:34824
  ds_read_b64_tr_b16 a[208:209], v44 offset:32768
  ds_read_b64_tr_b16 a[210:211], v44 offset:34816
  ds_read_b64_tr_b16 a[212:213], v44 offset:32776
  ds_read_b64_tr_b16 a[214:215], v44 offset:34824
  ds_read_b64_tr_b16 a[216:217], v46 offset:32768
  ds_read_b64_tr_b16 a[218:219], v46 offset:34816
  s_waitcnt lgkmcnt(12)
  v_mfma_f32_16x16x32_bf16 v[64:67], a[192:195], a[24:27], v[64:67]
  v_mfma_f32_16x16x32_bf16 v[128:131], a[192:195], a[28:31], v[128:131]
  v_mfma_f32_16x16x32_bf16 v[192:195], a[192:195], a[32:35], v[192:195]
  ds_read_b64_tr_b16 a[220:221], v46 offset:32776
  ds_read_b64_tr_b16 a[222:223], v46 offset:34824
  s_waitcnt lgkmcnt(12)
  v_mfma_f32_16x16x32_bf16 v[68:71], a[196:199], a[24:27], v[68:71]
  s_mov_b32 s31, 2097152
  v_mfma_f32_16x16x32_bf16 v[132:135], a[196:199], a[28:31], v[132:135]
  v_mfma_f32_16x16x32_bf16 v[196:199], a[196:199], a[32:35], v[196:199]
  ds_read_b64_tr_b16 a[224:225], v40 offset:33024
  ds_read_b64_tr_b16 a[226:227], v40 offset:35072
  s_waitcnt lgkmcnt(12)
  v_mfma_f32_16x16x32_bf16 v[72:75], a[200:203], a[24:27], v[72:75]
  v_mfma_f32_16x16x32_bf16 v[136:139], a[200:203], a[28:31], v[136:139]
  v_mfma_f32_16x16x32_bf16 v[200:203], a[200:203], a[32:35], v[200:203]
  ds_read_b64_tr_b16 a[228:229], v40 offset:33032
  ds_read_b64_tr_b16 a[230:231], v40 offset:35080
  s_waitcnt lgkmcnt(12)
  v_mfma_f32_16x16x32_bf16 v[76:79], a[204:207], a[24:27], v[76:79]
  v_mfma_f32_16x16x32_bf16 v[140:143], a[204:207], a[28:31], v[140:143]
  v_mfma_f32_16x16x32_bf16 v[204:207], a[204:207], a[32:35], v[204:207]
  ds_read_b64_tr_b16 a[232:233], v42 offset:33024
  ds_read_b64_tr_b16 a[234:235], v42 offset:35072
  s_waitcnt lgkmcnt(12)
  v_mfma_f32_16x16x32_bf16 v[80:83], a[208:211], a[24:27], v[80:83]
  v_mfma_f32_16x16x32_bf16 v[144:147], a[208:211], a[28:31], v[144:147]
  s_add_u32 m0, s29, 0
  s_nop 0
  buffer_load_dwordx4 v16, s[16:19], s31 offen lds
  v_mfma_f32_16x16x32_bf16 v[208:211], a[208:211], a[32:35], v[208:211]
  ds_read_b64_tr_b16 a[236:237], v42 offset:33032
  ds_read_b64_tr_b16 a[238:239], v42 offset:35080
  s_waitcnt lgkmcnt(12)
  v_mfma_f32_16x16x32_bf16 v[84:87], a[212:215], a[24:27], v[84:87]
  v_mfma_f32_16x16x32_bf16 v[148:151], a[212:215], a[28:31], v[148:151]
  v_mfma_f32_16x16x32_bf16 v[212:215], a[212:215], a[32:35], v[212:215]
  ds_read_b64_tr_b16 a[240:241], v44 offset:33024
  ds_read_b64_tr_b16 a[242:243], v44 offset:35072
  s_waitcnt lgkmcnt(12)
  v_mfma_f32_16x16x32_bf16 v[88:91], a[216:219], a[24:27], v[88:91]
  v_mfma_f32_16x16x32_bf16 v[152:155], a[216:219], a[28:31], v[152:155]
  v_mfma_f32_16x16x32_bf16 v[216:219], a[216:219], a[32:35], v[216:219]
  ds_read_b64_tr_b16 a[244:245], v44 offset:33032
  ds_read_b64_tr_b16 a[246:247], v44 offset:35080
  s_waitcnt lgkmcnt(12)
  v_mfma_f32_16x16x32_bf16 v[92:95], a[220:223], a[24:27], v[92:95]
  v_mfma_f32_16x16x32_bf16 v[156:159], a[220:223], a[28:31], v[156:159]
  v_mfma_f32_16x16x32_bf16 v[220:223], a[220:223], a[32:35], v[220:223]
  s_add_u32 m0, s29, 1024
  s_nop 0
  buffer_load_dwordx4 v17, s[16:19], s31 offen lds
  ds_read_b64_tr_b16 a[248:249], v46 offset:33024
  ds_read_b64_tr_b16 a[250:251], v46 offset:35072
  s_waitcnt lgkmcnt(12)
  v_mfma_f32_16x16x32_bf16 v[96:99], a[224:227], a[24:27], v[96:99]
  v_mfma_f32_16x16x32_bf16 v[160:163], a[224:227], a[28:31], v[160:163]
  v_mfma_f32_16x16x32_bf16 v[224:227], a[224:227], a[32:35], v[224:227]
  ds_read_b64_tr_b16 a[252:253], v46 offset:33032
  ds_read_b64_tr_b16 a[254:255], v46 offset:35080
  s_waitcnt lgkmcnt(12)
  v_mfma_f32_16x16x32_bf16 v[100:103], a[228:231], a[24:27], v[100:103]
  v_mfma_f32_16x16x32_bf16 v[164:167], a[228:231], a[28:31], v[164:167]
  v_mfma_f32_16x16x32_bf16 v[228:231], a[228:231], a[32:35], v[228:231]
  ds_read_b64_tr_b16 a[192:193], v40 offset:49152
  ds_read_b64_tr_b16 a[194:195], v40 offset:51200
  s_waitcnt lgkmcnt(12)
  v_mfma_f32_16x16x32_bf16 v[104:107], a[232:235], a[24:27], v[104:107]
  v_mfma_f32_16x16x32_bf16 v[168:171], a[232:235], a[28:31], v[168:171]
  v_mfma_f32_16x16x32_bf16 v[232:235], a[232:235], a[32:35], v[232:235]
  ds_read_b64_tr_b16 a[196:197], v40 offset:49160
  ds_read_b64_tr_b16 a[198:199], v40 offset:51208
  s_waitcnt lgkmcnt(12)
  v_mfma_f32_16x16x32_bf16 v[108:111], a[236:239], a[24:27], v[108:111]
  s_add_u32 m0, s29, 2048
  s_nop 0
  buffer_load_dwordx4 v18, s[16:19], s31 offen lds
  v_mfma_f32_16x16x32_bf16 v[172:175], a[236:239], a[28:31], v[172:175]
  v_mfma_f32_16x16x32_bf16 v[236:239], a[236:239], a[32:35], v[236:239]
  ds_read_b64_tr_b16 a[200:201], v42 offset:49152
  ds_read_b64_tr_b16 a[202:203], v42 offset:51200
  s_waitcnt lgkmcnt(12)
  v_mfma_f32_16x16x32_bf16 v[112:115], a[240:243], a[24:27], v[112:115]
  v_mfma_f32_16x16x32_bf16 v[176:179], a[240:243], a[28:31], v[176:179]
  v_mfma_f32_16x16x32_bf16 v[240:243], a[240:243], a[32:35], v[240:243]
  ds_read_b64_tr_b16 a[204:205], v42 offset:49160
  ds_read_b64_tr_b16 a[206:207], v42 offset:51208
  s_waitcnt lgkmcnt(12)
  v_mfma_f32_16x16x32_bf16 v[116:119], a[244:247], a[24:27], v[116:119]
  v_mfma_f32_16x16x32_bf16 v[180:183], a[244:247], a[28:31], v[180:183]
  v_mfma_f32_16x16x32_bf16 v[244:247], a[244:247], a[32:35], v[244:247]
  ds_read_b64_tr_b16 a[208:209], v44 offset:49152
  ds_read_b64_tr_b16 a[210:211], v44 offset:51200
  s_waitcnt lgkmcnt(12)
  v_mfma_f32_16x16x32_bf16 v[120:123], a[248:251], a[24:27], v[120:123]
  v_mfma_f32_16x16x32_bf16 v[184:187], a[248:251], a[28:31], v[184:187]
  s_add_u32 m0, s29, 3072
  s_nop 0
  buffer_load_dwordx4 v19, s[16:19], s31 offen lds
  v_mfma_f32_16x16x32_bf16 v[248:251], a[248:251], a[32:35], v[248:251]
  ds_read_b64_tr_b16 a[212:213], v44 offset:49160
  ds_read_b64_tr_b16 a[214:215], v44 offset:51208
  s_waitcnt lgkmcnt(12)
  v_mfma_f32_16x16x32_bf16 v[124:127], a[252:255], a[24:27], v[124:127]
  v_mfma_f32_16x16x32_bf16 v[188:191], a[252:255], a[28:31], v[188:191]
  v_mfma_f32_16x16x32_bf16 v[252:255], a[252:255], a[32:35], v[252:255]
  ds_read_b64_tr_b16 a[216:217], v46 offset:49152
  ds_read_b64_tr_b16 a[218:219], v46 offset:51200
  s_waitcnt lgkmcnt(12)
  v_mfma_f32_16x16x32_bf16 v[64:67], a[192:195], a[36:39], v[64:67]
  v_mfma_f32_16x16x32_bf16 v[128:131], a[192:195], a[40:43], v[128:131]
  v_mfma_f32_16x16x32_bf16 v[192:195], a[192:195], a[44:47], v[192:195]
  ds_read_b64_tr_b16 a[220:221], v46 offset:49160
  ds_read_b64_tr_b16 a[222:223], v46 offset:51208
  s_waitcnt lgkmcnt(12)
  v_mfma_f32_16x16x32_bf16 v[68:71], a[196:199], a[36:39], v[68:71]
  v_mfma_f32_16x16x32_bf16 v[132:135], a[196:199], a[40:43], v[132:135]
  v_mfma_f32_16x16x32_bf16 v[196:199], a[196:199], a[44:47], v[196:199]
  s_add_u32 m0, s29, 4096
  s_nop 0
  buffer_load_dwordx4 v20, s[16:19], s31 offen lds
  ds_read_b64_tr_b16 a[224:225], v40 offset:49408
  ds_read_b64_tr_b16 a[226:227], v40 offset:51456
  s_waitcnt lgkmcnt(12)
  v_mfma_f32_16x16x32_bf16 v[72:75], a[200:203], a[36:39], v[72:75]
  v_mfma_f32_16x16x32_bf16 v[136:139], a[200:203], a[40:43], v[136:139]
  v_mfma_f32_16x16x32_bf16 v[200:203], a[200:203], a[44:47], v[200:203]
  ds_read_b64_tr_b16 a[228:229], v40 offset:49416
  ds_read_b64_tr_b16 a[230:231], v40 offset:51464
  s_waitcnt lgkmcnt(12)
  v_mfma_f32_16x16x32_bf16 v[76:79], a[204:207], a[36:39], v[76:79]
  v_mfma_f32_16x16x32_bf16 v[140:143], a[204:207], a[40:43], v[140:143]
  v_mfma_f32_16x16x32_bf16 v[204:207], a[204:207], a[44:47], v[204:207]
  ds_read_b64_tr_b16 a[232:233], v42 offset:49408
  ds_read_b64_tr_b16 a[234:235], v42 offset:51456
  s_waitcnt lgkmcnt(12)
  v_mfma_f32_16x16x32_bf16 v[80:83], a[208:211], a[36:39], v[80:83]
  v_mfma_f32_16x16x32_bf16 v[144:147], a[208:211], a[40:43], v[144:147]
  v_mfma_f32_16x16x32_bf16 v[208:211], a[208:211], a[44:47], v[208:211]
  ds_read_b64_tr_b16 a[236:237], v42 offset:49416
  ds_read_b64_tr_b16 a[238:239], v42 offset:51464
  s_waitcnt lgkmcnt(12)
  v_mfma_f32_16x16x32_bf16 v[84:87], a[212:215], a[36:39], v[84:87]
  s_add_u32 m0, s29, 5120
  s_nop 0
  buffer_load_dwordx4 v21, s[16:19], s31 offen lds
  v_mfma_f32_16x16x32_bf16 v[148:151], a[212:215], a[40:43], v[148:151]
  v_mfma_f32_16x16x32_bf16 v[212:215], a[212:215], a[44:47], v[212:215]
  ds_read_b64_tr_b16 a[240:241], v44 offset:49408
  ds_read_b64_tr_b16 a[242:243], v44 offset:51456
  s_waitcnt lgkmcnt(12)
  v_mfma_f32_16x16x32_bf16 v[88:91], a[216:219], a[36:39], v[88:91]
  v_mfma_f32_16x16x32_bf16 v[152:155], a[216:219], a[40:43], v[152:155]
  v_mfma_f32_16x16x32_bf16 v[216:219], a[216:219], a[44:47], v[216:219]
  ds_read_b64_tr_b16 a[244:245], v44 offset:49416
  ds_read_b64_tr_b16 a[246:247], v44 offset:51464
  s_waitcnt lgkmcnt(12)
  v_mfma_f32_16x16x32_bf16 v[92:95], a[220:223], a[36:39], v[92:95]
  v_mfma_f32_16x16x32_bf16 v[156:159], a[220:223], a[40:43], v[156:159]
  v_mfma_f32_16x16x32_bf16 v[220:223], a[220:223], a[44:47], v[220:223]
  ds_read_b64_tr_b16 a[248:249], v46 offset:49408
  ds_read_b64_tr_b16 a[250:251], v46 offset:51456
  s_waitcnt lgkmcnt(12)
  v_mfma_f32_16x16x32_bf16 v[96:99], a[224:227], a[36:39], v[96:99]
  v_mfma_f32_16x16x32_bf16 v[160:163], a[224:227], a[40:43], v[160:163]
  s_add_u32 m0, s29, 6144
  s_nop 0
  buffer_load_dwordx4 v22, s[16:19], s31 offen lds
  v_mfma_f32_16x16x32_bf16 v[224:227], a[224:227], a[44:47], v[224:227]
  ds_read_b64_tr_b16 a[252:253], v46 offset:49416
  ds_read_b64_tr_b16 a[254:255], v46 offset:51464
  s_waitcnt lgkmcnt(12)
  v_mfma_f32_16x16x32_bf16 v[100:103], a[228:231], a[36:39], v[100:103]
  v_mfma_f32_16x16x32_bf16 v[164:167], a[228:231], a[40:43], v[164:167]
  v_mfma_f32_16x16x32_bf16 v[228:231], a[228:231], a[44:47], v[228:231]
  s_waitcnt lgkmcnt(10)
  v_mfma_f32_16x16x32_bf16 v[104:107], a[232:235], a[36:39], v[104:107]
  v_mfma_f32_16x16x32_bf16 v[168:171], a[232:235], a[40:43], v[168:171]
  v_mfma_f32_16x16x32_bf16 v[232:235], a[232:235], a[44:47], v[232:235]
  s_waitcnt lgkmcnt(8)
  v_mfma_f32_16x16x32_bf16 v[108:111], a[236:239], a[36:39], v[108:111]
  v_mfma_f32_16x16x32_bf16 v[172:175], a[236:239], a[40:43], v[172:175]
  v_mfma_f32_16x16x32_bf16 v[236:239], a[236:239], a[44:47], v[236:239]
  s_add_u32 m0, s29, 7168
  s_nop 0
  buffer_load_dwordx4 v23, s[16:19], s31 offen lds
  s_waitcnt lgkmcnt(6)
  v_mfma_f32_16x16x32_bf16 v[112:115], a[240:243], a[36:39], v[112:115]
  v_mfma_f32_16x16x32_bf16 v[176:179], a[240:243], a[40:43], v[176:179]
  v_mfma_f32_16x16x32_bf16 v[240:243], a[240:243], a[44:47], v[240:243]
  s_waitcnt lgkmcnt(4)
  v_mfma_f32_16x16x32_bf16 v[116:119], a[244:247], a[36:39], v[116:119]
  v_mfma_f32_16x16x32_bf16 v[180:183], a[244:247], a[40:43], v[180:183]
  v_mfma_f32_16x16x32_bf16 v[244:247], a[244:247], a[44:47], v[244:247]
  s_waitcnt lgkmcnt(2)
  v_mfma_f32_16x16x32_bf16 v[120:123], a[248:251], a[36:39], v[120:123]
  v_mfma_f32_16x16x32_bf16 v[184:187], a[248:251], a[40:43], v[184:187]
  v_mfma_f32_16x16x32_bf16 v[248:251], a[248:251], a[44:47], v[248:251]
  s_waitcnt lgkmcnt(0)
  v_mfma_f32_16x16x32_bf16 v[124:127], a[252:255], a[36:39], v[124:127]
  v_mfma_f32_16x16x32_bf16 v[188:191], a[252:255], a[40:43], v[188:191]
  v_mfma_f32_16x16x32_bf16 v[252:255], a[252:255], a[44:47], v[252:255]
  s_waitcnt vmcnt(16)
  s_barrier
  ds_read_b64_tr_b16 a[192:193], v41 offset:0
  ds_read_b64_tr_b16 a[194:195], v41 offset:2048
  ds_read_b64_tr_b16 a[196:197], v41 offset:8
  ds_read_b64_tr_b16 a[198:199], v41 offset:2056
  ds_read_b64_tr_b16 a[200:201], v43 offset:0
  ds_read_b64_tr_b16 a[202:203], v43 offset:2048
  ds_read_b64_tr_b16 a[204:205], v43 offset:8
  ds_read_b64_tr_b16 a[206:207], v43 offset:2056
  ds_read_b64_tr_b16 a[208:209], v45 offset:0
  ds_read_b64_tr_b16 a[210:211], v45 offset:2048
  ds_read_b64_tr_b16 a[212:213], v45 offset:8
  ds_read_b64_tr_b16 a[214:215], v45 offset:2056
  ds_read_b64_tr_b16 a[216:217], v47 offset:0
  ds_read_b64_tr_b16 a[218:219], v47 offset:2048
  s_waitcnt lgkmcnt(12)
  v_mfma_f32_16x16x32_bf16 v[64:67], a[192:195], a[48:51], v[64:67]
  v_mfma_f32_16x16x32_bf16 v[128:131], a[192:195], a[52:55], v[128:131]
  v_mfma_f32_16x16x32_bf16 v[192:195], a[192:195], a[56:59], v[192:195]
  ds_read_b64_tr_b16 a[220:221], v47 offset:8
  ds_read_b64_tr_b16 a[222:223], v47 offset:2056
  s_waitcnt lgkmcnt(12)
  v_mfma_f32_16x16x32_bf16 v[68:71], a[196:199], a[48:51], v[68:71]
  v_mfma_f32_16x16x32_bf16 v[132:135], a[196:199], a[52:55], v[132:135]
  v_mfma_f32_16x16x32_bf16 v[196:199], a[196:199], a[56:59], v[196:199]
  ds_read_b64_tr_b16 a[224:225], v41 offset:256
  ds_read_b64_tr_b16 a[226:227], v41 offset:2304
  s_waitcnt lgkmcnt(12)
  v_mfma_f32_16x16x32_bf16 v[72:75], a[200:203], a[48:51], v[72:75]
  v_mfma_f32_16x16x32_bf16 v[136:139], a[200:203], a[52:55], v[136:139]
  s_mov_b32 s42, 2621440
  v_mfma_f32_16x16x32_bf16 v[200:203], a[200:203], a[56:59], v[200:203]
  ds_read_b64_tr_b16 a[228:229], v41 offset:264
  ds_read_b64_tr_b16 a[230:231], v41 offset:2312
  s_waitcnt lgkmcnt(12)
  v_mfma_f32_16x16x32_bf16 v[76:79], a[204:207], a[48:51], v[76:79]
  v_mfma_f32_16x16x32_bf16 v[140:143], a[204:207], a[52:55], v[140:143]
  v_mfma_f32_16x16x32_bf16 v[204:207], a[204:207], a[56:59], v[204:207]
  ds_read_b64_tr_b16 a[232:233], v43 offset:256
  ds_read_b64_tr_b16 a[234:235], v43 offset:2304
  s_waitcnt lgkmcnt(12)
  v_mfma_f32_16x16x32_bf16 v[80:83], a[208:211], a[48:51], v[80:83]
  v_mfma_f32_16x16x32_bf16 v[144:147], a[208:211], a[52:55], v[144:147]
  v_mfma_f32_16x16x32_bf16 v[208:211], a[208:211], a[56:59], v[208:211]
  ds_read_b64_tr_b16 a[236:237], v43 offset:264
  ds_read_b64_tr_b16 a[238:239], v43 offset:2312
  s_waitcnt lgkmcnt(12)
  v_mfma_f32_16x16x32_bf16 v[84:87], a[212:215], a[48:51], v[84:87]
  v_mfma_f32_16x16x32_bf16 v[148:151], a[212:215], a[52:55], v[148:151]
  v_mfma_f32_16x16x32_bf16 v[212:215], a[212:215], a[56:59], v[212:215]
  s_add_u32 m0, s29, 32768
  s_nop 0
  buffer_load_dwordx4 v16, s[16:19], s42 offen lds
  ds_read_b64_tr_b16 a[240:241], v45 offset:256
  ds_read_b64_tr_b16 a[242:243], v45 offset:2304
  s_waitcnt lgkmcnt(12)
  v_mfma_f32_16x16x32_bf16 v[88:91], a[216:219], a[48:51], v[88:91]
  v_mfma_f32_16x16x32_bf16 v[152:155], a[216:219], a[52:55], v[152:155]
  v_mfma_f32_16x16x32_bf16 v[216:219], a[216:219], a[56:59], v[216:219]
  ds_read_b64_tr_b16 a[244:245], v45 offset:264
  ds_read_b64_tr_b16 a[246:247], v45 offset:2312
  s_waitcnt lgkmcnt(12)
  v_mfma_f32_16x16x32_bf16 v[92:95], a[220:223], a[48:51], v[92:95]
  v_mfma_f32_16x16x32_bf16 v[156:159], a[220:223], a[52:55], v[156:159]
  v_mfma_f32_16x16x32_bf16 v[220:223], a[220:223], a[56:59], v[220:223]
  ds_read_b64_tr_b16 a[248:249], v47 offset:256
  ds_read_b64_tr_b16 a[250:251], v47 offset:2304
  s_waitcnt lgkmcnt(12)
  v_mfma_f32_16x16x32_bf16 v[96:99], a[224:227], a[48:51], v[96:99]
  v_mfma_f32_16x16x32_bf16 v[160:163], a[224:227], a[52:55], v[160:163]
  v_mfma_f32_16x16x32_bf16 v[224:227], a[224:227], a[56:59], v[224:227]
  ds_read_b64_tr_b16 a[252:253], v47 offset:264
  ds_read_b64_tr_b16 a[254:255], v47 offset:2312
  s_waitcnt lgkmcnt(12)
  v_mfma_f32_16x16x32_bf16 v[100:103], a[228:231], a[48:51], v[100:103]
  s_add_u32 m0, s29, 33792
  s_nop 0
  buffer_load_dwordx4 v17, s[16:19], s42 offen lds
  v_mfma_f32_16x16x32_bf16 v[164:167], a[228:231], a[52:55], v[164:167]
  v_mfma_f32_16x16x32_bf16 v[228:231], a[228:231], a[56:59], v[228:231]
  ds_read_b64_tr_b16 a[192:193], v41 offset:16384
  ds_read_b64_tr_b16 a[194:195], v41 offset:18432
  s_waitcnt lgkmcnt(12)
  v_mfma_f32_16x16x32_bf16 v[104:107], a[232:235], a[48:51], v[104:107]
  v_mfma_f32_16x16x32_bf16 v[168:171], a[232:235], a[52:55], v[168:171]
  v_mfma_f32_16x16x32_bf16 v[232:235], a[232:235], a[56:59], v[232:235]
  ds_read_b64_tr_b16 a[196:197], v41 offset:16392
  ds_read_b64_tr_b16 a[198:199], v41 offset:18440
  s_waitcnt lgkmcnt(12)
  v_mfma_f32_16x16x32_bf16 v[108:111], a[236:239], a[48:51], v[108:111]
  v_mfma_f32_16x16x32_bf16 v[172:175], a[236:239], a[52:55], v[172:175]
  v_mfma_f32_16x16x32_bf16 v[236:239], a[236:239], a[56:59], v[236:239]
  ds_read_b64_tr_b16 a[200:201], v43 offset:16384
  ds_read_b64_tr_b16 a[202:203], v43 offset:18432
  s_waitcnt lgkmcnt(12)
  v_mfma_f32_16x16x32_bf16 v[112:115], a[240:243], a[48:51], v[112:115]
  v_mfma_f32_16x16x32_bf16 v[176:179], a[240:243], a[52:55], v[176:179]
  s_add_u32 m0, s29, 34816
  s_nop 0
  buffer_load_dwordx4 v18, s[16:19], s42 offen lds
  v_mfma_f32_16x16x32_bf16 v[240:243], a[240:243], a[56:59], v[240:243]
  ds_read_b64_tr_b16 a[204:205], v43 offset:16392
  ds_read_b64_tr_b16 a[206:207], v43 offset:18440
  s_waitcnt lgkmcnt(12)
  v_mfma_f32_16x16x32_bf16 v[116:119], a[244:247], a[48:51], v[116:119]
  v_mfma_f32_16x16x32_bf16 v[180:183], a[244:247], a[52:55], v[180:183]
  v_mfma_f32_16x16x32_bf16 v[244:247], a[244:247], a[56:59], v[244:247]
  ds_read_b64_tr_b16 a[208:209], v45 offset:16384
  ds_read_b64_tr_b16 a[210:211], v45 offset:18432
  s_waitcnt lgkmcnt(12)
  v_mfma_f32_16x16x32_bf16 v[120:123], a[248:251], a[48:51], v[120:123]
  v_mfma_f32_16x16x32_bf16 v[184:187], a[248:251], a[52:55], v[184:187]
  v_mfma_f32_16x16x32_bf16 v[248:251], a[248:251], a[56:59], v[248:251]
  ds_read_b64_tr_b16 a[212:213], v45 offset:16392
  ds_read_b64_tr_b16 a[214:215], v45 offset:18440
  s_waitcnt lgkmcnt(12)
  v_mfma_f32_16x16x32_bf16 v[124:127], a[252:255], a[48:51], v[124:127]
  v_mfma_f32_16x16x32_bf16 v[188:191], a[252:255], a[52:55], v[188:191]
  v_mfma_f32_16x16x32_bf16 v[252:255], a[252:255], a[56:59], v[252:255]
  s_add_u32 m0, s29, 35840
  s_nop 0
  buffer_load_dwordx4 v19, s[16:19], s42 offen lds
  ds_read_b64_tr_b16 a[216:217], v47 offset:16384
  ds_read_b64_tr_b16 a[218:219], v47 offset:18432
  s_waitcnt lgkmcnt(12)
  v_mfma_f32_16x16x32_bf16 v[64:67], a[192:195], a[60:63], v[64:67]
  v_mfma_f32_16x16x32_bf16 v[128:131], a[192:195], a[64:67], v[128:131]
  v_mfma_f32_16x16x32_bf16 v[192:195], a[192:195], a[68:71], v[192:195]
  ds_read_b64_tr_b16 a[220:221], v47 offset:16392
  ds_read_b64_tr_b16 a[222:223], v47 offset:18440
  s_waitcnt lgkmcnt(12)
  v_mfma_f32_16x16x32_bf16 v[68:71], a[196:199], a[60:63], v[68:71]
  v_mfma_f32_16x16x32_bf16 v[132:135], a[196:199], a[64:67], v[132:135]
  v_mfma_f32_16x16x32_bf16 v[196:199], a[196:199], a[68:71], v[196:199]
  ds_read_b64_tr_b16 a[224:225], v41 offset:16640
  ds_read_b64_tr_b16 a[226:227], v41 offset:18688
  s_waitcnt lgkmcnt(12)
  v_mfma_f32_16x16x32_bf16 v[72:75], a[200:203], a[60:63], v[72:75]
  v_mfma_f32_16x16x32_bf16 v[136:139], a[200:203], a[64:67], v[136:139]
  v_mfma_f32_16x16x32_bf16 v[200:203], a[200:203], a[68:71], v[200:203]
  ds_read_b64_tr_b16 a[228:229], v41 offset:16648
  ds_read_b64_tr_b16 a[230:231], v41 offset:18696
  s_waitcnt lgkmcnt(12)
  v_mfma_f32_16x16x32_bf16 v[76:79], a[204:207], a[60:63], v[76:79]
  s_add_u32 m0, s29, 36864
  s_nop 0
  buffer_load_dwordx4 v20, s[16:19], s42 offen lds
  v_mfma_f32_16x16x32_bf16 v[140:143], a[204:207], a[64:67], v[140:143]
  v_mfma_f32_16x16x32_bf16 v[204:207], a[204:207], a[68:71], v[204:207]
  ds_read_b64_tr_b16 a[232:233], v43 offset:16640
  ds_read_b64_tr_b16 a[234:235], v43 offset:18688
  s_waitcnt lgkmcnt(12)
  v_mfma_f32_16x16x32_bf16 v[80:83], a[208:211], a[60:63], v[80:83]
  v_mfma_f32_16x16x32_bf16 v[144:147], a[208:211], a[64:67], v[144:147]
  v_mfma_f32_16x16x32_bf16 v[208:211], a[208:211], a[68:71], v[208:211]
  ds_read_b64_tr_b16 a[236:237], v43 offset:16648
  ds_read_b64_tr_b16 a[238:239], v43 offset:18696
  s_waitcnt lgkmcnt(12)
  v_mfma_f32_16x16x32_bf16 v[84:87], a[212:215], a[60:63], v[84:87]
  v_mfma_f32_16x16x32_bf16 v[148:151], a[212:215], a[64:67], v[148:151]
  v_mfma_f32_16x16x32_bf16 v[212:215], a[212:215], a[68:71], v[212:215]
  ds_read_b64_tr_b16 a[240:241], v45 offset:16640
  ds_read_b64_tr_b16 a[242:243], v45 offset:18688
  s_waitcnt lgkmcnt(12)
  v_mfma_f32_16x16x32_bf16 v[88:91], a[216:219], a[60:63], v[88:91]
  v_mfma_f32_16x16x32_bf16 v[152:155], a[216:219], a[64:67], v[152:155]
  s_add_u32 m0, s29, 37888
  s_nop 0
  buffer_load_dwordx4 v21, s[16:19], s42 offen lds
  v_mfma_f32_16x16x32_bf16 v[216:219], a[216:219], a[68:71], v[216:219]
  ds_read_b64_tr_b16 a[244:245], v45 offset:16648
  ds_read_b64_tr_b16 a[246:247], v45 offset:18696
  s_waitcnt lgkmcnt(12)
  v_mfma_f32_16x16x32_bf16 v[92:95], a[220:223], a[60:63], v[92:95]
  v_mfma_f32_16x16x32_bf16 v[156:159], a[220:223], a[64:67], v[156:159]
  v_mfma_f32_16x16x32_bf16 v[220:223], a[220:223], a[68:71], v[220:223]
  ds_read_b64_tr_b16 a[248:249], v47 offset:16640
  ds_read_b64_tr_b16 a[250:251], v47 offset:18688
  s_waitcnt lgkmcnt(12)
  v_mfma_f32_16x16x32_bf16 v[96:99], a[224:227], a[60:63], v[96:99]
  v_mfma_f32_16x16x32_bf16 v[160:163], a[224:227], a[64:67], v[160:163]
  v_mfma_f32_16x16x32_bf16 v[224:227], a[224:227], a[68:71], v[224:227]
  ds_read_b64_tr_b16 a[252:253], v47 offset:16648
  ds_read_b64_tr_b16 a[254:255], v47 offset:18696
  s_waitcnt lgkmcnt(12)
  v_mfma_f32_16x16x32_bf16 v[100:103], a[228:231], a[60:63], v[100:103]
  v_mfma_f32_16x16x32_bf16 v[164:167], a[228:231], a[64:67], v[164:167]
  v_mfma_f32_16x16x32_bf16 v[228:231], a[228:231], a[68:71], v[228:231]
  s_add_u32 m0, s29, 38912
  s_nop 0
  buffer_load_dwordx4 v22, s[16:19], s42 offen lds
  s_waitcnt lgkmcnt(10)
  v_mfma_f32_16x16x32_bf16 v[104:107], a[232:235], a[60:63], v[104:107]
  v_mfma_f32_16x16x32_bf16 v[168:171], a[232:235], a[64:67], v[168:171]
  v_mfma_f32_16x16x32_bf16 v[232:235], a[232:235], a[68:71], v[232:235]
  s_waitcnt lgkmcnt(8)
  v_mfma_f32_16x16x32_bf16 v[108:111], a[236:239], a[60:63], v[108:111]
  v_mfma_f32_16x16x32_bf16 v[172:175], a[236:239], a[64:67], v[172:175]
  v_mfma_f32_16x16x32_bf16 v[236:239], a[236:239], a[68:71], v[236:239]
  s_waitcnt lgkmcnt(6)
  v_mfma_f32_16x16x32_bf16 v[112:115], a[240:243], a[60:63], v[112:115]
  v_mfma_f32_16x16x32_bf16 v[176:179], a[240:243], a[64:67], v[176:179]
  v_mfma_f32_16x16x32_bf16 v[240:243], a[240:243], a[68:71], v[240:243]
  s_waitcnt lgkmcnt(4)
  v_mfma_f32_16x16x32_bf16 v[116:119], a[244:247], a[60:63], v[116:119]
  s_add_u32 m0, s29, 39936
  s_nop 0
  buffer_load_dwordx4 v23, s[16:19], s42 offen lds
  v_mfma_f32_16x16x32_bf16 v[180:183], a[244:247], a[64:67], v[180:183]
  v_mfma_f32_16x16x32_bf16 v[244:247], a[244:247], a[68:71], v[244:247]
  s_waitcnt lgkmcnt(2)
  v_mfma_f32_16x16x32_bf16 v[120:123], a[248:251], a[60:63], v[120:123]
  v_mfma_f32_16x16x32_bf16 v[184:187], a[248:251], a[64:67], v[184:187]
  v_mfma_f32_16x16x32_bf16 v[248:251], a[248:251], a[68:71], v[248:251]
  s_waitcnt lgkmcnt(0)
  v_mfma_f32_16x16x32_bf16 v[124:127], a[252:255], a[60:63], v[124:127]
  v_mfma_f32_16x16x32_bf16 v[188:191], a[252:255], a[64:67], v[188:191]
  v_mfma_f32_16x16x32_bf16 v[252:255], a[252:255], a[68:71], v[252:255]
  s_waitcnt vmcnt(16)
  s_barrier
  ds_read_b64_tr_b16 a[192:193], v41 offset:32768
  ds_read_b64_tr_b16 a[194:195], v41 offset:34816
  ds_read_b64_tr_b16 a[196:197], v41 offset:32776
  ds_read_b64_tr_b16 a[198:199], v41 offset:34824
  ds_read_b64_tr_b16 a[200:201], v43 offset:32768
  ds_read_b64_tr_b16 a[202:203], v43 offset:34816
  ds_read_b64_tr_b16 a[204:205], v43 offset:32776
  ds_read_b64_tr_b16 a[206:207], v43 offset:34824
  ds_read_b64_tr_b16 a[208:209], v45 offset:32768
  ds_read_b64_tr_b16 a[210:211], v45 offset:34816
  ds_read_b64_tr_b16 a[212:213], v45 offset:32776
  ds_read_b64_tr_b16 a[214:215], v45 offset:34824
  ds_read_b64_tr_b16 a[216:217], v47 offset:32768
  ds_read_b64_tr_b16 a[218:219], v47 offset:34816
  s_waitcnt lgkmcnt(12)
  v_mfma_f32_16x16x32_bf16 v[64:67], a[192:195], a[72:75], v[64:67]
  v_mfma_f32_16x16x32_bf16 v[128:131], a[192:195], a[76:79], v[128:131]
  s_mov_b32 s31, 3145728
  v_mfma_f32_16x16x32_bf16 v[192:195], a[192:195], a[80:83], v[192:195]
  ds_read_b64_tr_b16 a[220:221], v47 offset:32776
  ds_read_b64_tr_b16 a[222:223], v47 offset:34824
  s_waitcnt lgkmcnt(12)
  v_mfma_f32_16x16x32_bf16 v[68:71], a[196:199], a[72:75], v[68:71]
  v_mfma_f32_16x16x32_bf16 v[132:135], a[196:199], a[76:79], v[132:135]
  v_mfma_f32_16x16x32_bf16 v[196:199], a[196:199], a[80:83], v[196:199]
  ds_read_b64_tr_b16 a[224:225], v41 offset:33024
  ds_read_b64_tr_b16 a[226:227], v41 offset:35072
  s_waitcnt lgkmcnt(12)
  v_mfma_f32_16x16x32_bf16 v[72:75], a[200:203], a[72:75], v[72:75]
  v_mfma_f32_16x16x32_bf16 v[136:139], a[200:203], a[76:79], v[136:139]
  v_mfma_f32_16x16x32_bf16 v[200:203], a[200:203], a[80:83], v[200:203]
  ds_read_b64_tr_b16 a[228:229], v41 offset:33032
  ds_read_b64_tr_b16 a[230:231], v41 offset:35080
  s_waitcnt lgkmcnt(12)
  v_mfma_f32_16x16x32_bf16 v[76:79], a[204:207], a[72:75], v[76:79]
  v_mfma_f32_16x16x32_bf16 v[140:143], a[204:207], a[76:79], v[140:143]
  v_mfma_f32_16x16x32_bf16 v[204:207], a[204:207], a[80:83], v[204:207]
  s_add_u32 m0, s29, 65536
  s_nop 0
  buffer_load_dwordx4 v16, s[16:19], s31 offen lds
  ds_read_b64_tr_b16 a[232:233], v43 offset:33024
  ds_read_b64_tr_b16 a[234:235], v43 offset:35072
  s_waitcnt lgkmcnt(12)
  v_mfma_f32_16x16x32_bf16 v[80:83], a[208:211], a[72:75], v[80:83]
  v_mfma_f32_16x16x32_bf16 v[144:147], a[208:211], a[76:79], v[144:147]
  v_mfma_f32_16x16x32_bf16 v[208:211], a[208:211], a[80:83], v[208:211]
  ds_read_b64_tr_b16 a[236:237], v43 offset:33032
  ds_read_b64_tr_b16 a[238:239], v43 offset:35080
  s_waitcnt lgkmcnt(12)
  v_mfma_f32_16x16x32_bf16 v[84:87], a[212:215], a[72:75], v[84:87]
  v_mfma_f32_16x16x32_bf16 v[148:151], a[212:215], a[76:79], v[148:151]
  v_mfma_f32_16x16x32_bf16 v[212:215], a[212:215], a[80:83], v[212:215]
  ds_read_b64_tr_b16 a[240:241], v45 offset:33024
  ds_read_b64_tr_b16 a[242:243], v45 offset:35072
  s_waitcnt lgkmcnt(12)
  v_mfma_f32_16x16x32_bf16 v[88:91], a[216:219], a[72:75], v[88:91]
  v_mfma_f32_16x16x32_bf16 v[152:155], a[216:219], a[76:79], v[152:155]
  v_mfma_f32_16x16x32_bf16 v[216:219], a[216:219], a[80:83], v[216:219]
  ds_read_b64_tr_b16 a[244:245], v45 offset:33032
  ds_read_b64_tr_b16 a[246:247], v45 offset:35080
  s_waitcnt lgkmcnt(12)
  v_mfma_f32_16x16x32_bf16 v[92:95], a[220:223], a[72:75], v[92:95]
  s_add_u32 m0, s29, 66560
  s_nop 0
  buffer_load_dwordx4 v17, s[16:19], s31 offen lds
  v_mfma_f32_16x16x32_bf16 v[156:159], a[220:223], a[76:79], v[156:159]
  v_mfma_f32_16x16x32_bf16 v[220:223], a[220:223], a[80:83], v[220:223]
  ds_read_b64_tr_b16 a[248:249], v47 offset:33024
  ds_read_b64_tr_b16 a[250:251], v47 offset:35072
  s_waitcnt lgkmcnt(12)
  v_mfma_f32_16x16x32_bf16 v[96:99], a[224:227], a[72:75], v[96:99]
  v_mfma_f32_16x16x32_bf16 v[160:163], a[224:227], a[76:79], v[160:163]
  v_mfma_f32_16x16x32_bf16 v[224:227], a[224:227], a[80:83], v[224:227]
  ds_read_b64_tr_b16 a[252:253], v47 offset:33032
  ds_read_b64_tr_b16 a[254:255], v47 offset:35080
  s_waitcnt lgkmcnt(12)
  v_mfma_f32_16x16x32_bf16 v[100:103], a[228:231], a[72:75], v[100:103]
  v_mfma_f32_16x16x32_bf16 v[164:167], a[228:231], a[76:79], v[164:167]
  v_mfma_f32_16x16x32_bf16 v[228:231], a[228:231], a[80:83], v[228:231]
  ds_read_b64_tr_b16 a[192:193], v41 offset:49152
  ds_read_b64_tr_b16 a[194:195], v41 offset:51200
  s_waitcnt lgkmcnt(12)
  v_mfma_f32_16x16x32_bf16 v[104:107], a[232:235], a[72:75], v[104:107]
  v_mfma_f32_16x16x32_bf16 v[168:171], a[232:235], a[76:79], v[168:171]
  s_add_u32 m0, s29, 67584
  s_nop 0
  buffer_load_dwordx4 v18, s[16:19], s31 offen lds
  v_mfma_f32_16x16x32_bf16 v[232:235], a[232:235], a[80:83], v[232:235]
  ds_read_b64_tr_b16 a[196:197], v41 offset:49160
  ds_read_b64_tr_b16 a[198:199], v41 offset:51208
  s_waitcnt lgkmcnt(12)
  v_mfma_f32_16x16x32_bf16 v[108:111], a[236:239], a[72:75], v[108:111]
  v_mfma_f32_16x16x32_bf16 v[172:175], a[236:239], a[76:79], v[172:175]
  v_mfma_f32_16x16x32_bf16 v[236:239], a[236:239], a[80:83], v[236:239]
  ds_read_b64_tr_b16 a[200:201], v43 offset:49152
  ds_read_b64_tr_b16 a[202:203], v43 offset:51200
  s_waitcnt lgkmcnt(12)
  v_mfma_f32_16x16x32_bf16 v[112:115], a[240:243], a[72:75], v[112:115]
  v_mfma_f32_16x16x32_bf16 v[176:179], a[240:243], a[76:79], v[176:179]
  v_mfma_f32_16x16x32_bf16 v[240:243], a[240:243], a[80:83], v[240:243]
  ds_read_b64_tr_b16 a[204:205], v43 offset:49160
  ds_read_b64_tr_b16 a[206:207], v43 offset:51208
  s_waitcnt lgkmcnt(12)
  v_mfma_f32_16x16x32_bf16 v[116:119], a[244:247], a[72:75], v[116:119]
  v_mfma_f32_16x16x32_bf16 v[180:183], a[244:247], a[76:79], v[180:183]
  v_mfma_f32_16x16x32_bf16 v[244:247], a[244:247], a[80:83], v[244:247]
  s_add_u32 m0, s29, 68608
  s_nop 0
  buffer_load_dwordx4 v19, s[16:19], s31 offen lds
  ds_read_b64_tr_b16 a[208:209], v45 offset:49152
  ds_read_b64_tr_b16 a[210:211], v45 offset:51200
  s_waitcnt lgkmcnt(12)
  v_mfma_f32_16x16x32_bf16 v[120:123], a[248:251], a[72:75], v[120:123]
  v_mfma_f32_16x16x32_bf16 v[184:187], a[248:251], a[76:79], v[184:187]
  v_mfma_f32_16x16x32_bf16 v[248:251], a[248:251], a[80:83], v[248:251]
  ds_read_b64_tr_b16 a[212:213], v45 offset:49160
  ds_read_b64_tr_b16 a[214:215], v45 offset:51208
  s_waitcnt lgkmcnt(12)
  v_mfma_f32_16x16x32_bf16 v[124:127], a[252:255], a[72:75], v[124:127]
  v_mfma_f32_16x16x32_bf16 v[188:191], a[252:255], a[76:79], v[188:191]
  v_mfma_f32_16x16x32_bf16 v[252:255], a[252:255], a[80:83], v[252:255]
  ds_read_b64_tr_b16 a[216:217], v47 offset:49152
  ds_read_b64_tr_b16 a[218:219], v47 offset:51200
  s_waitcnt lgkmcnt(12)
  v_mfma_f32_16x16x32_bf16 v[64:67], a[192:195], a[84:87], v[64:67]
  v_mfma_f32_16x16x32_bf16 v[128:131], a[192:195], a[88:91], v[128:131]
  v_mfma_f32_16x16x32_bf16 v[192:195], a[192:195], a[92:95], v[192:195]
  ds_read_b64_tr_b16 a[220:221], v47 offset:49160
  ds_read_b64_tr_b16 a[222:223], v47 offset:51208
  s_waitcnt lgkmcnt(12)
  v_mfma_f32_16x16x32_bf16 v[68:71], a[196:199], a[84:87], v[68:71]
  s_add_u32 m0, s29, 69632
  s_nop 0
  buffer_load_dwordx4 v20, s[16:19], s31 offen lds
  v_mfma_f32_16x16x32_bf16 v[132:135], a[196:199], a[88:91], v[132:135]
  v_mfma_f32_16x16x32_bf16 v[196:199], a[196:199], a[92:95], v[196:199]
  ds_read_b64_tr_b16 a[224:225], v41 offset:49408
  ds_read_b64_tr_b16 a[226:227], v41 offset:51456
  s_waitcnt lgkmcnt(12)
  v_mfma_f32_16x16x32_bf16 v[72:75], a[200:203], a[84:87], v[72:75]
  v_mfma_f32_16x16x32_bf16 v[136:139], a[200:203], a[88:91], v[136:139]
  v_mfma_f32_16x16x32_bf16 v[200:203], a[200:203], a[92:95], v[200:203]
  ds_read_b64_tr_b16 a[228:229], v41 offset:49416
  ds_read_b64_tr_b16 a[230:231], v41 offset:51464
  s_waitcnt lgkmcnt(12)
  v_mfma_f32_16x16x32_bf16 v[76:79], a[204:207], a[84:87], v[76:79]
  v_mfma_f32_16x16x32_bf16 v[140:143], a[204:207], a[88:91], v[140:143]
  v_mfma_f32_16x16x32_bf16 v[204:207], a[204:207], a[92:95], v[204:207]
  ds_read_b64_tr_b16 a[232:233], v43 offset:49408
  ds_read_b64_tr_b16 a[234:235], v43 offset:51456
  s_waitcnt lgkmcnt(12)
  v_mfma_f32_16x16x32_bf16 v[80:83], a[208:211], a[84:87], v[80:83]
  v_mfma_f32_16x16x32_bf16 v[144:147], a[208:211], a[88:91], v[144:147]
  s_add_u32 m0, s29, 70656
  s_nop 0
  buffer_load_dwordx4 v21, s[16:19], s31 offen lds
  v_mfma_f32_16x16x32_bf16 v[208:211], a[208:211], a[92:95], v[208:211]
  ds_read_b64_tr_b16 a[236:237], v43 offset:49416
  ds_read_b64_tr_b16 a[238:239], v43 offset:51464
  s_waitcnt lgkmcnt(12)
  v_mfma_f32_16x16x32_bf16 v[84:87], a[212:215], a[84:87], v[84:87]
  v_mfma_f32_16x16x32_bf16 v[148:151], a[212:215], a[88:91], v[148:151]
  v_mfma_f32_16x16x32_bf16 v[212:215], a[212:215], a[92:95], v[212:215]
  ds_read_b64_tr_b16 a[240:241], v45 offset:49408
  ds_read_b64_tr_b16 a[242:243], v45 offset:51456
  s_waitcnt lgkmcnt(12)
  v_mfma_f32_16x16x32_bf16 v[88:91], a[216:219], a[84:87], v[88:91]
  v_mfma_f32_16x16x32_bf16 v[152:155], a[216:219], a[88:91], v[152:155]
  v_mfma_f32_16x16x32_bf16 v[216:219], a[216:219], a[92:95], v[216:219]
  ds_read_b64_tr_b16 a[244:245], v45 offset:49416
  ds_read_b64_tr_b16 a[246:247], v45 offset:51464
  s_waitcnt lgkmcnt(12)
  v_mfma_f32_16x16x32_bf16 v[92:95], a[220:223], a[84:87], v[92:95]
  v_mfma_f32_16x16x32_bf16 v[156:159], a[220:223], a[88:91], v[156:159]
  v_mfma_f32_16x16x32_bf16 v[220:223], a[220:223], a[92:95], v[220:223]
  s_add_u32 m0, s29, 71680
  s_nop 0
  buffer_load_dwordx4 v22, s[16:19], s31 offen lds
  ds_read_b64_tr_b16 a[248:249], v47 offset:49408
  ds_read_b64_tr_b16 a[250:251], v47 offset:51456
  s_waitcnt lgkmcnt(12)
  v_mfma_f32_16x16x32_bf16 v[96:99], a[224:227], a[84:87], v[96:99]
  v_mfma_f32_16x16x32_bf16 v[160:163], a[224:227], a[88:91], v[160:163]
  v_mfma_f32_16x16x32_bf16 v[224:227], a[224:227], a[92:95], v[224:227]
  ds_read_b64_tr_b16 a[252:253], v47 offset:49416
  ds_read_b64_tr_b16 a[254:255], v47 offset:51464
  s_waitcnt lgkmcnt(12)
  v_mfma_f32_16x16x32_bf16 v[100:103], a[228:231], a[84:87], v[100:103]
  v_mfma_f32_16x16x32_bf16 v[164:167], a[228:231], a[88:91], v[164:167]
  v_mfma_f32_16x16x32_bf16 v[228:231], a[228:231], a[92:95], v[228:231]
  s_waitcnt lgkmcnt(10)
  v_mfma_f32_16x16x32_bf16 v[104:107], a[232:235], a[84:87], v[104:107]
  v_mfma_f32_16x16x32_bf16 v[168:171], a[232:235], a[88:91], v[168:171]
  v_mfma_f32_16x16x32_bf16 v[232:235], a[232:235], a[92:95], v[232:235]
  s_waitcnt lgkmcnt(8)
  v_mfma_f32_16x16x32_bf16 v[108:111], a[236:239], a[84:87], v[108:111]
  s_add_u32 m0, s29, 72704
  s_nop 0
  buffer_load_dwordx4 v23, s[16:19], s31 offen lds
  v_mfma_f32_16x16x32_bf16 v[172:175], a[236:239], a[88:91], v[172:175]
  v_mfma_f32_16x16x32_bf16 v[236:239], a[236:239], a[92:95], v[236:239]
  s_waitcnt lgkmcnt(6)
  v_mfma_f32_16x16x32_bf16 v[112:115], a[240:243], a[84:87], v[112:115]
  v_mfma_f32_16x16x32_bf16 v[176:179], a[240:243], a[88:91], v[176:179]
  v_mfma_f32_16x16x32_bf16 v[240:243], a[240:243], a[92:95], v[240:243]
  s_waitcnt lgkmcnt(4)
  v_mfma_f32_16x16x32_bf16 v[116:119], a[244:247], a[84:87], v[116:119]
  v_mfma_f32_16x16x32_bf16 v[180:183], a[244:247], a[88:91], v[180:183]
  v_mfma_f32_16x16x32_bf16 v[244:247], a[244:247], a[92:95], v[244:247]
  s_waitcnt lgkmcnt(2)
  v_mfma_f32_16x16x32_bf16 v[120:123], a[248:251], a[84:87], v[120:123]
  v_mfma_f32_16x16x32_bf16 v[184:187], a[248:251], a[88:91], v[184:187]
  v_mfma_f32_16x16x32_bf16 v[248:251], a[248:251], a[92:95], v[248:251]
  s_waitcnt lgkmcnt(0)
  v_mfma_f32_16x16x32_bf16 v[124:127], a[252:255], a[84:87], v[124:127]
  v_mfma_f32_16x16x32_bf16 v[188:191], a[252:255], a[88:91], v[188:191]
  v_mfma_f32_16x16x32_bf16 v[252:255], a[252:255], a[92:95], v[252:255]
  s_waitcnt vmcnt(16)
  s_barrier
  ds_read_b64_tr_b16 a[192:193], v40 offset:0
  ds_read_b64_tr_b16 a[194:195], v40 offset:2048
  ds_read_b64_tr_b16 a[196:197], v40 offset:8
  ds_read_b64_tr_b16 a[198:199], v40 offset:2056
  ds_read_b64_tr_b16 a[200:201], v42 offset:0
  ds_read_b64_tr_b16 a[202:203], v42 offset:2048
  ds_read_b64_tr_b16 a[204:205], v42 offset:8
  ds_read_b64_tr_b16 a[206:207], v42 offset:2056
  ds_read_b64_tr_b16 a[208:209], v44 offset:0
  ds_read_b64_tr_b16 a[210:211], v44 offset:2048
  ds_read_b64_tr_b16 a[212:213], v44 offset:8
  ds_read_b64_tr_b16 a[214:215], v44 offset:2056
  ds_read_b64_tr_b16 a[216:217], v46 offset:0
  ds_read_b64_tr_b16 a[218:219], v46 offset:2048
  s_waitcnt lgkmcnt(12)
  v_mfma_f32_16x16x32_bf16 v[64:67], a[192:195], a[96:99], v[64:67]
  v_mfma_f32_16x16x32_bf16 v[128:131], a[192:195], a[100:103], v[128:131]
  v_mfma_f32_16x16x32_bf16 v[192:195], a[192:195], a[104:107], v[192:195]
  ds_read_b64_tr_b16 a[220:221], v46 offset:8
  ds_read_b64_tr_b16 a[222:223], v46 offset:2056
  s_waitcnt lgkmcnt(12)
  v_mfma_f32_16x16x32_bf16 v[68:71], a[196:199], a[96:99], v[68:71]
  v_mfma_f32_16x16x32_bf16 v[132:135], a[196:199], a[100:103], v[132:135]
  v_mfma_f32_16x16x32_bf16 v[196:199], a[196:199], a[104:107], v[196:199]
  v_xor_b32 v12, 0, v24
  v_lshl_add_u32 v12, v12, 4, v27
  v_add_u32 v16, 0, v12
  v_xor_b32 v12, 2, v24
  v_lshl_add_u32 v12, v12, 4, v27
  v_add_u32 v17, 1024, v12
  v_xor_b32 v12, 4, v24
  v_lshl_add_u32 v12, v12, 4, v27
  v_add_u32 v18, 2048, v12
  v_xor_b32 v12, 6, v24
  v_lshl_add_u32 v12, v12, 4, v27
  v_add_u32 v19, 3072, v12
  v_xor_b32 v12, 8, v24
  v_lshl_add_u32 v12, v12, 4, v27
  v_add_u32 v20, 4096, v12
  v_xor_b32 v12, 10, v24
  v_lshl_add_u32 v12, v12, 4, v27
  v_add_u32 v21, 5120, v12
  v_xor_b32 v12, 12, v24
  v_lshl_add_u32 v12, v12, 4, v27
  v_add_u32 v22, 6144, v12
  v_xor_b32 v12, 14, v24
  v_lshl_add_u32 v12, v12, 4, v27
  v_add_u32 v23, 7168, v12
  s_add_u32 s42, s43, 0
  s_and_b32 s42, s42, 7
  s_lshl_b32 s42, s42, 15
  ds_read_b64_tr_b16 a[224:225], v40 offset:256
  ds_read_b64_tr_b16 a[226:227], v40 offset:2304
  s_waitcnt lgkmcnt(12)
  v_mfma_f32_16x16x32_bf16 v[72:75], a[200:203], a[96:99], v[72:75]
  v_mfma_f32_16x16x32_bf16 v[136:139], a[200:203], a[100:103], v[136:139]
  v_mfma_f32_16x16x32_bf16 v[200:203], a[200:203], a[104:107], v[200:203]
  ds_read_b64_tr_b16 a[228:229], v40 offset:264
  ds_read_b64_tr_b16 a[230:231], v40 offset:2312
  s_waitcnt lgkmcnt(12)
  v_mfma_f32_16x16x32_bf16 v[76:79], a[204:207], a[96:99], v[76:79]
  v_mfma_f32_16x16x32_bf16 v[140:143], a[204:207], a[100:103], v[140:143]
  v_mfma_f32_16x16x32_bf16 v[204:207], a[204:207], a[104:107], v[204:207]
  ds_read_b64_tr_b16 a[232:233], v42 offset:256
  ds_read_b64_tr_b16 a[234:235], v42 offset:2304
  s_waitcnt lgkmcnt(12)
  v_mfma_f32_16x16x32_bf16 v[80:83], a[208:211], a[96:99], v[80:83]
  v_mfma_f32_16x16x32_bf16 v[144:147], a[208:211], a[100:103], v[144:147]
  v_mfma_f32_16x16x32_bf16 v[208:211], a[208:211], a[104:107], v[208:211]
  ds_read_b64_tr_b16 a[236:237], v42 offset:264
  ds_read_b64_tr_b16 a[238:239], v42 offset:2312
  s_waitcnt lgkmcnt(12)
  v_mfma_f32_16x16x32_bf16 v[84:87], a[212:215], a[96:99], v[84:87]
  s_add_u32 m0, s29, 98304
  s_nop 0
  buffer_load_dwordx4 v16, s[8:11], s42 offen nt lds
  v_mfma_f32_16x16x32_bf16 v[148:151], a[212:215], a[100:103], v[148:151]
  v_mfma_f32_16x16x32_bf16 v[212:215], a[212:215], a[104:107], v[212:215]
  ds_read_b64_tr_b16 a[240:241], v44 offset:256
  ds_read_b64_tr_b16 a[242:243], v44 offset:2304
  s_waitcnt lgkmcnt(12)
  v_mfma_f32_16x16x32_bf16 v[88:91], a[216:219], a[96:99], v[88:91]
  v_mfma_f32_16x16x32_bf16 v[152:155], a[216:219], a[100:103], v[152:155]
  v_mfma_f32_16x16x32_bf16 v[216:219], a[216:219], a[104:107], v[216:219]
  ds_read_b64_tr_b16 a[244:245], v44 offset:264
  ds_read_b64_tr_b16 a[246:247], v44 offset:2312
  s_waitcnt lgkmcnt(12)
  v_mfma_f32_16x16x32_bf16 v[92:95], a[220:223], a[96:99], v[92:95]
  v_mfma_f32_16x16x32_bf16 v[156:159], a[220:223], a[100:103], v[156:159]
  v_mfma_f32_16x16x32_bf16 v[220:223], a[220:223], a[104:107], v[220:223]
  ds_read_b64_tr_b16 a[248:249], v46 offset:256
  ds_read_b64_tr_b16 a[250:251], v46 offset:2304
  s_waitcnt lgkmcnt(12)
  v_mfma_f32_16x16x32_bf16 v[96:99], a[224:227], a[96:99], v[96:99]
  v_mfma_f32_16x16x32_bf16 v[160:163], a[224:227], a[100:103], v[160:163]
  s_add_u32 m0, s29, 99328
  s_nop 0
  buffer_load_dwordx4 v17, s[8:11], s42 offen nt lds
  v_mfma_f32_16x16x32_bf16 v[224:227], a[224:227], a[104:107], v[224:227]
  ds_read_b64_tr_b16 a[252:253], v46 offset:264
  ds_read_b64_tr_b16 a[254:255], v46 offset:2312
  s_waitcnt lgkmcnt(12)
  v_mfma_f32_16x16x32_bf16 v[100:103], a[228:231], a[96:99], v[100:103]
  v_mfma_f32_16x16x32_bf16 v[164:167], a[228:231], a[100:103], v[164:167]
  v_mfma_f32_16x16x32_bf16 v[228:231], a[228:231], a[104:107], v[228:231]
  ds_read_b64_tr_b16 a[192:193], v40 offset:16384
  ds_read_b64_tr_b16 a[194:195], v40 offset:18432
  s_waitcnt lgkmcnt(12)
  v_mfma_f32_16x16x32_bf16 v[104:107], a[232:235], a[96:99], v[104:107]
  v_mfma_f32_16x16x32_bf16 v[168:171], a[232:235], a[100:103], v[168:171]
  v_mfma_f32_16x16x32_bf16 v[232:235], a[232:235], a[104:107], v[232:235]
  ds_read_b64_tr_b16 a[196:197], v40 offset:16392
  ds_read_b64_tr_b16 a[198:199], v40 offset:18440
  s_waitcnt lgkmcnt(12)
  v_mfma_f32_16x16x32_bf16 v[108:111], a[236:239], a[96:99], v[108:111]
  v_mfma_f32_16x16x32_bf16 v[172:175], a[236:239], a[100:103], v[172:175]
  v_mfma_f32_16x16x32_bf16 v[236:239], a[236:239], a[104:107], v[236:239]
  s_add_u32 m0, s29, 100352
  s_nop 0
  buffer_load_dwordx4 v18, s[8:11], s42 offen nt lds
  ds_read_b64_tr_b16 a[200:201], v42 offset:16384
  ds_read_b64_tr_b16 a[202:203], v42 offset:18432
  s_waitcnt lgkmcnt(12)
  v_mfma_f32_16x16x32_bf16 v[112:115], a[240:243], a[96:99], v[112:115]
  v_mfma_f32_16x16x32_bf16 v[176:179], a[240:243], a[100:103], v[176:179]
  v_mfma_f32_16x16x32_bf16 v[240:243], a[240:243], a[104:107], v[240:243]
  ds_read_b64_tr_b16 a[204:205], v42 offset:16392
  ds_read_b64_tr_b16 a[206:207], v42 offset:18440
  s_waitcnt lgkmcnt(12)
  v_mfma_f32_16x16x32_bf16 v[116:119], a[244:247], a[96:99], v[116:119]
  v_mfma_f32_16x16x32_bf16 v[180:183], a[244:247], a[100:103], v[180:183]
  v_mfma_f32_16x16x32_bf16 v[244:247], a[244:247], a[104:107], v[244:247]
  ds_read_b64_tr_b16 a[208:209], v44 offset:16384
  ds_read_b64_tr_b16 a[210:211], v44 offset:18432
  s_waitcnt lgkmcnt(12)
  v_mfma_f32_16x16x32_bf16 v[120:123], a[248:251], a[96:99], v[120:123]
  v_mfma_f32_16x16x32_bf16 v[184:187], a[248:251], a[100:103], v[184:187]
  v_mfma_f32_16x16x32_bf16 v[248:251], a[248:251], a[104:107], v[248:251]
  ds_read_b64_tr_b16 a[212:213], v44 offset:16392
  ds_read_b64_tr_b16 a[214:215], v44 offset:18440
  s_waitcnt lgkmcnt(12)
  v_mfma_f32_16x16x32_bf16 v[124:127], a[252:255], a[96:99], v[124:127]
  s_add_u32 m0, s29, 101376
  s_nop 0
  buffer_load_dwordx4 v19, s[8:11], s42 offen nt lds
  v_mfma_f32_16x16x32_bf16 v[188:191], a[252:255], a[100:103], v[188:191]
  v_mfma_f32_16x16x32_bf16 v[252:255], a[252:255], a[104:107], v[252:255]
  ds_read_b64_tr_b16 a[216:217], v46 offset:16384
  ds_read_b64_tr_b16 a[218:219], v46 offset:18432
  s_waitcnt lgkmcnt(12)
  v_mfma_f32_16x16x32_bf16 v[64:67], a[192:195], a[108:111], v[64:67]
  v_mfma_f32_16x16x32_bf16 v[128:131], a[192:195], a[112:115], v[128:131]
  v_mfma_f32_16x16x32_bf16 v[192:195], a[192:195], a[116:119], v[192:195]
  ds_read_b64_tr_b16 a[220:221], v46 offset:16392
  ds_read_b64_tr_b16 a[222:223], v46 offset:18440
  s_waitcnt lgkmcnt(12)
  v_mfma_f32_16x16x32_bf16 v[68:71], a[196:199], a[108:111], v[68:71]
  v_mfma_f32_16x16x32_bf16 v[132:135], a[196:199], a[112:115], v[132:135]
  v_mfma_f32_16x16x32_bf16 v[196:199], a[196:199], a[116:119], v[196:199]
  ds_read_b64_tr_b16 a[224:225], v40 offset:16640
  ds_read_b64_tr_b16 a[226:227], v40 offset:18688
  s_waitcnt lgkmcnt(12)
  v_mfma_f32_16x16x32_bf16 v[72:75], a[200:203], a[108:111], v[72:75]
  v_mfma_f32_16x16x32_bf16 v[136:139], a[200:203], a[112:115], v[136:139]
  s_add_u32 m0, s29, 102400
  s_nop 0
  buffer_load_dwordx4 v20, s[8:11], s42 offen nt lds
  v_mfma_f32_16x16x32_bf16 v[200:203], a[200:203], a[116:119], v[200:203]
  ds_read_b64_tr_b16 a[228:229], v40 offset:16648
  ds_read_b64_tr_b16 a[230:231], v40 offset:18696
  s_waitcnt lgkmcnt(12)
  v_mfma_f32_16x16x32_bf16 v[76:79], a[204:207], a[108:111], v[76:79]
  v_mfma_f32_16x16x32_bf16 v[140:143], a[204:207], a[112:115], v[140:143]
  v_mfma_f32_16x16x32_bf16 v[204:207], a[204:207], a[116:119], v[204:207]
  ds_read_b64_tr_b16 a[232:233], v42 offset:16640
  ds_read_b64_tr_b16 a[234:235], v42 offset:18688
  s_waitcnt lgkmcnt(12)
  v_mfma_f32_16x16x32_bf16 v[80:83], a[208:211], a[108:111], v[80:83]
  v_mfma_f32_16x16x32_bf16 v[144:147], a[208:211], a[112:115], v[144:147]
  v_mfma_f32_16x16x32_bf16 v[208:211], a[208:211], a[116:119], v[208:211]
  ds_read_b64_tr_b16 a[236:237], v42 offset:16648
  ds_read_b64_tr_b16 a[238:239], v42 offset:18696
  s_waitcnt lgkmcnt(12)
  v_mfma_f32_16x16x32_bf16 v[84:87], a[212:215], a[108:111], v[84:87]
  v_mfma_f32_16x16x32_bf16 v[148:151], a[212:215], a[112:115], v[148:151]
  v_mfma_f32_16x16x32_bf16 v[212:215], a[212:215], a[116:119], v[212:215]
  s_add_u32 m0, s29, 103424
  s_nop 0
  buffer_load_dwordx4 v21, s[8:11], s42 offen nt lds
  ds_read_b64_tr_b16 a[240:241], v44 offset:16640
  ds_read_b64_tr_b16 a[242:243], v44 offset:18688
  s_waitcnt lgkmcnt(12)
  v_mfma_f32_16x16x32_bf16 v[88:91], a[216:219], a[108:111], v[88:91]
  v_mfma_f32_16x16x32_bf16 v[152:155], a[216:219], a[112:115], v[152:155]
  v_mfma_f32_16x16x32_bf16 v[216:219], a[216:219], a[116:119], v[216:219]
  ds_read_b64_tr_b16 a[244:245], v44 offset:16648
  ds_read_b64_tr_b16 a[246:247], v44 offset:18696
  s_waitcnt lgkmcnt(12)
  v_mfma_f32_16x16x32_bf16 v[92:95], a[220:223], a[108:111], v[92:95]
  v_mfma_f32_16x16x32_bf16 v[156:159], a[220:223], a[112:115], v[156:159]
  v_mfma_f32_16x16x32_bf16 v[220:223], a[220:223], a[116:119], v[220:223]
  ds_read_b64_tr_b16 a[248:249], v46 offset:16640
  ds_read_b64_tr_b16 a[250:251], v46 offset:18688
  s_waitcnt lgkmcnt(12)
  v_mfma_f32_16x16x32_bf16 v[96:99], a[224:227], a[108:111], v[96:99]
  v_mfma_f32_16x16x32_bf16 v[160:163], a[224:227], a[112:115], v[160:163]
  v_mfma_f32_16x16x32_bf16 v[224:227], a[224:227], a[116:119], v[224:227]
  ds_read_b64_tr_b16 a[252:253], v46 offset:16648
  ds_read_b64_tr_b16 a[254:255], v46 offset:18696
  s_waitcnt lgkmcnt(12)
  v_mfma_f32_16x16x32_bf16 v[100:103], a[228:231], a[108:111], v[100:103]
  s_add_u32 m0, s29, 104448
  s_nop 0
  buffer_load_dwordx4 v22, s[8:11], s42 offen nt lds
  v_mfma_f32_16x16x32_bf16 v[164:167], a[228:231], a[112:115], v[164:167]
  v_mfma_f32_16x16x32_bf16 v[228:231], a[228:231], a[116:119], v[228:231]
  s_waitcnt lgkmcnt(10)
  v_mfma_f32_16x16x32_bf16 v[104:107], a[232:235], a[108:111], v[104:107]
  v_mfma_f32_16x16x32_bf16 v[168:171], a[232:235], a[112:115], v[168:171]
  v_mfma_f32_16x16x32_bf16 v[232:235], a[232:235], a[116:119], v[232:235]
  s_waitcnt lgkmcnt(8)
  v_mfma_f32_16x16x32_bf16 v[108:111], a[236:239], a[108:111], v[108:111]
  v_mfma_f32_16x16x32_bf16 v[172:175], a[236:239], a[112:115], v[172:175]
  v_mfma_f32_16x16x32_bf16 v[236:239], a[236:239], a[116:119], v[236:239]
  s_waitcnt lgkmcnt(6)
  v_mfma_f32_16x16x32_bf16 v[112:115], a[240:243], a[108:111], v[112:115]
  v_mfma_f32_16x16x32_bf16 v[176:179], a[240:243], a[112:115], v[176:179]
  s_add_u32 m0, s29, 105472
  s_nop 0
  buffer_load_dwordx4 v23, s[8:11], s42 offen nt lds
  v_mfma_f32_16x16x32_bf16 v[240:243], a[240:243], a[116:119], v[240:243]
  s_waitcnt lgkmcnt(4)
  v_mfma_f32_16x16x32_bf16 v[116:119], a[244:247], a[108:111], v[116:119]
  v_mfma_f32_16x16x32_bf16 v[180:183], a[244:247], a[112:115], v[180:183]
  v_mfma_f32_16x16x32_bf16 v[244:247], a[244:247], a[116:119], v[244:247]
  s_waitcnt lgkmcnt(2)
  v_mfma_f32_16x16x32_bf16 v[120:123], a[248:251], a[108:111], v[120:123]
  v_mfma_f32_16x16x32_bf16 v[184:187], a[248:251], a[112:115], v[184:187]
  v_mfma_f32_16x16x32_bf16 v[248:251], a[248:251], a[116:119], v[248:251]
  s_waitcnt lgkmcnt(0)
  v_mfma_f32_16x16x32_bf16 v[124:127], a[252:255], a[108:111], v[124:127]
  v_mfma_f32_16x16x32_bf16 v[188:191], a[252:255], a[112:115], v[188:191]
  v_mfma_f32_16x16x32_bf16 v[252:255], a[252:255], a[116:119], v[252:255]
  s_waitcnt vmcnt(16)
  s_barrier
  ds_read_b64_tr_b16 a[192:193], v40 offset:32768
  ds_read_b64_tr_b16 a[194:195], v40 offset:34816
  ds_read_b64_tr_b16 a[196:197], v40 offset:32776
  ds_read_b64_tr_b16 a[198:199], v40 offset:34824
  ds_read_b64_tr_b16 a[200:201], v42 offset:32768
  ds_read_b64_tr_b16 a[202:203], v42 offset:34816
  ds_read_b64_tr_b16 a[204:205], v42 offset:32776
  ds_read_b64_tr_b16 a[206:207], v42 offset:34824
  ds_read_b64_tr_b16 a[208:209], v44 offset:32768
  ds_read_b64_tr_b16 a[210:211], v44 offset:34816
  ds_read_b64_tr_b16 a[212:213], v44 offset:32776
  ds_read_b64_tr_b16 a[214:215], v44 offset:34824
  ds_read_b64_tr_b16 a[216:217], v46 offset:32768
  ds_read_b64_tr_b16 a[218:219], v46 offset:34816
  s_waitcnt lgkmcnt(12)
  v_mfma_f32_16x16x32_bf16 v[64:67], a[192:195], a[120:123], v[64:67]
  v_mfma_f32_16x16x32_bf16 v[128:131], a[192:195], a[124:127], v[128:131]
  v_mfma_f32_16x16x32_bf16 v[192:195], a[192:195], a[128:131], v[192:195]
  ds_read_b64_tr_b16 a[220:221], v46 offset:32776
  ds_read_b64_tr_b16 a[222:223], v46 offset:34824
  s_waitcnt lgkmcnt(12)
  v_mfma_f32_16x16x32_bf16 v[68:71], a[196:199], a[120:123], v[68:71]
  v_mfma_f32_16x16x32_bf16 v[132:135], a[196:199], a[124:127], v[132:135]
  v_mfma_f32_16x16x32_bf16 v[196:199], a[196:199], a[128:131], v[196:199]
  ds_read_b64_tr_b16 a[224:225], v40 offset:33024
  ds_read_b64_tr_b16 a[226:227], v40 offset:35072
  s_waitcnt lgkmcnt(12)
  v_mfma_f32_16x16x32_bf16 v[72:75], a[200:203], a[120:123], v[72:75]
  v_mfma_f32_16x16x32_bf16 v[136:139], a[200:203], a[124:127], v[136:139]
  v_mfma_f32_16x16x32_bf16 v[200:203], a[200:203], a[128:131], v[200:203]
  ds_read_b64_tr_b16 a[228:229], v40 offset:33032
  ds_read_b64_tr_b16 a[230:231], v40 offset:35080
  s_waitcnt lgkmcnt(12)
  v_mfma_f32_16x16x32_bf16 v[76:79], a[204:207], a[120:123], v[76:79]
  s_add_u32 s31, s43, 1
  s_and_b32 s31, s31, 7
  s_lshl_b32 s31, s31, 15
  v_mfma_f32_16x16x32_bf16 v[140:143], a[204:207], a[124:127], v[140:143]
  v_mfma_f32_16x16x32_bf16 v[204:207], a[204:207], a[128:131], v[204:207]
  ds_read_b64_tr_b16 a[232:233], v42 offset:33024
  ds_read_b64_tr_b16 a[234:235], v42 offset:35072
  s_waitcnt lgkmcnt(12)
  v_mfma_f32_16x16x32_bf16 v[80:83], a[208:211], a[120:123], v[80:83]
  v_mfma_f32_16x16x32_bf16 v[144:147], a[208:211], a[124:127], v[144:147]
  v_mfma_f32_16x16x32_bf16 v[208:211], a[208:211], a[128:131], v[208:211]
  ds_read_b64_tr_b16 a[236:237], v42 offset:33032
  ds_read_b64_tr_b16 a[238:239], v42 offset:35080
  s_waitcnt lgkmcnt(12)
  v_mfma_f32_16x16x32_bf16 v[84:87], a[212:215], a[120:123], v[84:87]
  v_mfma_f32_16x16x32_bf16 v[148:151], a[212:215], a[124:127], v[148:151]
  v_mfma_f32_16x16x32_bf16 v[212:215], a[212:215], a[128:131], v[212:215]
  ds_read_b64_tr_b16 a[240:241], v44 offset:33024
  ds_read_b64_tr_b16 a[242:243], v44 offset:35072
  s_waitcnt lgkmcnt(12)
  v_mfma_f32_16x16x32_bf16 v[88:91], a[216:219], a[120:123], v[88:91]
  v_mfma_f32_16x16x32_bf16 v[152:155], a[216:219], a[124:127], v[152:155]
  s_add_u32 m0, s29, 0
  s_nop 0
  buffer_load_dwordx4 v16, s[8:11], s31 offen nt lds
  v_mfma_f32_16x16x32_bf16 v[216:219], a[216:219], a[128:131], v[216:219]
  ds_read_b64_tr_b16 a[244:245], v44 offset:33032
  ds_read_b64_tr_b16 a[246:247], v44 offset:35080
  s_waitcnt lgkmcnt(12)
  v_mfma_f32_16x16x32_bf16 v[92:95], a[220:223], a[120:123], v[92:95]
  v_mfma_f32_16x16x32_bf16 v[156:159], a[220:223], a[124:127], v[156:159]
  v_mfma_f32_16x16x32_bf16 v[220:223], a[220:223], a[128:131], v[220:223]
  ds_read_b64_tr_b16 a[248:249], v46 offset:33024
  ds_read_b64_tr_b16 a[250:251], v46 offset:35072
  s_waitcnt lgkmcnt(12)
  v_mfma_f32_16x16x32_bf16 v[96:99], a[224:227], a[120:123], v[96:99]
  v_mfma_f32_16x16x32_bf16 v[160:163], a[224:227], a[124:127], v[160:163]
  v_mfma_f32_16x16x32_bf16 v[224:227], a[224:227], a[128:131], v[224:227]
  ds_read_b64_tr_b16 a[252:253], v46 offset:33032
  ds_read_b64_tr_b16 a[254:255], v46 offset:35080
  s_waitcnt lgkmcnt(12)
  v_mfma_f32_16x16x32_bf16 v[100:103], a[228:231], a[120:123], v[100:103]
  v_mfma_f32_16x16x32_bf16 v[164:167], a[228:231], a[124:127], v[164:167]
  v_mfma_f32_16x16x32_bf16 v[228:231], a[228:231], a[128:131], v[228:231]
  s_add_u32 m0, s29, 1024
  s_nop 0
  buffer_load_dwordx4 v17, s[8:11], s31 offen nt lds
  ds_read_b64_tr_b16 a[192:193], v40 offset:49152
  ds_read_b64_tr_b16 a[194:195], v40 offset:51200
  s_waitcnt lgkmcnt(12)
  v_mfma_f32_16x16x32_bf16 v[104:107], a[232:235], a[120:123], v[104:107]
  v_mfma_f32_16x16x32_bf16 v[168:171], a[232:235], a[124:127], v[168:171]
  v_mfma_f32_16x16x32_bf16 v[232:235], a[232:235], a[128:131], v[232:235]
  ds_read_b64_tr_b16 a[196:197], v40 offset:49160
  ds_read_b64_tr_b16 a[198:199], v40 offset:51208
  s_waitcnt lgkmcnt(12)
  v_mfma_f32_16x16x32_bf16 v[108:111], a[236:239], a[120:123], v[108:111]
  v_mfma_f32_16x16x32_bf16 v[172:175], a[236:239], a[124:127], v[172:175]
  v_mfma_f32_16x16x32_bf16 v[236:239], a[236:239], a[128:131], v[236:239]
  ds_read_b64_tr_b16 a[200:201], v42 offset:49152
  ds_read_b64_tr_b16 a[202:203], v42 offset:51200
  s_waitcnt lgkmcnt(12)
  v_mfma_f32_16x16x32_bf16 v[112:115], a[240:243], a[120:123], v[112:115]
  v_mfma_f32_16x16x32_bf16 v[176:179], a[240:243], a[124:127], v[176:179]
  v_mfma_f32_16x16x32_bf16 v[240:243], a[240:243], a[128:131], v[240:243]
  ds_read_b64_tr_b16 a[204:205], v42 offset:49160
  ds_read_b64_tr_b16 a[206:207], v42 offset:51208
  s_waitcnt lgkmcnt(12)
  v_mfma_f32_16x16x32_bf16 v[116:119], a[244:247], a[120:123], v[116:119]
  s_add_u32 m0, s29, 2048
  s_nop 0
  buffer_load_dwordx4 v18, s[8:11], s31 offen nt lds
  v_mfma_f32_16x16x32_bf16 v[180:183], a[244:247], a[124:127], v[180:183]
  v_mfma_f32_16x16x32_bf16 v[244:247], a[244:247], a[128:131], v[244:247]
  ds_read_b64_tr_b16 a[208:209], v44 offset:49152
  ds_read_b64_tr_b16 a[210:211], v44 offset:51200
  s_waitcnt lgkmcnt(12)
  v_mfma_f32_16x16x32_bf16 v[120:123], a[248:251], a[120:123], v[120:123]
  v_mfma_f32_16x16x32_bf16 v[184:187], a[248:251], a[124:127], v[184:187]
  v_mfma_f32_16x16x32_bf16 v[248:251], a[248:251], a[128:131], v[248:251]
  ds_read_b64_tr_b16 a[212:213], v44 offset:49160
  ds_read_b64_tr_b16 a[214:215], v44 offset:51208
  s_waitcnt lgkmcnt(12)
  v_mfma_f32_16x16x32_bf16 v[124:127], a[252:255], a[120:123], v[124:127]
  v_mfma_f32_16x16x32_bf16 v[188:191], a[252:255], a[124:127], v[188:191]
  v_mfma_f32_16x16x32_bf16 v[252:255], a[252:255], a[128:131], v[252:255]
  ds_read_b64_tr_b16 a[216:217], v46 offset:49152
  ds_read_b64_tr_b16 a[218:219], v46 offset:51200
  s_waitcnt lgkmcnt(12)
  v_mfma_f32_16x16x32_bf16 v[64:67], a[192:195], a[132:135], v[64:67]
  v_mfma_f32_16x16x32_bf16 v[128:131], a[192:195], a[136:139], v[128:131]
  s_add_u32 m0, s29, 3072
  s_nop 0
  buffer_load_dwordx4 v19, s[8:11], s31 offen nt lds
  v_mfma_f32_16x16x32_bf16 v[192:195], a[192:195], a[140:143], v[192:195]
  ds_read_b64_tr_b16 a[220:221], v46 offset:49160
  ds_read_b64_tr_b16 a[222:223], v46 offset:51208
  s_waitcnt lgkmcnt(12)
  v_mfma_f32_16x16x32_bf16 v[68:71], a[196:199], a[132:135], v[68:71]
  v_mfma_f32_16x16x32_bf16 v[132:135], a[196:199], a[136:139], v[132:135]
  v_mfma_f32_16x16x32_bf16 v[196:199], a[196:199], a[140:143], v[196:199]
  ds_read_b64_tr_b16 a[224:225], v40 offset:49408
  ds_read_b64_tr_b16 a[226:227], v40 offset:51456
  s_waitcnt lgkmcnt(12)
  v_mfma_f32_16x16x32_bf16 v[72:75], a[200:203], a[132:135], v[72:75]
  v_mfma_f32_16x16x32_bf16 v[136:139], a[200:203], a[136:139], v[136:139]
  v_mfma_f32_16x16x32_bf16 v[200:203], a[200:203], a[140:143], v[200:203]
  ds_read_b64_tr_b16 a[228:229], v40 offset:49416
  ds_read_b64_tr_b16 a[230:231], v40 offset:51464
  s_waitcnt lgkmcnt(12)
  v_mfma_f32_16x16x32_bf16 v[76:79], a[204:207], a[132:135], v[76:79]
  v_mfma_f32_16x16x32_bf16 v[140:143], a[204:207], a[136:139], v[140:143]
  v_mfma_f32_16x16x32_bf16 v[204:207], a[204:207], a[140:143], v[204:207]
  s_add_u32 m0, s29, 4096
  s_nop 0
  buffer_load_dwordx4 v20, s[8:11], s31 offen nt lds
  ds_read_b64_tr_b16 a[232:233], v42 offset:49408
  ds_read_b64_tr_b16 a[234:235], v42 offset:51456
  s_waitcnt lgkmcnt(12)
  v_mfma_f32_16x16x32_bf16 v[80:83], a[208:211], a[132:135], v[80:83]
  v_mfma_f32_16x16x32_bf16 v[144:147], a[208:211], a[136:139], v[144:147]
  v_mfma_f32_16x16x32_bf16 v[208:211], a[208:211], a[140:143], v[208:211]
  ds_read_b64_tr_b16 a[236:237], v42 offset:49416
  ds_read_b64_tr_b16 a[238:239], v42 offset:51464
  s_waitcnt lgkmcnt(12)
  v_mfma_f32_16x16x32_bf16 v[84:87], a[212:215], a[132:135], v[84:87]
  v_mfma_f32_16x16x32_bf16 v[148:151], a[212:215], a[136:139], v[148:151]
  v_mfma_f32_16x16x32_bf16 v[212:215], a[212:215], a[140:143], v[212:215]
  ds_read_b64_tr_b16 a[240:241], v44 offset:49408
  ds_read_b64_tr_b16 a[242:243], v44 offset:51456
  s_waitcnt lgkmcnt(12)
  v_mfma_f32_16x16x32_bf16 v[88:91], a[216:219], a[132:135], v[88:91]
  v_mfma_f32_16x16x32_bf16 v[152:155], a[216:219], a[136:139], v[152:155]
  v_mfma_f32_16x16x32_bf16 v[216:219], a[216:219], a[140:143], v[216:219]
  ds_read_b64_tr_b16 a[244:245], v44 offset:49416
  ds_read_b64_tr_b16 a[246:247], v44 offset:51464
  s_waitcnt lgkmcnt(12)
  v_mfma_f32_16x16x32_bf16 v[92:95], a[220:223], a[132:135], v[92:95]
  s_add_u32 m0, s29, 5120
  s_nop 0
  buffer_load_dwordx4 v21, s[8:11], s31 offen nt lds
  v_mfma_f32_16x16x32_bf16 v[156:159], a[220:223], a[136:139], v[156:159]
  v_mfma_f32_16x16x32_bf16 v[220:223], a[220:223], a[140:143], v[220:223]
  ds_read_b64_tr_b16 a[248:249], v46 offset:49408
  ds_read_b64_tr_b16 a[250:251], v46 offset:51456
  s_waitcnt lgkmcnt(12)
  v_mfma_f32_16x16x32_bf16 v[96:99], a[224:227], a[132:135], v[96:99]
  v_mfma_f32_16x16x32_bf16 v[160:163], a[224:227], a[136:139], v[160:163]
  v_mfma_f32_16x16x32_bf16 v[224:227], a[224:227], a[140:143], v[224:227]
  ds_read_b64_tr_b16 a[252:253], v46 offset:49416
  ds_read_b64_tr_b16 a[254:255], v46 offset:51464
  s_waitcnt lgkmcnt(12)
  v_mfma_f32_16x16x32_bf16 v[100:103], a[228:231], a[132:135], v[100:103]
  v_mfma_f32_16x16x32_bf16 v[164:167], a[228:231], a[136:139], v[164:167]
  v_mfma_f32_16x16x32_bf16 v[228:231], a[228:231], a[140:143], v[228:231]
  s_waitcnt lgkmcnt(10)
  v_mfma_f32_16x16x32_bf16 v[104:107], a[232:235], a[132:135], v[104:107]
  v_mfma_f32_16x16x32_bf16 v[168:171], a[232:235], a[136:139], v[168:171]
  s_add_u32 m0, s29, 6144
  s_nop 0
  buffer_load_dwordx4 v22, s[8:11], s31 offen nt lds
  v_mfma_f32_16x16x32_bf16 v[232:235], a[232:235], a[140:143], v[232:235]
  s_waitcnt lgkmcnt(8)
  v_mfma_f32_16x16x32_bf16 v[108:111], a[236:239], a[132:135], v[108:111]
  v_mfma_f32_16x16x32_bf16 v[172:175], a[236:239], a[136:139], v[172:175]
  v_mfma_f32_16x16x32_bf16 v[236:239], a[236:239], a[140:143], v[236:239]
  s_waitcnt lgkmcnt(6)
  v_mfma_f32_16x16x32_bf16 v[112:115], a[240:243], a[132:135], v[112:115]
  v_mfma_f32_16x16x32_bf16 v[176:179], a[240:243], a[136:139], v[176:179]
  v_mfma_f32_16x16x32_bf16 v[240:243], a[240:243], a[140:143], v[240:243]
  s_waitcnt lgkmcnt(4)
  v_mfma_f32_16x16x32_bf16 v[116:119], a[244:247], a[132:135], v[116:119]
  v_mfma_f32_16x16x32_bf16 v[180:183], a[244:247], a[136:139], v[180:183]
  v_mfma_f32_16x16x32_bf16 v[244:247], a[244:247], a[140:143], v[244:247]
  s_add_u32 m0, s29, 7168
  s_nop 0
  buffer_load_dwordx4 v23, s[8:11], s31 offen nt lds
  s_waitcnt lgkmcnt(2)
  v_mfma_f32_16x16x32_bf16 v[120:123], a[248:251], a[132:135], v[120:123]
  v_mfma_f32_16x16x32_bf16 v[184:187], a[248:251], a[136:139], v[184:187]
  v_mfma_f32_16x16x32_bf16 v[248:251], a[248:251], a[140:143], v[248:251]
  s_waitcnt lgkmcnt(0)
  v_mfma_f32_16x16x32_bf16 v[124:127], a[252:255], a[132:135], v[124:127]
  v_mfma_f32_16x16x32_bf16 v[188:191], a[252:255], a[136:139], v[188:191]
  v_mfma_f32_16x16x32_bf16 v[252:255], a[252:255], a[140:143], v[252:255]
  s_waitcnt vmcnt(16)
  s_barrier
  ds_read_b64_tr_b16 a[192:193], v41 offset:0
  ds_read_b64_tr_b16 a[194:195], v41 offset:2048
  ds_read_b64_tr_b16 a[196:197], v41 offset:8
  ds_read_b64_tr_b16 a[198:199], v41 offset:2056
  ds_read_b64_tr_b16 a[200:201], v43 offset:0
  ds_read_b64_tr_b16 a[202:203], v43 offset:2048
  ds_read_b64_tr_b16 a[204:205], v43 offset:8
  ds_read_b64_tr_b16 a[206:207], v43 offset:2056
  ds_read_b64_tr_b16 a[208:209], v45 offset:0
  ds_read_b64_tr_b16 a[210:211], v45 offset:2048
  ds_read_b64_tr_b16 a[212:213], v45 offset:8
  ds_read_b64_tr_b16 a[214:215], v45 offset:2056
  ds_read_b64_tr_b16 a[216:217], v47 offset:0
  ds_read_b64_tr_b16 a[218:219], v47 offset:2048
  s_waitcnt lgkmcnt(12)
  v_mfma_f32_16x16x32_bf16 v[64:67], a[192:195], a[144:147], v[64:67]
  v_mfma_f32_16x16x32_bf16 v[128:131], a[192:195], a[148:151], v[128:131]
  v_mfma_f32_16x16x32_bf16 v[192:195], a[192:195], a[152:155], v[192:195]
  ds_read_b64_tr_b16 a[220:221], v47 offset:8
  ds_read_b64_tr_b16 a[222:223], v47 offset:2056
  s_waitcnt lgkmcnt(12)
  v_mfma_f32_16x16x32_bf16 v[68:71], a[196:199], a[144:147], v[68:71]
  s_add_u32 s42, s43, 2
  s_and_b32 s42, s42, 7
  s_lshl_b32 s42, s42, 15
  v_mfma_f32_16x16x32_bf16 v[132:135], a[196:199], a[148:151], v[132:135]
  v_mfma_f32_16x16x32_bf16 v[196:199], a[196:199], a[152:155], v[196:199]
  ds_read_b64_tr_b16 a[224:225], v41 offset:256
  ds_read_b64_tr_b16 a[226:227], v41 offset:2304
  s_waitcnt lgkmcnt(12)
  v_mfma_f32_16x16x32_bf16 v[72:75], a[200:203], a[144:147], v[72:75]
  v_mfma_f32_16x16x32_bf16 v[136:139], a[200:203], a[148:151], v[136:139]
  v_mfma_f32_16x16x32_bf16 v[200:203], a[200:203], a[152:155], v[200:203]
  ds_read_b64_tr_b16 a[228:229], v41 offset:264
  ds_read_b64_tr_b16 a[230:231], v41 offset:2312
  s_waitcnt lgkmcnt(12)
  v_mfma_f32_16x16x32_bf16 v[76:79], a[204:207], a[144:147], v[76:79]
  v_mfma_f32_16x16x32_bf16 v[140:143], a[204:207], a[148:151], v[140:143]
  v_mfma_f32_16x16x32_bf16 v[204:207], a[204:207], a[152:155], v[204:207]
  ds_read_b64_tr_b16 a[232:233], v43 offset:256
  ds_read_b64_tr_b16 a[234:235], v43 offset:2304
  s_waitcnt lgkmcnt(12)
  v_mfma_f32_16x16x32_bf16 v[80:83], a[208:211], a[144:147], v[80:83]
  v_mfma_f32_16x16x32_bf16 v[144:147], a[208:211], a[148:151], v[144:147]
  s_add_u32 m0, s29, 32768
  s_nop 0
  buffer_load_dwordx4 v16, s[8:11], s42 offen nt lds
  v_mfma_f32_16x16x32_bf16 v[208:211], a[208:211], a[152:155], v[208:211]
  ds_read_b64_tr_b16 a[236:237], v43 offset:264
  ds_read_b64_tr_b16 a[238:239], v43 offset:2312
  s_waitcnt lgkmcnt(12)
  v_mfma_f32_16x16x32_bf16 v[84:87], a[212:215], a[144:147], v[84:87]
  v_mfma_f32_16x16x32_bf16 v[148:151], a[212:215], a[148:151], v[148:151]
  v_mfma_f32_16x16x32_bf16 v[212:215], a[212:215], a[152:155], v[212:215]
  ds_read_b64_tr_b16 a[240:241], v45 offset:256
  ds_read_b64_tr_b16 a[242:243], v45 offset:2304
  s_waitcnt lgkmcnt(12)
  v_mfma_f32_16x16x32_bf16 v[88:91], a[216:219], a[144:147], v[88:91]
  v_mfma_f32_16x16x32_bf16 v[152:155], a[216:219], a[148:151], v[152:155]
  v_mfma_f32_16x16x32_bf16 v[216:219], a[216:219], a[152:155], v[216:219]
  ds_read_b64_tr_b16 a[244:245], v45 offset:264
  ds_read_b64_tr_b16 a[246:247], v45 offset:2312
  s_waitcnt lgkmcnt(12)
  v_mfma_f32_16x16x32_bf16 v[92:95], a[220:223], a[144:147], v[92:95]
  v_mfma_f32_16x16x32_bf16 v[156:159], a[220:223], a[148:151], v[156:159]
  v_mfma_f32_16x16x32_bf16 v[220:223], a[220:223], a[152:155], v[220:223]
  s_add_u32 m0, s29, 33792
  s_nop 0
  buffer_load_dwordx4 v17, s[8:11], s42 offen nt lds
  ds_read_b64_tr_b16 a[248:249], v47 offset:256
  ds_read_b64_tr_b16 a[250:251], v47 offset:2304
  s_waitcnt lgkmcnt(12)
  v_mfma_f32_16x16x32_bf16 v[96:99], a[224:227], a[144:147], v[96:99]
  v_mfma_f32_16x16x32_bf16 v[160:163], a[224:227], a[148:151], v[160:163]
  v_mfma_f32_16x16x32_bf16 v[224:227], a[224:227], a[152:155], v[224:227]
  ds_read_b64_tr_b16 a[252:253], v47 offset:264
  ds_read_b64_tr_b16 a[254:255], v47 offset:2312
  s_waitcnt lgkmcnt(12)
  v_mfma_f32_16x16x32_bf16 v[100:103], a[228:231], a[144:147], v[100:103]
  v_mfma_f32_16x16x32_bf16 v[164:167], a[228:231], a[148:151], v[164:167]
  v_mfma_f32_16x16x32_bf16 v[228:231], a[228:231], a[152:155], v[228:231]
  ds_read_b64_tr_b16 a[192:193], v41 offset:16384
  ds_read_b64_tr_b16 a[194:195], v41 offset:18432
  s_waitcnt lgkmcnt(12)
  v_mfma_f32_16x16x32_bf16 v[104:107], a[232:235], a[144:147], v[104:107]
  v_mfma_f32_16x16x32_bf16 v[168:171], a[232:235], a[148:151], v[168:171]
  v_mfma_f32_16x16x32_bf16 v[232:235], a[232:235], a[152:155], v[232:235]
  ds_read_b64_tr_b16 a[196:197], v41 offset:16392
  ds_read_b64_tr_b16 a[198:199], v41 offset:18440
  s_waitcnt lgkmcnt(12)
  v_mfma_f32_16x16x32_bf16 v[108:111], a[236:239], a[144:147], v[108:111]
  s_add_u32 m0, s29, 34816
  s_nop 0
  buffer_load_dwordx4 v18, s[8:11], s42 offen nt lds
  v_mfma_f32_16x16x32_bf16 v[172:175], a[236:239], a[148:151], v[172:175]
  v_mfma_f32_16x16x32_bf16 v[236:239], a[236:239], a[152:155], v[236:239]
  ds_read_b64_tr_b16 a[200:201], v43 offset:16384
  ds_read_b64_tr_b16 a[202:203], v43 offset:18432
  s_waitcnt lgkmcnt(12)
  v_mfma_f32_16x16x32_bf16 v[112:115], a[240:243], a[144:147], v[112:115]
  v_mfma_f32_16x16x32_bf16 v[176:179], a[240:243], a[148:151], v[176:179]
  v_mfma_f32_16x16x32_bf16 v[240:243], a[240:243], a[152:155], v[240:243]
  ds_read_b64_tr_b16 a[204:205], v43 offset:16392
  ds_read_b64_tr_b16 a[206:207], v43 offset:18440
  s_waitcnt lgkmcnt(12)
  v_mfma_f32_16x16x32_bf16 v[116:119], a[244:247], a[144:147], v[116:119]
  v_mfma_f32_16x16x32_bf16 v[180:183], a[244:247], a[148:151], v[180:183]
  v_mfma_f32_16x16x32_bf16 v[244:247], a[244:247], a[152:155], v[244:247]
  ds_read_b64_tr_b16 a[208:209], v45 offset:16384
  ds_read_b64_tr_b16 a[210:211], v45 offset:18432
  s_waitcnt lgkmcnt(12)
  v_mfma_f32_16x16x32_bf16 v[120:123], a[248:251], a[144:147], v[120:123]
  v_mfma_f32_16x16x32_bf16 v[184:187], a[248:251], a[148:151], v[184:187]
  s_add_u32 m0, s29, 35840
  s_nop 0
  buffer_load_dwordx4 v19, s[8:11], s42 offen nt lds
  v_mfma_f32_16x16x32_bf16 v[248:251], a[248:251], a[152:155], v[248:251]
  ds_read_b64_tr_b16 a[212:213], v45 offset:16392
  ds_read_b64_tr_b16 a[214:215], v45 offset:18440
  s_waitcnt lgkmcnt(12)
  v_mfma_f32_16x16x32_bf16 v[124:127], a[252:255], a[144:147], v[124:127]
  v_mfma_f32_16x16x32_bf16 v[188:191], a[252:255], a[148:151], v[188:191]
  v_mfma_f32_16x16x32_bf16 v[252:255], a[252:255], a[152:155], v[252:255]
  ds_read_b64_tr_b16 a[216:217], v47 offset:16384
  ds_read_b64_tr_b16 a[218:219], v47 offset:18432
  s_waitcnt lgkmcnt(12)
  v_mfma_f32_16x16x32_bf16 v[64:67], a[192:195], a[156:159], v[64:67]
  v_mfma_f32_16x16x32_bf16 v[128:131], a[192:195], a[160:163], v[128:131]
  v_mfma_f32_16x16x32_bf16 v[192:195], a[192:195], a[164:167], v[192:195]
  ds_read_b64_tr_b16 a[220:221], v47 offset:16392
  ds_read_b64_tr_b16 a[222:223], v47 offset:18440
  s_waitcnt lgkmcnt(12)
  v_mfma_f32_16x16x32_bf16 v[68:71], a[196:199], a[156:159], v[68:71]
  v_mfma_f32_16x16x32_bf16 v[132:135], a[196:199], a[160:163], v[132:135]
  v_mfma_f32_16x16x32_bf16 v[196:199], a[196:199], a[164:167], v[196:199]
  s_add_u32 m0, s29, 36864
  s_nop 0
  buffer_load_dwordx4 v20, s[8:11], s42 offen nt lds
  ds_read_b64_tr_b16 a[224:225], v41 offset:16640
  ds_read_b64_tr_b16 a[226:227], v41 offset:18688
  s_waitcnt lgkmcnt(12)
  v_mfma_f32_16x16x32_bf16 v[72:75], a[200:203], a[156:159], v[72:75]
  v_mfma_f32_16x16x32_bf16 v[136:139], a[200:203], a[160:163], v[136:139]
  v_mfma_f32_16x16x32_bf16 v[200:203], a[200:203], a[164:167], v[200:203]
  ds_read_b64_tr_b16 a[228:229], v41 offset:16648
  ds_read_b64_tr_b16 a[230:231], v41 offset:18696
  s_waitcnt lgkmcnt(12)
  v_mfma_f32_16x16x32_bf16 v[76:79], a[204:207], a[156:159], v[76:79]
  v_mfma_f32_16x16x32_bf16 v[140:143], a[204:207], a[160:163], v[140:143]
  v_mfma_f32_16x16x32_bf16 v[204:207], a[204:207], a[164:167], v[204:207]
  ds_read_b64_tr_b16 a[232:233], v43 offset:16640
  ds_read_b64_tr_b16 a[234:235], v43 offset:18688
  s_waitcnt lgkmcnt(12)
  v_mfma_f32_16x16x32_bf16 v[80:83], a[208:211], a[156:159], v[80:83]
  v_mfma_f32_16x16x32_bf16 v[144:147], a[208:211], a[160:163], v[144:147]
  v_mfma_f32_16x16x32_bf16 v[208:211], a[208:211], a[164:167], v[208:211]
  ds_read_b64_tr_b16 a[236:237], v43 offset:16648
  ds_read_b64_tr_b16 a[238:239], v43 offset:18696
  s_waitcnt lgkmcnt(12)
  v_mfma_f32_16x16x32_bf16 v[84:87], a[212:215], a[156:159], v[84:87]
  s_add_u32 m0, s29, 37888
  s_nop 0
  buffer_load_dwordx4 v21, s[8:11], s42 offen nt lds
  v_mfma_f32_16x16x32_bf16 v[148:151], a[212:215], a[160:163], v[148:151]
  v_mfma_f32_16x16x32_bf16 v[212:215], a[212:215], a[164:167], v[212:215]
  ds_read_b64_tr_b16 a[240:241], v45 offset:16640
  ds_read_b64_tr_b16 a[242:243], v45 offset:18688
  s_waitcnt lgkmcnt(12)
  v_mfma_f32_16x16x32_bf16 v[88:91], a[216:219], a[156:159], v[88:91]
  v_mfma_f32_16x16x32_bf16 v[152:155], a[216:219], a[160:163], v[152:155]
  v_mfma_f32_16x16x32_bf16 v[216:219], a[216:219], a[164:167], v[216:219]
  ds_read_b64_tr_b16 a[244:245], v45 offset:16648
  ds_read_b64_tr_b16 a[246:247], v45 offset:18696
  s_waitcnt lgkmcnt(12)
  v_mfma_f32_16x16x32_bf16 v[92:95], a[220:223], a[156:159], v[92:95]
  v_mfma_f32_16x16x32_bf16 v[156:159], a[220:223], a[160:163], v[156:159]
  v_mfma_f32_16x16x32_bf16 v[220:223], a[220:223], a[164:167], v[220:223]
  ds_read_b64_tr_b16 a[248:249], v47 offset:16640
  ds_read_b64_tr_b16 a[250:251], v47 offset:18688
  s_waitcnt lgkmcnt(12)
  v_mfma_f32_16x16x32_bf16 v[96:99], a[224:227], a[156:159], v[96:99]
  v_mfma_f32_16x16x32_bf16 v[160:163], a[224:227], a[160:163], v[160:163]
  s_add_u32 m0, s29, 38912
  s_nop 0
  buffer_load_dwordx4 v22, s[8:11], s42 offen nt lds
  v_mfma_f32_16x16x32_bf16 v[224:227], a[224:227], a[164:167], v[224:227]
  ds_read_b64_tr_b16 a[252:253], v47 offset:16648
  ds_read_b64_tr_b16 a[254:255], v47 offset:18696
  s_waitcnt lgkmcnt(12)
  v_mfma_f32_16x16x32_bf16 v[100:103], a[228:231], a[156:159], v[100:103]
  v_mfma_f32_16x16x32_bf16 v[164:167], a[228:231], a[160:163], v[164:167]
  v_mfma_f32_16x16x32_bf16 v[228:231], a[228:231], a[164:167], v[228:231]
  s_waitcnt lgkmcnt(10)
  v_mfma_f32_16x16x32_bf16 v[104:107], a[232:235], a[156:159], v[104:107]
  v_mfma_f32_16x16x32_bf16 v[168:171], a[232:235], a[160:163], v[168:171]
  v_mfma_f32_16x16x32_bf16 v[232:235], a[232:235], a[164:167], v[232:235]
  s_waitcnt lgkmcnt(8)
  v_mfma_f32_16x16x32_bf16 v[108:111], a[236:239], a[156:159], v[108:111]
  v_mfma_f32_16x16x32_bf16 v[172:175], a[236:239], a[160:163], v[172:175]
  v_mfma_f32_16x16x32_bf16 v[236:239], a[236:239], a[164:167], v[236:239]
  s_add_u32 m0, s29, 39936
  s_nop 0
  buffer_load_dwordx4 v23, s[8:11], s42 offen nt lds
  s_waitcnt lgkmcnt(6)
  v_mfma_f32_16x16x32_bf16 v[112:115], a[240:243], a[156:159], v[112:115]
  v_mfma_f32_16x16x32_bf16 v[176:179], a[240:243], a[160:163], v[176:179]
  v_mfma_f32_16x16x32_bf16 v[240:243], a[240:243], a[164:167], v[240:243]
  s_waitcnt lgkmcnt(4)
  v_mfma_f32_16x16x32_bf16 v[116:119], a[244:247], a[156:159], v[116:119]
  v_mfma_f32_16x16x32_bf16 v[180:183], a[244:247], a[160:163], v[180:183]
  v_mfma_f32_16x16x32_bf16 v[244:247], a[244:247], a[164:167], v[244:247]
  s_waitcnt lgkmcnt(2)
  v_mfma_f32_16x16x32_bf16 v[120:123], a[248:251], a[156:159], v[120:123]
  v_mfma_f32_16x16x32_bf16 v[184:187], a[248:251], a[160:163], v[184:187]
  v_mfma_f32_16x16x32_bf16 v[248:251], a[248:251], a[164:167], v[248:251]
  s_waitcnt lgkmcnt(0)
  v_mfma_f32_16x16x32_bf16 v[124:127], a[252:255], a[156:159], v[124:127]
  v_mfma_f32_16x16x32_bf16 v[188:191], a[252:255], a[160:163], v[188:191]
  v_mfma_f32_16x16x32_bf16 v[252:255], a[252:255], a[164:167], v[252:255]
  v_cvt_pk_bf16_f32 v12, v64, v65
  v_accvgpr_write_b32 a0, v12
  v_cvt_pk_bf16_f32 v13, v66, v67
  v_accvgpr_write_b32 a1, v13
  v_cvt_pk_bf16_f32 v14, v68, v69
  v_accvgpr_write_b32 a2, v14
  v_cvt_pk_bf16_f32 v15, v70, v71
  v_accvgpr_write_b32 a3, v15
  v_cvt_pk_bf16_f32 v12, v72, v73
  v_accvgpr_write_b32 a4, v12
  v_cvt_pk_bf16_f32 v13, v74, v75
  v_accvgpr_write_b32 a5, v13
  v_cvt_pk_bf16_f32 v14, v76, v77
  v_accvgpr_write_b32 a6, v14
  v_cvt_pk_bf16_f32 v15, v78, v79
  v_accvgpr_write_b32 a7, v15
  v_cvt_pk_bf16_f32 v12, v80, v81
  v_accvgpr_write_b32 a8, v12
  v_cvt_pk_bf16_f32 v13, v82, v83
  v_accvgpr_write_b32 a9, v13
  v_cvt_pk_bf16_f32 v14, v84, v85
  v_accvgpr_write_b32 a10, v14
  v_cvt_pk_bf16_f32 v15, v86, v87
  v_accvgpr_write_b32 a11, v15
  v_cvt_pk_bf16_f32 v12, v88, v89
  v_accvgpr_write_b32 a12, v12
  v_cvt_pk_bf16_f32 v13, v90, v91
  v_accvgpr_write_b32 a13, v13
  v_cvt_pk_bf16_f32 v14, v92, v93
  v_accvgpr_write_b32 a14, v14
  v_cvt_pk_bf16_f32 v15, v94, v95
  v_accvgpr_write_b32 a15, v15
  v_cvt_pk_bf16_f32 v12, v96, v97
  v_accvgpr_write_b32 a16, v12
  v_cvt_pk_bf16_f32 v13, v98, v99
  v_accvgpr_write_b32 a17, v13
  v_cvt_pk_bf16_f32 v14, v100, v101
  v_accvgpr_write_b32 a18, v14
  v_cvt_pk_bf16_f32 v15, v102, v103
  v_accvgpr_write_b32 a19, v15
  v_cvt_pk_bf16_f32 v12, v104, v105
  v_accvgpr_write_b32 a20, v12
  v_cvt_pk_bf16_f32 v13, v106, v107
  v_accvgpr_write_b32 a21, v13
  v_cvt_pk_bf16_f32 v14, v108, v109
  v_accvgpr_write_b32 a22, v14
  v_cvt_pk_bf16_f32 v15, v110, v111
  v_accvgpr_write_b32 a23, v15
  v_cvt_pk_bf16_f32 v12, v112, v113
  v_accvgpr_write_b32 a24, v12
  v_cvt_pk_bf16_f32 v13, v114, v115
  v_accvgpr_write_b32 a25, v13
  v_cvt_pk_bf16_f32 v14, v116, v117
  v_accvgpr_write_b32 a26, v14
  v_cvt_pk_bf16_f32 v15, v118, v119
  v_accvgpr_write_b32 a27, v15
  v_cvt_pk_bf16_f32 v12, v120, v121
  v_accvgpr_write_b32 a28, v12
  v_cvt_pk_bf16_f32 v13, v122, v123
  v_accvgpr_write_b32 a29, v13
  v_cvt_pk_bf16_f32 v14, v124, v125
  v_accvgpr_write_b32 a30, v14
  v_cvt_pk_bf16_f32 v15, v126, v127
  v_accvgpr_write_b32 a31, v15
  v_cvt_pk_bf16_f32 v12, v128, v129
  v_accvgpr_write_b32 a32, v12
  v_cvt_pk_bf16_f32 v13, v130, v131
  v_accvgpr_write_b32 a33, v13
  v_cvt_pk_bf16_f32 v14, v132, v133
  v_accvgpr_write_b32 a34, v14
  v_cvt_pk_bf16_f32 v15, v134, v135
  v_accvgpr_write_b32 a35, v15
  v_cvt_pk_bf16_f32 v12, v136, v137
  v_accvgpr_write_b32 a36, v12
  v_cvt_pk_bf16_f32 v13, v138, v139
  v_accvgpr_write_b32 a37, v13
  v_cvt_pk_bf16_f32 v14, v140, v141
  v_accvgpr_write_b32 a38, v14
  v_cvt_pk_bf16_f32 v15, v142, v143
  v_accvgpr_write_b32 a39, v15
  v_cvt_pk_bf16_f32 v12, v144, v145
  v_accvgpr_write_b32 a40, v12
  v_cvt_pk_bf16_f32 v13, v146, v147
  v_accvgpr_write_b32 a41, v13
  v_cvt_pk_bf16_f32 v14, v148, v149
  v_accvgpr_write_b32 a42, v14
  v_cvt_pk_bf16_f32 v15, v150, v151
  v_accvgpr_write_b32 a43, v15
  v_cvt_pk_bf16_f32 v12, v152, v153
  v_accvgpr_write_b32 a44, v12
  v_cvt_pk_bf16_f32 v13, v154, v155
  v_accvgpr_write_b32 a45, v13
  v_cvt_pk_bf16_f32 v14, v156, v157
  v_accvgpr_write_b32 a46, v14
  v_cvt_pk_bf16_f32 v15, v158, v159
  v_accvgpr_write_b32 a47, v15
  v_cvt_pk_bf16_f32 v12, v160, v161
  v_accvgpr_write_b32 a48, v12
  v_cvt_pk_bf16_f32 v13, v162, v163
  v_accvgpr_write_b32 a49, v13
  v_cvt_pk_bf16_f32 v14, v164, v165
  v_accvgpr_write_b32 a50, v14
  v_cvt_pk_bf16_f32 v15, v166, v167
  v_accvgpr_write_b32 a51, v15
  v_cvt_pk_bf16_f32 v12, v168, v169
  v_accvgpr_write_b32 a52, v12
  v_cvt_pk_bf16_f32 v13, v170, v171
  v_accvgpr_write_b32 a53, v13
  v_cvt_pk_bf16_f32 v14, v172, v173
  v_accvgpr_write_b32 a54, v14
  v_cvt_pk_bf16_f32 v15, v174, v175
  v_accvgpr_write_b32 a55, v15
  v_cvt_pk_bf16_f32 v12, v176, v177
  v_accvgpr_write_b32 a56, v12
  v_cvt_pk_bf16_f32 v13, v178, v179
  v_accvgpr_write_b32 a57, v13
  v_cvt_pk_bf16_f32 v14, v180, v181
  v_accvgpr_write_b32 a58, v14
  v_cvt_pk_bf16_f32 v15, v182, v183
  v_accvgpr_write_b32 a59, v15
  v_cvt_pk_bf16_f32 v12, v184, v185
  v_accvgpr_write_b32 a60, v12
  v_cvt_pk_bf16_f32 v13, v186, v187
  v_accvgpr_write_b32 a61, v13
  v_cvt_pk_bf16_f32 v14, v188, v189
  v_accvgpr_write_b32 a62, v14
  v_cvt_pk_bf16_f32 v15, v190, v191
  v_accvgpr_write_b32 a63, v15
  v_cvt_pk_bf16_f32 v12, v192, v193
  v_accvgpr_write_b32 a64, v12
  v_cvt_pk_bf16_f32 v13, v194, v195
  v_accvgpr_write_b32 a65, v13
  v_cvt_pk_bf16_f32 v14, v196, v197
  v_accvgpr_write_b32 a66, v14
  v_cvt_pk_bf16_f32 v15, v198, v199
  v_accvgpr_write_b32 a67, v15
  v_cvt_pk_bf16_f32 v12, v200, v201
  v_accvgpr_write_b32 a68, v12
  v_cvt_pk_bf16_f32 v13, v202, v203
  v_accvgpr_write_b32 a69, v13
  v_cvt_pk_bf16_f32 v14, v204, v205
  v_accvgpr_write_b32 a70, v14
  v_cvt_pk_bf16_f32 v15, v206, v207
  v_accvgpr_write_b32 a71, v15
  v_cvt_pk_bf16_f32 v12, v208, v209
  v_accvgpr_write_b32 a72, v12
  v_cvt_pk_bf16_f32 v13, v210, v211
  v_accvgpr_write_b32 a73, v13
  v_cvt_pk_bf16_f32 v14, v212, v213
  v_accvgpr_write_b32 a74, v14
  v_cvt_pk_bf16_f32 v15, v214, v215
  v_accvgpr_write_b32 a75, v15
  v_cvt_pk_bf16_f32 v12, v216, v217
  v_accvgpr_write_b32 a76, v12
  v_cvt_pk_bf16_f32 v13, v218, v219
  v_accvgpr_write_b32 a77, v13
  v_cvt_pk_bf16_f32 v14, v220, v221
  v_accvgpr_write_b32 a78, v14
  v_cvt_pk_bf16_f32 v15, v222, v223
  v_accvgpr_write_b32 a79, v15
  v_cvt_pk_bf16_f32 v12, v224, v225
  v_accvgpr_write_b32 a80, v12
  v_cvt_pk_bf16_f32 v13, v226, v227
  v_accvgpr_write_b32 a81, v13
  v_cvt_pk_bf16_f32 v14, v228, v229
  v_accvgpr_write_b32 a82, v14
  v_cvt_pk_bf16_f32 v15, v230, v231
  v_accvgpr_write_b32 a83, v15
  v_cvt_pk_bf16_f32 v12, v232, v233
  v_accvgpr_write_b32 a84, v12
  v_cvt_pk_bf16_f32 v13, v234, v235
  v_accvgpr_write_b32 a85, v13
  v_cvt_pk_bf16_f32 v14, v236, v237
  v_accvgpr_write_b32 a86, v14
  v_cvt_pk_bf16_f32 v15, v238, v239
  v_accvgpr_write_b32 a87, v15
  v_cvt_pk_bf16_f32 v12, v240, v241
  v_accvgpr_write_b32 a88, v12
  v_cvt_pk_bf16_f32 v13, v242, v243
  v_accvgpr_write_b32 a89, v13
  v_cvt_pk_bf16_f32 v14, v244, v245
  v_accvgpr_write_b32 a90, v14
  v_cvt_pk_bf16_f32 v15, v246, v247
  v_accvgpr_write_b32 a91, v15
  v_cvt_pk_bf16_f32 v12, v248, v249
  v_accvgpr_write_b32 a92, v12
  v_cvt_pk_bf16_f32 v13, v250, v251
  v_accvgpr_write_b32 a93, v13
  v_cvt_pk_bf16_f32 v14, v252, v253
  v_accvgpr_write_b32 a94, v14
  v_cvt_pk_bf16_f32 v15, v254, v255
  v_accvgpr_write_b32 a95, v15
  v_lshlrev_b32 v6, 9, v3
  s_lshl_b32 s5, s28, 13
  v_add_u32 v7, 0, v2
  v_xor_b32 v7, v7, v3
  v_lshl_add_u32 v40, v7, 4, v6
  v_add_u32 v41, 0x10000, v40
  v_add_u32 v48, s5, v40
  v_add_u32 v49, s5, v41
  v_add_u32 v7, 4, v2
  v_xor_b32 v7, v7, v3
  v_lshl_add_u32 v42, v7, 4, v6
  v_add_u32 v43, 0x10000, v42
  v_add_u32 v50, s5, v42
  v_add_u32 v51, s5, v43
  v_add_u32 v7, 8, v2
  v_xor_b32 v7, v7, v3
  v_lshl_add_u32 v44, v7, 4, v6
  v_add_u32 v45, 0x10000, v44
  v_add_u32 v52, s5, v44
  v_add_u32 v53, s5, v45
  v_add_u32 v7, 12, v2
  v_xor_b32 v7, v7, v3
  v_lshl_add_u32 v46, v7, 4, v6
  v_add_u32 v47, 0x10000, v46
  v_add_u32 v54, s5, v46
  v_add_u32 v55, s5, v47
  s_waitcnt vmcnt(16)
  s_barrier
  ds_read_b128 a[192:195], v41 offset:32768
  ds_read_b128 a[196:199], v43 offset:32768
  ds_read_b128 a[200:203], v45 offset:32768
  ds_read_b128 a[204:207], v47 offset:32768
  ds_read_b128 a[208:211], v41 offset:33024
  ds_read_b128 a[212:215], v43 offset:33024
  ds_read_b128 a[216:219], v45 offset:33024
  s_waitcnt lgkmcnt(6)
  v_mfma_f32_16x16x32_bf16 v[216:219], a[192:195], a[0:3], 0
  v_mfma_f32_16x16x32_bf16 v[220:223], a[192:195], a[32:35], 0
  ds_read_b128 a[220:223], v47 offset:33024
  s_waitcnt lgkmcnt(6)
  v_mfma_f32_16x16x32_bf16 v[216:219], a[196:199], a[4:7], v[216:219]
  v_mfma_f32_16x16x32_bf16 v[220:223], a[196:199], a[36:39], v[220:223]
  s_waitcnt lgkmcnt(5)
  v_mfma_f32_16x16x32_bf16 v[216:219], a[200:203], a[8:11], v[216:219]
  v_mfma_f32_16x16x32_bf16 v[220:223], a[200:203], a[40:43], v[220:223]
  s_waitcnt lgkmcnt(4)
  v_mfma_f32_16x16x32_bf16 v[216:219], a[204:207], a[12:15], v[216:219]
  s_add_u32 s31, s43, 3
  s_and_b32 s31, s31, 7
  s_lshl_b32 s31, s31, 15
  v_mfma_f32_16x16x32_bf16 v[220:223], a[204:207], a[44:47], v[220:223]
  s_waitcnt lgkmcnt(3)
  v_mfma_f32_16x16x32_bf16 v[216:219], a[208:211], a[16:19], v[216:219]
  v_mfma_f32_16x16x32_bf16 v[220:223], a[208:211], a[48:51], v[220:223]
  s_waitcnt lgkmcnt(2)
  v_mfma_f32_16x16x32_bf16 v[216:219], a[212:215], a[20:23], v[216:219]
  v_mfma_f32_16x16x32_bf16 v[220:223], a[212:215], a[52:55], v[220:223]
  s_waitcnt lgkmcnt(1)
  v_mfma_f32_16x16x32_bf16 v[216:219], a[216:219], a[24:27], v[216:219]
  v_mfma_f32_16x16x32_bf16 v[220:223], a[216:219], a[56:59], v[220:223]
  s_add_u32 m0, s29, 65536
  s_nop 0
  buffer_load_dwordx4 v16, s[8:11], s31 offen nt lds
  s_waitcnt lgkmcnt(0)
  v_mfma_f32_16x16x32_bf16 v[216:219], a[220:223], a[28:31], v[216:219]
  v_mfma_f32_16x16x32_bf16 v[220:223], a[220:223], a[60:63], v[220:223]
  ds_read_b128 a[224:227], v41 offset:40960
  ds_read_b128 a[228:231], v43 offset:40960
  ds_read_b128 a[232:235], v45 offset:40960
  ds_read_b128 a[236:239], v47 offset:40960
  ds_read_b128 a[240:243], v41 offset:41216
  ds_read_b128 a[244:247], v43 offset:41216
  ds_read_b128 a[248:251], v45 offset:41216
  s_waitcnt lgkmcnt(6)
  v_mfma_f32_16x16x32_bf16 v[224:227], a[224:227], a[0:3], 0
  v_max_f32 v31, v216, v217
  v_max3_f32 v31, v31, v218, v219
  v_mfma_f32_16x16x32_bf16 v[228:231], a[224:227], a[32:35], 0
  v_cvt_pk_bf16_f32 v72, v216, v217
  v_cvt_pk_bf16_f32 v73, v218, v219
  ds_read_b128 a[252:255], v47 offset:41216
  s_waitcnt lgkmcnt(6)
  v_mfma_f32_16x16x32_bf16 v[224:227], a[228:231], a[4:7], v[224:227]
  v_max_f32 v32, v220, v221
  v_max3_f32 v32, v32, v222, v223
  v_mfma_f32_16x16x32_bf16 v[228:231], a[228:231], a[36:39], v[228:231]
  v_cvt_pk_bf16_f32 v136, v220, v221
  v_cvt_pk_bf16_f32 v137, v222, v223
  s_waitcnt lgkmcnt(5)
  v_mfma_f32_16x16x32_bf16 v[224:227], a[232:235], a[8:11], v[224:227]
  s_add_u32 m0, s29, 66560
  s_nop 0
  buffer_load_dwordx4 v17, s[8:11], s31 offen nt lds
  v_mfma_f32_16x16x32_bf16 v[228:231], a[232:235], a[40:43], v[228:231]
  s_waitcnt lgkmcnt(4)
  v_mfma_f32_16x16x32_bf16 v[224:227], a[236:239], a[12:15], v[224:227]
  v_mfma_f32_16x16x32_bf16 v[228:231], a[236:239], a[44:47], v[228:231]
  s_waitcnt lgkmcnt(3)
  v_mfma_f32_16x16x32_bf16 v[224:227], a[240:243], a[16:19], v[224:227]
  v_mfma_f32_16x16x32_bf16 v[228:231], a[240:243], a[48:51], v[228:231]
  s_waitcnt lgkmcnt(2)
  v_mfma_f32_16x16x32_bf16 v[224:227], a[244:247], a[20:23], v[224:227]
  v_mfma_f32_16x16x32_bf16 v[228:231], a[244:247], a[52:55], v[228:231]
  s_add_u32 m0, s29, 67584
  s_nop 0
  buffer_load_dwordx4 v18, s[8:11], s31 offen nt lds
  s_waitcnt lgkmcnt(1)
  v_mfma_f32_16x16x32_bf16 v[224:227], a[248:251], a[24:27], v[224:227]
  v_mfma_f32_16x16x32_bf16 v[228:231], a[248:251], a[56:59], v[228:231]
  s_waitcnt lgkmcnt(0)
  v_mfma_f32_16x16x32_bf16 v[224:227], a[252:255], a[28:31], v[224:227]
  v_mfma_f32_16x16x32_bf16 v[228:231], a[252:255], a[60:63], v[228:231]
  ds_read_b128 a[192:195], v41 offset:49152
  ds_read_b128 a[196:199], v43 offset:49152
  ds_read_b128 a[200:203], v45 offset:49152
  ds_read_b128 a[204:207], v47 offset:49152
  ds_read_b128 a[208:211], v41 offset:49408
  ds_read_b128 a[212:215], v43 offset:49408
  ds_read_b128 a[216:219], v45 offset:49408
  s_waitcnt lgkmcnt(6)
  v_mfma_f32_16x16x32_bf16 v[216:219], a[192:195], a[0:3], 0
  v_max3_f32 v31, v31, v224, v225
  v_max3_f32 v31, v31, v226, v227
  v_mfma_f32_16x16x32_bf16 v[220:223], a[192:195], a[32:35], 0
  v_cvt_pk_bf16_f32 v74, v224, v225
  v_cvt_pk_bf16_f32 v75, v226, v227
  ds_read_b128 a[220:223], v47 offset:49408
  s_waitcnt lgkmcnt(6)
  v_mfma_f32_16x16x32_bf16 v[216:219], a[196:199], a[4:7], v[216:219]
  v_max3_f32 v32, v32, v228, v229
  v_max3_f32 v32, v32, v230, v231
  s_add_u32 m0, s29, 68608
  s_nop 0
  buffer_load_dwordx4 v19, s[8:11], s31 offen nt lds
  v_mfma_f32_16x16x32_bf16 v[220:223], a[196:199], a[36:39], v[220:223]
  v_cvt_pk_bf16_f32 v138, v228, v229
  v_cvt_pk_bf16_f32 v139, v230, v231
  s_waitcnt lgkmcnt(5)
  v_mfma_f32_16x16x32_bf16 v[216:219], a[200:203], a[8:11], v[216:219]
  v_mfma_f32_16x16x32_bf16 v[220:223], a[200:203], a[40:43], v[220:223]
  s_waitcnt lgkmcnt(4)
  v_mfma_f32_16x16x32_bf16 v[216:219], a[204:207], a[12:15], v[216:219]
  v_mfma_f32_16x16x32_bf16 v[220:223], a[204:207], a[44:47], v[220:223]
  s_waitcnt lgkmcnt(3)
  v_mfma_f32_16x16x32_bf16 v[216:219], a[208:211], a[16:19], v[216:219]
  v_mfma_f32_16x16x32_bf16 v[220:223], a[208:211], a[48:51], v[220:223]
  s_add_u32 m0, s29, 69632
  s_nop 0
  buffer_load_dwordx4 v20, s[8:11], s31 offen nt lds
  s_waitcnt lgkmcnt(2)
  v_mfma_f32_16x16x32_bf16 v[216:219], a[212:215], a[20:23], v[216:219]
  v_mfma_f32_16x16x32_bf16 v[220:223], a[212:215], a[52:55], v[220:223]
  s_waitcnt lgkmcnt(1)
  v_mfma_f32_16x16x32_bf16 v[216:219], a[216:219], a[24:27], v[216:219]
  v_mfma_f32_16x16x32_bf16 v[220:223], a[216:219], a[56:59], v[220:223]
  s_waitcnt lgkmcnt(0)
  v_mfma_f32_16x16x32_bf16 v[216:219], a[220:223], a[28:31], v[216:219]
  v_mfma_f32_16x16x32_bf16 v[220:223], a[220:223], a[60:63], v[220:223]
  ds_read_b128 a[224:227], v41 offset:57344
  ds_read_b128 a[228:231], v43 offset:57344
  ds_read_b128 a[232:235], v45 offset:57344
  ds_read_b128 a[236:239], v47 offset:57344
  ds_read_b128 a[240:243], v41 offset:57600
  ds_read_b128 a[244:247], v43 offset:57600
  ds_read_b128 a[248:251], v45 offset:57600
  s_waitcnt lgkmcnt(6)
  v_mfma_f32_16x16x32_bf16 v[224:227], a[224:227], a[0:3], 0
  v_max3_f32 v31, v31, v216, v217
  v_max3_f32 v31, v31, v218, v219
  s_add_u32 m0, s29, 70656
  s_nop 0
  buffer_load_dwordx4 v21, s[8:11], s31 offen nt lds
  v_mfma_f32_16x16x32_bf16 v[228:231], a[224:227], a[32:35], 0
  v_cvt_pk_bf16_f32 v76, v216, v217
  v_cvt_pk_bf16_f32 v77, v218, v219
  ds_read_b128 a[252:255], v47 offset:57600
  s_waitcnt lgkmcnt(6)
  v_mfma_f32_16x16x32_bf16 v[224:227], a[228:231], a[4:7], v[224:227]
  v_max3_f32 v32, v32, v220, v221
  v_max3_f32 v32, v32, v222, v223
  v_mfma_f32_16x16x32_bf16 v[228:231], a[228:231], a[36:39], v[228:231]
  v_cvt_pk_bf16_f32 v140, v220, v221
  v_cvt_pk_bf16_f32 v141, v222, v223
  s_waitcnt lgkmcnt(5)
  v_mfma_f32_16x16x32_bf16 v[224:227], a[232:235], a[8:11], v[224:227]
  v_mfma_f32_16x16x32_bf16 v[228:231], a[232:235], a[40:43], v[228:231]
  s_waitcnt lgkmcnt(4)
  v_mfma_f32_16x16x32_bf16 v[224:227], a[236:239], a[12:15], v[224:227]
  v_mfma_f32_16x16x32_bf16 v[228:231], a[236:239], a[44:47], v[228:231]
  s_add_u32 m0, s29, 71680
  s_nop 0
  buffer_load_dwordx4 v22, s[8:11], s31 offen nt lds
  s_waitcnt lgkmcnt(3)
  v_mfma_f32_16x16x32_bf16 v[224:227], a[240:243], a[16:19], v[224:227]
  v_mfma_f32_16x16x32_bf16 v[228:231], a[240:243], a[48:51], v[228:231]
  s_waitcnt lgkmcnt(2)
  v_mfma_f32_16x16x32_bf16 v[224:227], a[244:247], a[20:23], v[224:227]
  v_mfma_f32_16x16x32_bf16 v[228:231], a[244:247], a[52:55], v[228:231]
  s_waitcnt lgkmcnt(1)
  v_mfma_f32_16x16x32_bf16 v[224:227], a[248:251], a[24:27], v[224:227]
  v_mfma_f32_16x16x32_bf16 v[228:231], a[248:251], a[56:59], v[228:231]
  s_waitcnt lgkmcnt(0)
  v_mfma_f32_16x16x32_bf16 v[224:227], a[252:255], a[28:31], v[224:227]
  s_add_u32 m0, s29, 72704
  s_nop 0
  buffer_load_dwordx4 v23, s[8:11], s31 offen nt lds
  v_mfma_f32_16x16x32_bf16 v[228:231], a[252:255], a[60:63], v[228:231]
  ds_read_b128 a[192:195], v49 offset:32768
  ds_read_b128 a[196:199], v51 offset:32768
  ds_read_b128 a[200:203], v53 offset:32768
  ds_read_b128 a[204:207], v55 offset:32768
  ds_read_b128 a[208:211], v49 offset:33024
  ds_read_b128 a[212:215], v51 offset:33024
  ds_read_b128 a[216:219], v53 offset:33024
  s_waitcnt lgkmcnt(6)
  v_mfma_f32_16x16x32_bf16 v[232:235], a[192:195], a[64:67], 0
  v_max3_f32 v31, v31, v224, v225
  v_max3_f32 v31, v31, v226, v227
  ds_read_b128 a[220:223], v55 offset:33024
  s_waitcnt lgkmcnt(6)
  v_mfma_f32_16x16x32_bf16 v[232:235], a[196:199], a[68:71], v[232:235]
  v_cvt_pk_bf16_f32 v78, v224, v225
  v_cvt_pk_bf16_f32 v79, v226, v227
  s_waitcnt lgkmcnt(5)
  v_mfma_f32_16x16x32_bf16 v[232:235], a[200:203], a[72:75], v[232:235]
  v_max3_f32 v32, v32, v228, v229
  v_max3_f32 v32, v32, v230, v231
  s_waitcnt lgkmcnt(4)
  v_mfma_f32_16x16x32_bf16 v[232:235], a[204:207], a[76:79], v[232:235]
  v_cvt_pk_bf16_f32 v142, v228, v229
  v_cvt_pk_bf16_f32 v143, v230, v231
  s_waitcnt lgkmcnt(3)
  v_mfma_f32_16x16x32_bf16 v[232:235], a[208:211], a[80:83], v[232:235]
  s_waitcnt lgkmcnt(2)
  v_mfma_f32_16x16x32_bf16 v[232:235], a[212:215], a[84:87], v[232:235]
  s_waitcnt lgkmcnt(1)
  v_mfma_f32_16x16x32_bf16 v[232:235], a[216:219], a[88:91], v[232:235]
  s_waitcnt lgkmcnt(0)
  v_mfma_f32_16x16x32_bf16 v[232:235], a[220:223], a[92:95], v[232:235]
  s_waitcnt vmcnt(16)
  s_barrier
  ds_read_b128 a[224:227], v40 offset:0
  ds_read_b128 a[228:231], v42 offset:0
  ds_read_b128 a[232:235], v44 offset:0
  ds_read_b128 a[236:239], v46 offset:0
  ds_read_b128 a[240:243], v40 offset:256
  ds_read_b128 a[244:247], v42 offset:256
  ds_read_b128 a[248:251], v44 offset:256
  s_waitcnt lgkmcnt(6)
  v_mfma_f32_16x16x32_bf16 v[216:219], a[224:227], a[0:3], 0
  v_max_f32 v33, v232, v233
  v_max3_f32 v33, v33, v234, v235
  v_mfma_f32_16x16x32_bf16 v[220:223], a[224:227], a[32:35], 0
  v_cvt_pk_bf16_f32 v200, v232, v233
  v_cvt_pk_bf16_f32 v201, v234, v235
  ds_read_b128 a[252:255], v46 offset:256
  s_waitcnt lgkmcnt(6)
  v_mfma_f32_16x16x32_bf16 v[216:219], a[228:231], a[4:7], v[216:219]
  v_mfma_f32_16x16x32_bf16 v[220:223], a[228:231], a[36:39], v[220:223]
  s_waitcnt lgkmcnt(5)
  v_mfma_f32_16x16x32_bf16 v[216:219], a[232:235], a[8:11], v[216:219]
  s_add_u32 s42, s43, 4
  s_and_b32 s42, s42, 7
  s_lshl_b32 s42, s42, 15
  v_mfma_f32_16x16x32_bf16 v[220:223], a[232:235], a[40:43], v[220:223]
  s_waitcnt lgkmcnt(4)
  v_mfma_f32_16x16x32_bf16 v[216:219], a[236:239], a[12:15], v[216:219]
  v_mfma_f32_16x16x32_bf16 v[220:223], a[236:239], a[44:47], v[220:223]
  s_waitcnt lgkmcnt(3)
  v_mfma_f32_16x16x32_bf16 v[216:219], a[240:243], a[16:19], v[216:219]
  v_mfma_f32_16x16x32_bf16 v[220:223], a[240:243], a[48:51], v[220:223]
  s_waitcnt lgkmcnt(2)
  v_mfma_f32_16x16x32_bf16 v[216:219], a[244:247], a[20:23], v[216:219]
  v_mfma_f32_16x16x32_bf16 v[220:223], a[244:247], a[52:55], v[220:223]
  s_add_u32 m0, s29, 98304
  s_nop 0
  buffer_load_dwordx4 v16, s[8:11], s42 offen nt lds
  s_waitcnt lgkmcnt(1)
  v_mfma_f32_16x16x32_bf16 v[216:219], a[248:251], a[24:27], v[216:219]
  v_mfma_f32_16x16x32_bf16 v[220:223], a[248:251], a[56:59], v[220:223]
  s_waitcnt lgkmcnt(0)
  v_mfma_f32_16x16x32_bf16 v[216:219], a[252:255], a[28:31], v[216:219]
  v_mfma_f32_16x16x32_bf16 v[220:223], a[252:255], a[60:63], v[220:223]
  ds_read_b128 a[192:195], v40 offset:8192
  ds_read_b128 a[196:199], v42 offset:8192
  ds_read_b128 a[200:203], v44 offset:8192
  ds_read_b128 a[204:207], v46 offset:8192
  ds_read_b128 a[208:211], v40 offset:8448
  ds_read_b128 a[212:215], v42 offset:8448
  ds_read_b128 a[216:219], v44 offset:8448
  s_waitcnt lgkmcnt(6)
  v_mfma_f32_16x16x32_bf16 v[224:227], a[192:195], a[0:3], 0
  v_max3_f32 v31, v31, v216, v217
  v_max3_f32 v31, v31, v218, v219
  v_mfma_f32_16x16x32_bf16 v[228:231], a[192:195], a[32:35], 0
  v_cvt_pk_bf16_f32 v80, v216, v217
  v_cvt_pk_bf16_f32 v81, v218, v219
  ds_read_b128 a[220:223], v46 offset:8448
  s_waitcnt lgkmcnt(6)
  v_mfma_f32_16x16x32_bf16 v[224:227], a[196:199], a[4:7], v[224:227]
  v_max3_f32 v32, v32, v220, v221
  v_max3_f32 v32, v32, v222, v223
  s_add_u32 m0, s29, 99328
  s_nop 0
  buffer_load_dwordx4 v17, s[8:11], s42 offen nt lds
  v_mfma_f32_16x16x32_bf16 v[228:231], a[196:199], a[36:39], v[228:231]
  v_cvt_pk_bf16_f32 v144, v220, v221
  v_cvt_pk_bf16_f32 v145, v222, v223
  s_waitcnt lgkmcnt(5)
  v_mfma_f32_16x16x32_bf16 v[224:227], a[200:203], a[8:11], v[224:227]
  v_mfma_f32_16x16x32_bf16 v[228:231], a[200:203], a[40:43], v[228:231]
  s_waitcnt lgkmcnt(4)
  v_mfma_f32_16x16x32_bf16 v[224:227], a[204:207], a[12:15], v[224:227]
  v_mfma_f32_16x16x32_bf16 v[228:231], a[204:207], a[44:47], v[228:231]
  s_waitcnt lgkmcnt(3)
  v_mfma_f32_16x16x32_bf16 v[224:227], a[208:211], a[16:19], v[224:227]
  v_mfma_f32_16x16x32_bf16 v[228:231], a[208:211], a[48:51], v[228:231]
  s_add_u32 m0, s29, 100352
  s_nop 0
  buffer_load_dwordx4 v18, s[8:11], s42 offen nt lds
  s_waitcnt lgkmcnt(2)
  v_mfma_f32_16x16x32_bf16 v[224:227], a[212:215], a[20:23], v[224:227]
  v_mfma_f32_16x16x32_bf16 v[228:231], a[212:215], a[52:55], v[228:231]
  s_waitcnt lgkmcnt(1)
  v_mfma_f32_16x16x32_bf16 v[224:227], a[216:219], a[24:27], v[224:227]
  v_mfma_f32_16x16x32_bf16 v[228:231], a[216:219], a[56:59], v[228:231]
  s_waitcnt lgkmcnt(0)
  v_mfma_f32_16x16x32_bf16 v[224:227], a[220:223], a[28:31], v[224:227]
  v_mfma_f32_16x16x32_bf16 v[228:231], a[220:223], a[60:63], v[228:231]
  ds_read_b128 a[224:227], v40 offset:16384
  ds_read_b128 a[228:231], v42 offset:16384
  ds_read_b128 a[232:235], v44 offset:16384
  ds_read_b128 a[236:239], v46 offset:16384
  ds_read_b128 a[240:243], v40 offset:16640
  ds_read_b128 a[244:247], v42 offset:16640
  ds_read_b128 a[248:251], v44 offset:16640
  s_waitcnt lgkmcnt(6)
  v_mfma_f32_16x16x32_bf16 v[216:219], a[224:227], a[0:3], 0
  v_max3_f32 v31, v31, v224, v225
  v_max3_f32 v31, v31, v226, v227
  s_add_u32 m0, s29, 101376
  s_nop 0
  buffer_load_dwordx4 v19, s[8:11], s42 offen nt lds
  v_mfma_f32_16x16x32_bf16 v[220:223], a[224:227], a[32:35], 0
  v_cvt_pk_bf16_f32 v82, v224, v225
  v_cvt_pk_bf16_f32 v83, v226, v227
  ds_read_b128 a[252:255], v46 offset:16640
  s_waitcnt lgkmcnt(6)
  v_mfma_f32_16x16x32_bf16 v[216:219], a[228:231], a[4:7], v[216:219]
  v_max3_f32 v32, v32, v228, v229
  v_max3_f32 v32, v32, v230, v231
  v_mfma_f32_16x16x32_bf16 v[220:223], a[228:231], a[36:39], v[220:223]
  v_cvt_pk_bf16_f32 v146, v228, v229
  v_cvt_pk_bf16_f32 v147, v230, v231
  s_waitcnt lgkmcnt(5)
  v_mfma_f32_16x16x32_bf16 v[216:219], a[232:235], a[8:11], v[216:219]
  v_mfma_f32_16x16x32_bf16 v[220:223], a[232:235], a[40:43], v[220:223]
  s_waitcnt lgkmcnt(4)
  v_mfma_f32_16x16x32_bf16 v[216:219], a[236:239], a[12:15], v[216:219]
  v_mfma_f32_16x16x32_bf16 v[220:223], a[236:239], a[44:47], v[220:223]
  s_add_u32 m0, s29, 102400
  s_nop 0
  buffer_load_dwordx4 v20, s[8:11], s42 offen nt lds
  s_waitcnt lgkmcnt(3)
  v_mfma_f32_16x16x32_bf16 v[216:219], a[240:243], a[16:19], v[216:219]
  v_mfma_f32_16x16x32_bf16 v[220:223], a[240:243], a[48:51], v[220:223]
  s_waitcnt lgkmcnt(2)
  v_mfma_f32_16x16x32_bf16 v[216:219], a[244:247], a[20:23], v[216:219]
  v_mfma_f32_16x16x32_bf16 v[220:223], a[244:247], a[52:55], v[220:223]
  s_waitcnt lgkmcnt(1)
  v_mfma_f32_16x16x32_bf16 v[216:219], a[248:251], a[24:27], v[216:219]
  v_mfma_f32_16x16x32_bf16 v[220:223], a[248:251], a[56:59], v[220:223]
  s_waitcnt lgkmcnt(0)
  v_mfma_f32_16x16x32_bf16 v[216:219], a[252:255], a[28:31], v[216:219]
  s_add_u32 m0, s29, 103424
  s_nop 0
  buffer_load_dwordx4 v21, s[8:11], s42 offen nt lds
  v_mfma_f32_16x16x32_bf16 v[220:223], a[252:255], a[60:63], v[220:223]
  ds_read_b128 a[192:195], v40 offset:24576
  ds_read_b128 a[196:199], v42 offset:24576
  ds_read_b128 a[200:203], v44 offset:24576
  ds_read_b128 a[204:207], v46 offset:24576
  ds_read_b128 a[208:211], v40 offset:24832
  ds_read_b128 a[212:215], v42 offset:24832
  ds_read_b128 a[216:219], v44 offset:24832
  s_waitcnt lgkmcnt(6)
  v_mfma_f32_16x16x32_bf16 v[224:227], a[192:195], a[0:3], 0
  v_max3_f32 v31, v31, v216, v217
  v_max3_f32 v31, v31, v218, v219
  v_mfma_f32_16x16x32_bf16 v[228:231], a[192:195], a[32:35], 0
  v_cvt_pk_bf16_f32 v84, v216, v217
  v_cvt_pk_bf16_f32 v85, v218, v219
  ds_read_b128 a[220:223], v46 offset:24832
  s_waitcnt lgkmcnt(6)
  v_mfma_f32_16x16x32_bf16 v[224:227], a[196:199], a[4:7], v[224:227]
  v_max3_f32 v32, v32, v220, v221
  v_max3_f32 v32, v32, v222, v223
  v_mfma_f32_16x16x32_bf16 v[228:231], a[196:199], a[36:39], v[228:231]
  v_cvt_pk_bf16_f32 v148, v220, v221
  v_cvt_pk_bf16_f32 v149, v222, v223
  s_waitcnt lgkmcnt(5)
  v_mfma_f32_16x16x32_bf16 v[224:227], a[200:203], a[8:11], v[224:227]
  v_mfma_f32_16x16x32_bf16 v[228:231], a[200:203], a[40:43], v[228:231]
  s_add_u32 m0, s29, 104448
  s_nop 0
  buffer_load_dwordx4 v22, s[8:11], s42 offen nt lds
  s_waitcnt lgkmcnt(4)
  v_mfma_f32_16x16x32_bf16 v[224:227], a[204:207], a[12:15], v[224:227]
  v_mfma_f32_16x16x32_bf16 v[228:231], a[204:207], a[44:47], v[228:231]
  s_waitcnt lgkmcnt(3)
  v_mfma_f32_16x16x32_bf16 v[224:227], a[208:211], a[16:19], v[224:227]
  v_mfma_f32_16x16x32_bf16 v[228:231], a[208:211], a[48:51], v[228:231]
  s_waitcnt lgkmcnt(2)
  v_mfma_f32_16x16x32_bf16 v[224:227], a[212:215], a[20:23], v[224:227]
  v_mfma_f32_16x16x32_bf16 v[228:231], a[212:215], a[52:55], v[228:231]
  s_waitcnt lgkmcnt(1)
  v_mfma_f32_16x16x32_bf16 v[224:227], a[216:219], a[24:27], v[224:227]
  s_add_u32 m0, s29, 105472
  s_nop 0
  buffer_load_dwordx4 v23, s[8:11], s42 offen nt lds
  v_mfma_f32_16x16x32_bf16 v[228:231], a[216:219], a[56:59], v[228:231]
  s_waitcnt lgkmcnt(0)
  v_mfma_f32_16x16x32_bf16 v[224:227], a[220:223], a[28:31], v[224:227]
  v_mfma_f32_16x16x32_bf16 v[228:231], a[220:223], a[60:63], v[228:231]
  ds_read_b128 a[224:227], v48 offset:0
  ds_read_b128 a[228:231], v50 offset:0
  ds_read_b128 a[232:235], v52 offset:0
  ds_read_b128 a[236:239], v54 offset:0
  ds_read_b128 a[240:243], v48 offset:256
  ds_read_b128 a[244:247], v50 offset:256
  ds_read_b128 a[248:251], v52 offset:256
  s_waitcnt lgkmcnt(6)
  v_mfma_f32_16x16x32_bf16 v[232:235], a[224:227], a[64:67], 0
  v_max3_f32 v31, v31, v224, v225
  v_max3_f32 v31, v31, v226, v227
  ds_read_b128 a[252:255], v54 offset:256
  s_waitcnt lgkmcnt(6)
  v_mfma_f32_16x16x32_bf16 v[232:235], a[228:231], a[68:71], v[232:235]
  v_cvt_pk_bf16_f32 v86, v224, v225
  v_cvt_pk_bf16_f32 v87, v226, v227
  s_waitcnt lgkmcnt(5)
  v_mfma_f32_16x16x32_bf16 v[232:235], a[232:235], a[72:75], v[232:235]
  v_max3_f32 v32, v32, v228, v229
  v_max3_f32 v32, v32, v230, v231
  s_waitcnt lgkmcnt(4)
  v_mfma_f32_16x16x32_bf16 v[232:235], a[236:239], a[76:79], v[232:235]
  v_cvt_pk_bf16_f32 v150, v228, v229
  v_cvt_pk_bf16_f32 v151, v230, v231
  s_waitcnt lgkmcnt(3)
  v_mfma_f32_16x16x32_bf16 v[232:235], a[240:243], a[80:83], v[232:235]
  s_waitcnt lgkmcnt(2)
  v_mfma_f32_16x16x32_bf16 v[232:235], a[244:247], a[84:87], v[232:235]
  s_waitcnt lgkmcnt(1)
  v_mfma_f32_16x16x32_bf16 v[232:235], a[248:251], a[88:91], v[232:235]
  s_waitcnt lgkmcnt(0)
  v_mfma_f32_16x16x32_bf16 v[232:235], a[252:255], a[92:95], v[232:235]
  s_waitcnt vmcnt(16)
  s_barrier
  ds_read_b128 a[192:195], v40 offset:32768
  ds_read_b128 a[196:199], v42 offset:32768
  ds_read_b128 a[200:203], v44 offset:32768
  ds_read_b128 a[204:207], v46 offset:32768
  ds_read_b128 a[208:211], v40 offset:33024
  ds_read_b128 a[212:215], v42 offset:33024
  ds_read_b128 a[216:219], v44 offset:33024
  s_waitcnt lgkmcnt(6)
  v_mfma_f32_16x16x32_bf16 v[216:219], a[192:195], a[0:3], 0
  v_max3_f32 v33, v33, v232, v233
  v_max3_f32 v33, v33, v234, v235
  v_mfma_f32_16x16x32_bf16 v[220:223], a[192:195], a[32:35], 0
  v_cvt_pk_bf16_f32 v202, v232, v233
  v_cvt_pk_bf16_f32 v203, v234, v235
  ds_read_b128 a[220:223], v46 offset:33024
  s_waitcnt lgkmcnt(6)
  v_mfma_f32_16x16x32_bf16 v[216:219], a[196:199], a[4:7], v[216:219]
  s_add_u32 s31, s43, 5
  s_and_b32 s31, s31, 7
  s_lshl_b32 s31, s31, 15
  v_mfma_f32_16x16x32_bf16 v[220:223], a[196:199], a[36:39], v[220:223]
  s_waitcnt lgkmcnt(5)
  v_mfma_f32_16x16x32_bf16 v[216:219], a[200:203], a[8:11], v[216:219]
  v_mfma_f32_16x16x32_bf16 v[220:223], a[200:203], a[40:43], v[220:223]
  s_waitcnt lgkmcnt(4)
  v_mfma_f32_16x16x32_bf16 v[216:219], a[204:207], a[12:15], v[216:219]
  v_mfma_f32_16x16x32_bf16 v[220:223], a[204:207], a[44:47], v[220:223]
  s_waitcnt lgkmcnt(3)
  v_mfma_f32_16x16x32_bf16 v[216:219], a[208:211], a[16:19], v[216:219]
  v_mfma_f32_16x16x32_bf16 v[220:223], a[208:211], a[48:51], v[220:223]
  s_add_u32 m0, s29, 0
  s_nop 0
  buffer_load_dwordx4 v16, s[8:11], s31 offen nt lds
  s_waitcnt lgkmcnt(2)
  v_mfma_f32_16x16x32_bf16 v[216:219], a[212:215], a[20:23], v[216:219]
  v_mfma_f32_16x16x32_bf16 v[220:223], a[212:215], a[52:55], v[220:223]
  s_waitcnt lgkmcnt(1)
  v_mfma_f32_16x16x32_bf16 v[216:219], a[216:219], a[24:27], v[216:219]
  v_mfma_f32_16x16x32_bf16 v[220:223], a[216:219], a[56:59], v[220:223]
  s_waitcnt lgkmcnt(0)
  v_mfma_f32_16x16x32_bf16 v[216:219], a[220:223], a[28:31], v[216:219]
  v_mfma_f32_16x16x32_bf16 v[220:223], a[220:223], a[60:63], v[220:223]
  ds_read_b128 a[224:227], v40 offset:40960
  ds_read_b128 a[228:231], v42 offset:40960
  ds_read_b128 a[232:235], v44 offset:40960
  ds_read_b128 a[236:239], v46 offset:40960
  ds_read_b128 a[240:243], v40 offset:41216
  ds_read_b128 a[244:247], v42 offset:41216
  ds_read_b128 a[248:251], v44 offset:41216
  s_waitcnt lgkmcnt(6)
  v_mfma_f32_16x16x32_bf16 v[224:227], a[224:227], a[0:3], 0
  v_max3_f32 v31, v31, v216, v217
  v_max3_f32 v31, v31, v218, v219
  s_add_u32 m0, s29, 1024
  s_nop 0
  buffer_load_dwordx4 v17, s[8:11], s31 offen nt lds
  v_mfma_f32_16x16x32_bf16 v[228:231], a[224:227], a[32:35], 0
  v_cvt_pk_bf16_f32 v88, v216, v217
  v_cvt_pk_bf16_f32 v89, v218, v219
  ds_read_b128 a[252:255], v46 offset:41216
  s_waitcnt lgkmcnt(6)
  v_mfma_f32_16x16x32_bf16 v[224:227], a[228:231], a[4:7], v[224:227]
  v_max3_f32 v32, v32, v220, v221
  v_max3_f32 v32, v32, v222, v223
  v_mfma_f32_16x16x32_bf16 v[228:231], a[228:231], a[36:39], v[228:231]
  v_cvt_pk_bf16_f32 v152, v220, v221
  v_cvt_pk_bf16_f32 v153, v222, v223
  s_waitcnt lgkmcnt(5)
  v_mfma_f32_16x16x32_bf16 v[224:227], a[232:235], a[8:11], v[224:227]
  v_mfma_f32_16x16x32_bf16 v[228:231], a[232:235], a[40:43], v[228:231]
  s_waitcnt lgkmcnt(4)
  v_mfma_f32_16x16x32_bf16 v[224:227], a[236:239], a[12:15], v[224:227]
  v_mfma_f32_16x16x32_bf16 v[228:231], a[236:239], a[44:47], v[228:231]
  s_add_u32 m0, s29, 2048
  s_nop 0
  buffer_load_dwordx4 v18, s[8:11], s31 offen nt lds
  s_waitcnt lgkmcnt(3)
  v_mfma_f32_16x16x32_bf16 v[224:227], a[240:243], a[16:19], v[224:227]
  v_mfma_f32_16x16x32_bf16 v[228:231], a[240:243], a[48:51], v[228:231]
  s_waitcnt lgkmcnt(2)
  v_mfma_f32_16x16x32_bf16 v[224:227], a[244:247], a[20:23], v[224:227]
  v_mfma_f32_16x16x32_bf16 v[228:231], a[244:247], a[52:55], v[228:231]
  s_waitcnt lgkmcnt(1)
  v_mfma_f32_16x16x32_bf16 v[224:227], a[248:251], a[24:27], v[224:227]
  v_mfma_f32_16x16x32_bf16 v[228:231], a[248:251], a[56:59], v[228:231]
  s_waitcnt lgkmcnt(0)
  v_mfma_f32_16x16x32_bf16 v[224:227], a[252:255], a[28:31], v[224:227]
  s_add_u32 m0, s29, 3072
  s_nop 0
  buffer_load_dwordx4 v19, s[8:11], s31 offen nt lds
  v_mfma_f32_16x16x32_bf16 v[228:231], a[252:255], a[60:63], v[228:231]
  ds_read_b128 a[192:195], v40 offset:49152
  ds_read_b128 a[196:199], v42 offset:49152
  ds_read_b128 a[200:203], v44 offset:49152
  ds_read_b128 a[204:207], v46 offset:49152
  ds_read_b128 a[208:211], v40 offset:49408
  ds_read_b128 a[212:215], v42 offset:49408
  ds_read_b128 a[216:219], v44 offset:49408
  s_waitcnt lgkmcnt(6)
  v_mfma_f32_16x16x32_bf16 v[216:219], a[192:195], a[0:3], 0
  v_max3_f32 v31, v31, v224, v225
  v_max3_f32 v31, v31, v226, v227
  v_mfma_f32_16x16x32_bf16 v[220:223], a[192:195], a[32:35], 0
  v_cvt_pk_bf16_f32 v90, v224, v225
  v_cvt_pk_bf16_f32 v91, v226, v227
  ds_read_b128 a[220:223], v46 offset:49408
  s_waitcnt lgkmcnt(6)
  v_mfma_f32_16x16x32_bf16 v[216:219], a[196:199], a[4:7], v[216:219]
  v_max3_f32 v32, v32, v228, v229
  v_max3_f32 v32, v32, v230, v231
  v_mfma_f32_16x16x32_bf16 v[220:223], a[196:199], a[36:39], v[220:223]
  v_cvt_pk_bf16_f32 v154, v228, v229
  v_cvt_pk_bf16_f32 v155, v230, v231
  s_waitcnt lgkmcnt(5)
  v_mfma_f32_16x16x32_bf16 v[216:219], a[200:203], a[8:11], v[216:219]
  v_mfma_f32_16x16x32_bf16 v[220:223], a[200:203], a[40:43], v[220:223]
  s_add_u32 m0, s29, 4096
  s_nop 0
  buffer_load_dwordx4 v20, s[8:11], s31 offen nt lds
  s_waitcnt lgkmcnt(4)
  v_mfma_f32_16x16x32_bf16 v[216:219], a[204:207], a[12:15], v[216:219]
  v_mfma_f32_16x16x32_bf16 v[220:223], a[204:207], a[44:47], v[220:223]
  s_waitcnt lgkmcnt(3)
  v_mfma_f32_16x16x32_bf16 v[216:219], a[208:211], a[16:19], v[216:219]
  v_mfma_f32_16x16x32_bf16 v[220:223], a[208:211], a[48:51], v[220:223]
  s_waitcnt lgkmcnt(2)
  v_mfma_f32_16x16x32_bf16 v[216:219], a[212:215], a[20:23], v[216:219]
  v_mfma_f32_16x16x32_bf16 v[220:223], a[212:215], a[52:55], v[220:223]
  s_waitcnt lgkmcnt(1)
  v_mfma_f32_16x16x32_bf16 v[216:219], a[216:219], a[24:27], v[216:219]
  s_add_u32 m0, s29, 5120
  s_nop 0
  buffer_load_dwordx4 v21, s[8:11], s31 offen nt lds
  v_mfma_f32_16x16x32_bf16 v[220:223], a[216:219], a[56:59], v[220:223]
  s_waitcnt lgkmcnt(0)
  v_mfma_f32_16x16x32_bf16 v[216:219], a[220:223], a[28:31], v[216:219]
  v_mfma_f32_16x16x32_bf16 v[220:223], a[220:223], a[60:63], v[220:223]
  ds_read_b128 a[224:227], v40 offset:57344
  ds_read_b128 a[228:231], v42 offset:57344
  ds_read_b128 a[232:235], v44 offset:57344
  ds_read_b128 a[236:239], v46 offset:57344
  ds_read_b128 a[240:243], v40 offset:57600
  ds_read_b128 a[244:247], v42 offset:57600
  ds_read_b128 a[248:251], v44 offset:57600
  s_waitcnt lgkmcnt(6)
  v_mfma_f32_16x16x32_bf16 v[224:227], a[224:227], a[0:3], 0
  v_max3_f32 v31, v31, v216, v217
  v_max3_f32 v31, v31, v218, v219
  v_mfma_f32_16x16x32_bf16 v[228:231], a[224:227], a[32:35], 0
  v_cvt_pk_bf16_f32 v92, v216, v217
  v_cvt_pk_bf16_f32 v93, v218, v219
  ds_read_b128 a[252:255], v46 offset:57600
  s_waitcnt lgkmcnt(6)
  v_mfma_f32_16x16x32_bf16 v[224:227], a[228:231], a[4:7], v[224:227]
  v_max3_f32 v32, v32, v220, v221
  v_max3_f32 v32, v32, v222, v223
  v_mfma_f32_16x16x32_bf16 v[228:231], a[228:231], a[36:39], v[228:231]
  v_cvt_pk_bf16_f32 v156, v220, v221
  v_cvt_pk_bf16_f32 v157, v222, v223
  s_add_u32 m0, s29, 6144
  s_nop 0
  buffer_load_dwordx4 v22, s[8:11], s31 offen nt lds
  s_waitcnt lgkmcnt(5)
  v_mfma_f32_16x16x32_bf16 v[224:227], a[232:235], a[8:11], v[224:227]
  v_mfma_f32_16x16x32_bf16 v[228:231], a[232:235], a[40:43], v[228:231]
  s_waitcnt lgkmcnt(4)
  v_mfma_f32_16x16x32_bf16 v[224:227], a[236:239], a[12:15], v[224:227]
  v_mfma_f32_16x16x32_bf16 v[228:231], a[236:239], a[44:47], v[228:231]
  s_waitcnt lgkmcnt(3)
  v_mfma_f32_16x16x32_bf16 v[224:227], a[240:243], a[16:19], v[224:227]
  v_mfma_f32_16x16x32_bf16 v[228:231], a[240:243], a[48:51], v[228:231]
  s_waitcnt lgkmcnt(2)
  v_mfma_f32_16x16x32_bf16 v[224:227], a[244:247], a[20:23], v[224:227]
  s_add_u32 m0, s29, 7168
  s_nop 0
  buffer_load_dwordx4 v23, s[8:11], s31 offen nt lds
  v_mfma_f32_16x16x32_bf16 v[228:231], a[244:247], a[52:55], v[228:231]
  s_waitcnt lgkmcnt(1)
  v_mfma_f32_16x16x32_bf16 v[224:227], a[248:251], a[24:27], v[224:227]
  v_mfma_f32_16x16x32_bf16 v[228:231], a[248:251], a[56:59], v[228:231]
  s_waitcnt lgkmcnt(0)
  v_mfma_f32_16x16x32_bf16 v[224:227], a[252:255], a[28:31], v[224:227]
  v_mfma_f32_16x16x32_bf16 v[228:231], a[252:255], a[60:63], v[228:231]
  ds_read_b128 a[192:195], v48 offset:32768
  ds_read_b128 a[196:199], v50 offset:32768
  ds_read_b128 a[200:203], v52 offset:32768
  ds_read_b128 a[204:207], v54 offset:32768
  ds_read_b128 a[208:211], v48 offset:33024
  ds_read_b128 a[212:215], v50 offset:33024
  ds_read_b128 a[216:219], v52 offset:33024
  s_waitcnt lgkmcnt(6)
  v_mfma_f32_16x16x32_bf16 v[232:235], a[192:195], a[64:67], 0
  v_max3_f32 v31, v31, v224, v225
  v_max3_f32 v31, v31, v226, v227
  ds_read_b128 a[220:223], v54 offset:33024
  s_waitcnt lgkmcnt(6)
  v_mfma_f32_16x16x32_bf16 v[232:235], a[196:199], a[68:71], v[232:235]
  v_cvt_pk_bf16_f32 v94, v224, v225
  v_cvt_pk_bf16_f32 v95, v226, v227
  s_waitcnt lgkmcnt(5)
  v_mfma_f32_16x16x32_bf16 v[232:235], a[200:203], a[72:75], v[232:235]
  v_max3_f32 v32, v32, v228, v229
  v_max3_f32 v32, v32, v230, v231
  s_waitcnt lgkmcnt(4)
  v_mfma_f32_16x16x32_bf16 v[232:235], a[204:207], a[76:79], v[232:235]
  v_cvt_pk_bf16_f32 v158, v228, v229
  v_cvt_pk_bf16_f32 v159, v230, v231
  s_waitcnt lgkmcnt(3)
  v_mfma_f32_16x16x32_bf16 v[232:235], a[208:211], a[80:83], v[232:235]
  s_waitcnt lgkmcnt(2)
  v_mfma_f32_16x16x32_bf16 v[232:235], a[212:215], a[84:87], v[232:235]
  s_waitcnt lgkmcnt(1)
  v_mfma_f32_16x16x32_bf16 v[232:235], a[216:219], a[88:91], v[232:235]
  s_waitcnt lgkmcnt(0)
  v_mfma_f32_16x16x32_bf16 v[232:235], a[220:223], a[92:95], v[232:235]
  s_waitcnt vmcnt(16)
  s_barrier
  ds_read_b128 a[224:227], v41 offset:0
  ds_read_b128 a[228:231], v43 offset:0
  ds_read_b128 a[232:235], v45 offset:0
  ds_read_b128 a[236:239], v47 offset:0
  ds_read_b128 a[240:243], v41 offset:256
  ds_read_b128 a[244:247], v43 offset:256
  ds_read_b128 a[248:251], v45 offset:256
  s_waitcnt lgkmcnt(6)
  v_mfma_f32_16x16x32_bf16 v[216:219], a[224:227], a[0:3], 0
  v_max3_f32 v33, v33, v232, v233
  v_max3_f32 v33, v33, v234, v235
  s_add_u32 s42, s43, 6
  s_and_b32 s42, s42, 7
  s_lshl_b32 s42, s42, 15
  v_mfma_f32_16x16x32_bf16 v[220:223], a[224:227], a[32:35], 0
  v_cvt_pk_bf16_f32 v204, v232, v233
  v_cvt_pk_bf16_f32 v205, v234, v235
  ds_read_b128 a[252:255], v47 offset:256
  s_waitcnt lgkmcnt(6)
  v_mfma_f32_16x16x32_bf16 v[216:219], a[228:231], a[4:7], v[216:219]
  v_mfma_f32_16x16x32_bf16 v[220:223], a[228:231], a[36:39], v[220:223]
  s_waitcnt lgkmcnt(5)
  v_mfma_f32_16x16x32_bf16 v[216:219], a[232:235], a[8:11], v[216:219]
  v_mfma_f32_16x16x32_bf16 v[220:223], a[232:235], a[40:43], v[220:223]
  s_waitcnt lgkmcnt(4)
  v_mfma_f32_16x16x32_bf16 v[216:219], a[236:239], a[12:15], v[216:219]
  v_mfma_f32_16x16x32_bf16 v[220:223], a[236:239], a[44:47], v[220:223]
  s_add_u32 m0, s29, 32768
  s_nop 0
  buffer_load_dwordx4 v16, s[8:11], s42 offen nt lds
  s_waitcnt lgkmcnt(3)
  v_mfma_f32_16x16x32_bf16 v[216:219], a[240:243], a[16:19], v[216:219]
  v_mfma_f32_16x16x32_bf16 v[220:223], a[240:243], a[48:51], v[220:223]
  s_waitcnt lgkmcnt(2)
  v_mfma_f32_16x16x32_bf16 v[216:219], a[244:247], a[20:23], v[216:219]
  v_mfma_f32_16x16x32_bf16 v[220:223], a[244:247], a[52:55], v[220:223]
  s_waitcnt lgkmcnt(1)
  v_mfma_f32_16x16x32_bf16 v[216:219], a[248:251], a[24:27], v[216:219]
  v_mfma_f32_16x16x32_bf16 v[220:223], a[248:251], a[56:59], v[220:223]
  s_waitcnt lgkmcnt(0)
  v_mfma_f32_16x16x32_bf16 v[216:219], a[252:255], a[28:31], v[216:219]
  s_add_u32 m0, s29, 33792
  s_nop 0
  buffer_load_dwordx4 v17, s[8:11], s42 offen nt lds
  v_mfma_f32_16x16x32_bf16 v[220:223], a[252:255], a[60:63], v[220:223]
  ds_read_b128 a[192:195], v41 offset:8192
  ds_read_b128 a[196:199], v43 offset:8192
  ds_read_b128 a[200:203], v45 offset:8192
  ds_read_b128 a[204:207], v47 offset:8192
  ds_read_b128 a[208:211], v41 offset:8448
  ds_read_b128 a[212:215], v43 offset:8448
  ds_read_b128 a[216:219], v45 offset:8448
  s_waitcnt lgkmcnt(6)
  v_mfma_f32_16x16x32_bf16 v[224:227], a[192:195], a[0:3], 0
  v_max3_f32 v31, v31, v216, v217
  v_max3_f32 v31, v31, v218, v219
  v_mfma_f32_16x16x32_bf16 v[228:231], a[192:195], a[32:35], 0
  v_cvt_pk_bf16_f32 v96, v216, v217
  v_cvt_pk_bf16_f32 v97, v218, v219
  ds_read_b128 a[220:223], v47 offset:8448
  s_waitcnt lgkmcnt(6)
  v_mfma_f32_16x16x32_bf16 v[224:227], a[196:199], a[4:7], v[224:227]
  v_max3_f32 v32, v32, v220, v221
  v_max3_f32 v32, v32, v222, v223
  v_mfma_f32_16x16x32_bf16 v[228:231], a[196:199], a[36:39], v[228:231]
  v_cvt_pk_bf16_f32 v160, v220, v221
  v_cvt_pk_bf16_f32 v161, v222, v223
  s_waitcnt lgkmcnt(5)
  v_mfma_f32_16x16x32_bf16 v[224:227], a[200:203], a[8:11], v[224:227]
  v_mfma_f32_16x16x32_bf16 v[228:231], a[200:203], a[40:43], v[228:231]
  s_add_u32 m0, s29, 34816
  s_nop 0
  buffer_load_dwordx4 v18, s[8:11], s42 offen nt lds
  s_waitcnt lgkmcnt(4)
  v_mfma_f32_16x16x32_bf16 v[224:227], a[204:207], a[12:15], v[224:227]
  v_mfma_f32_16x16x32_bf16 v[228:231], a[204:207], a[44:47], v[228:231]
  s_waitcnt lgkmcnt(3)
  v_mfma_f32_16x16x32_bf16 v[224:227], a[208:211], a[16:19], v[224:227]
  v_mfma_f32_16x16x32_bf16 v[228:231], a[208:211], a[48:51], v[228:231]
  s_waitcnt lgkmcnt(2)
  v_mfma_f32_16x16x32_bf16 v[224:227], a[212:215], a[20:23], v[224:227]
  v_mfma_f32_16x16x32_bf16 v[228:231], a[212:215], a[52:55], v[228:231]
  s_waitcnt lgkmcnt(1)
  v_mfma_f32_16x16x32_bf16 v[224:227], a[216:219], a[24:27], v[224:227]
  s_add_u32 m0, s29, 35840
  s_nop 0
  buffer_load_dwordx4 v19, s[8:11], s42 offen nt lds
  v_mfma_f32_16x16x32_bf16 v[228:231], a[216:219], a[56:59], v[228:231]
  s_waitcnt lgkmcnt(0)
  v_mfma_f32_16x16x32_bf16 v[224:227], a[220:223], a[28:31], v[224:227]
  v_mfma_f32_16x16x32_bf16 v[228:231], a[220:223], a[60:63], v[228:231]
  ds_read_b128 a[224:227], v41 offset:16384
  ds_read_b128 a[228:231], v43 offset:16384
  ds_read_b128 a[232:235], v45 offset:16384
  ds_read_b128 a[236:239], v47 offset:16384
  ds_read_b128 a[240:243], v41 offset:16640
  ds_read_b128 a[244:247], v43 offset:16640
  ds_read_b128 a[248:251], v45 offset:16640
  s_waitcnt lgkmcnt(6)
  v_mfma_f32_16x16x32_bf16 v[216:219], a[224:227], a[0:3], 0
  v_max3_f32 v31, v31, v224, v225
  v_max3_f32 v31, v31, v226, v227
  v_mfma_f32_16x16x32_bf16 v[220:223], a[224:227], a[32:35], 0
  v_cvt_pk_bf16_f32 v98, v224, v225
  v_cvt_pk_bf16_f32 v99, v226, v227
  ds_read_b128 a[252:255], v47 offset:16640
  s_waitcnt lgkmcnt(6)
  v_mfma_f32_16x16x32_bf16 v[216:219], a[228:231], a[4:7], v[216:219]
  v_max3_f32 v32, v32, v228, v229
  v_max3_f32 v32, v32, v230, v231
  v_mfma_f32_16x16x32_bf16 v[220:223], a[228:231], a[36:39], v[220:223]
  v_cvt_pk_bf16_f32 v162, v228, v229
  v_cvt_pk_bf16_f32 v163, v230, v231
  s_add_u32 m0, s29, 36864
  s_nop 0
  buffer_load_dwordx4 v20, s[8:11], s42 offen nt lds
  s_waitcnt lgkmcnt(5)
  v_mfma_f32_16x16x32_bf16 v[216:219], a[232:235], a[8:11], v[216:219]
  v_mfma_f32_16x16x32_bf16 v[220:223], a[232:235], a[40:43], v[220:223]
  s_waitcnt lgkmcnt(4)
  v_mfma_f32_16x16x32_bf16 v[216:219], a[236:239], a[12:15], v[216:219]
  v_mfma_f32_16x16x32_bf16 v[220:223], a[236:239], a[44:47], v[220:223]
  s_waitcnt lgkmcnt(3)
  v_mfma_f32_16x16x32_bf16 v[216:219], a[240:243], a[16:19], v[216:219]
  v_mfma_f32_16x16x32_bf16 v[220:223], a[240:243], a[48:51], v[220:223]
  s_waitcnt lgkmcnt(2)
  v_mfma_f32_16x16x32_bf16 v[216:219], a[244:247], a[20:23], v[216:219]
  s_add_u32 m0, s29, 37888
  s_nop 0
  buffer_load_dwordx4 v21, s[8:11], s42 offen nt lds
  v_mfma_f32_16x16x32_bf16 v[220:223], a[244:247], a[52:55], v[220:223]
  s_waitcnt lgkmcnt(1)
  v_mfma_f32_16x16x32_bf16 v[216:219], a[248:251], a[24:27], v[216:219]
  v_mfma_f32_16x16x32_bf16 v[220:223], a[248:251], a[56:59], v[220:223]
  s_waitcnt lgkmcnt(0)
  v_mfma_f32_16x16x32_bf16 v[216:219], a[252:255], a[28:31], v[216:219]
  v_mfma_f32_16x16x32_bf16 v[220:223], a[252:255], a[60:63], v[220:223]
  ds_read_b128 a[192:195], v41 offset:24576
  ds_read_b128 a[196:199], v43 offset:24576
  ds_read_b128 a[200:203], v45 offset:24576
  ds_read_b128 a[204:207], v47 offset:24576
  ds_read_b128 a[208:211], v41 offset:24832
  ds_read_b128 a[212:215], v43 offset:24832
  ds_read_b128 a[216:219], v45 offset:24832
  s_waitcnt lgkmcnt(6)
  v_mfma_f32_16x16x32_bf16 v[224:227], a[192:195], a[0:3], 0
  v_max3_f32 v31, v31, v216, v217
  v_max3_f32 v31, v31, v218, v219
  v_mfma_f32_16x16x32_bf16 v[228:231], a[192:195], a[32:35], 0
  v_cvt_pk_bf16_f32 v100, v216, v217
  v_cvt_pk_bf16_f32 v101, v218, v219
  s_add_u32 m0, s29, 38912
  s_nop 0
  buffer_load_dwordx4 v22, s[8:11], s42 offen nt lds
  ds_read_b128 a[220:223], v47 offset:24832
  s_waitcnt lgkmcnt(6)
  v_mfma_f32_16x16x32_bf16 v[224:227], a[196:199], a[4:7], v[224:227]
  v_max3_f32 v32, v32, v220, v221
  v_max3_f32 v32, v32, v222, v223
  v_mfma_f32_16x16x32_bf16 v[228:231], a[196:199], a[36:39], v[228:231]
  v_cvt_pk_bf16_f32 v164, v220, v221
  v_cvt_pk_bf16_f32 v165, v222, v223
  s_waitcnt lgkmcnt(5)
  v_mfma_f32_16x16x32_bf16 v[224:227], a[200:203], a[8:11], v[224:227]
  v_mfma_f32_16x16x32_bf16 v[228:231], a[200:203], a[40:43], v[228:231]
  s_waitcnt lgkmcnt(4)
  v_mfma_f32_16x16x32_bf16 v[224:227], a[204:207], a[12:15], v[224:227]
  v_mfma_f32_16x16x32_bf16 v[228:231], a[204:207], a[44:47], v[228:231]
  s_waitcnt lgkmcnt(3)
  v_mfma_f32_16x16x32_bf16 v[224:227], a[208:211], a[16:19], v[224:227]
  s_add_u32 m0, s29, 39936
  s_nop 0
  buffer_load_dwordx4 v23, s[8:11], s42 offen nt lds
  v_mfma_f32_16x16x32_bf16 v[228:231], a[208:211], a[48:51], v[228:231]
  s_waitcnt lgkmcnt(2)
  v_mfma_f32_16x16x32_bf16 v[224:227], a[212:215], a[20:23], v[224:227]
  v_mfma_f32_16x16x32_bf16 v[228:231], a[212:215], a[52:55], v[228:231]
  s_waitcnt lgkmcnt(1)
  v_mfma_f32_16x16x32_bf16 v[224:227], a[216:219], a[24:27], v[224:227]
  v_mfma_f32_16x16x32_bf16 v[228:231], a[216:219], a[56:59], v[228:231]
  s_waitcnt lgkmcnt(0)
  v_mfma_f32_16x16x32_bf16 v[224:227], a[220:223], a[28:31], v[224:227]
  v_mfma_f32_16x16x32_bf16 v[228:231], a[220:223], a[60:63], v[228:231]
  ds_read_b128 a[224:227], v49 offset:0
  ds_read_b128 a[228:231], v51 offset:0
  ds_read_b128 a[232:235], v53 offset:0
  ds_read_b128 a[236:239], v55 offset:0
  ds_read_b128 a[240:243], v49 offset:256
  ds_read_b128 a[244:247], v51 offset:256
  ds_read_b128 a[248:251], v53 offset:256
  s_waitcnt lgkmcnt(6)
  v_mfma_f32_16x16x32_bf16 v[232:235], a[224:227], a[64:67], 0
  v_max3_f32 v31, v31, v224, v225
  v_max3_f32 v31, v31, v226, v227
  ds_read_b128 a[252:255], v55 offset:256
  s_waitcnt lgkmcnt(6)
  v_mfma_f32_16x16x32_bf16 v[232:235], a[228:231], a[68:71], v[232:235]
  v_cvt_pk_bf16_f32 v102, v224, v225
  v_cvt_pk_bf16_f32 v103, v226, v227
  s_waitcnt lgkmcnt(5)
  v_mfma_f32_16x16x32_bf16 v[232:235], a[232:235], a[72:75], v[232:235]
  v_max3_f32 v32, v32, v228, v229
  v_max3_f32 v32, v32, v230, v231
  s_waitcnt lgkmcnt(4)
  v_mfma_f32_16x16x32_bf16 v[232:235], a[236:239], a[76:79], v[232:235]
  v_cvt_pk_bf16_f32 v166, v228, v229
  v_cvt_pk_bf16_f32 v167, v230, v231
  s_waitcnt lgkmcnt(3)
  v_mfma_f32_16x16x32_bf16 v[232:235], a[240:243], a[80:83], v[232:235]
  s_waitcnt lgkmcnt(2)
  v_mfma_f32_16x16x32_bf16 v[232:235], a[244:247], a[84:87], v[232:235]
  s_waitcnt lgkmcnt(1)
  v_mfma_f32_16x16x32_bf16 v[232:235], a[248:251], a[88:91], v[232:235]
  s_waitcnt lgkmcnt(0)
  v_mfma_f32_16x16x32_bf16 v[232:235], a[252:255], a[92:95], v[232:235]
  s_waitcnt vmcnt(16)
  s_barrier
  ds_read_b128 a[192:195], v41 offset:32768
  ds_read_b128 a[196:199], v43 offset:32768
  ds_read_b128 a[200:203], v45 offset:32768
  ds_read_b128 a[204:207], v47 offset:32768
  ds_read_b128 a[208:211], v41 offset:33024
  ds_read_b128 a[212:215], v43 offset:33024
  ds_read_b128 a[216:219], v45 offset:33024
  s_waitcnt lgkmcnt(6)
  v_mfma_f32_16x16x32_bf16 v[216:219], a[192:195], a[0:3], 0
  v_max3_f32 v33, v33, v232, v233
  v_max3_f32 v33, v33, v234, v235
  v_mfma_f32_16x16x32_bf16 v[220:223], a[192:195], a[32:35], 0
  v_cvt_pk_bf16_f32 v206, v232, v233
  v_cvt_pk_bf16_f32 v207, v234, v235
  ds_read_b128 a[220:223], v47 offset:33024
  s_waitcnt lgkmcnt(6)
  v_mfma_f32_16x16x32_bf16 v[216:219], a[196:199], a[4:7], v[216:219]
  v_mfma_f32_16x16x32_bf16 v[220:223], a[196:199], a[36:39], v[220:223]
  s_waitcnt lgkmcnt(5)
  v_mfma_f32_16x16x32_bf16 v[216:219], a[200:203], a[8:11], v[216:219]
  v_mfma_f32_16x16x32_bf16 v[220:223], a[200:203], a[40:43], v[220:223]
  s_add_u32 s31, s43, 7
  s_and_b32 s31, s31, 7
  s_lshl_b32 s31, s31, 15
  s_waitcnt lgkmcnt(4)
  v_mfma_f32_16x16x32_bf16 v[216:219], a[204:207], a[12:15], v[216:219]
  v_mfma_f32_16x16x32_bf16 v[220:223], a[204:207], a[44:47], v[220:223]
  s_waitcnt lgkmcnt(3)
  v_mfma_f32_16x16x32_bf16 v[216:219], a[208:211], a[16:19], v[216:219]
  v_mfma_f32_16x16x32_bf16 v[220:223], a[208:211], a[48:51], v[220:223]
  s_waitcnt lgkmcnt(2)
  v_mfma_f32_16x16x32_bf16 v[216:219], a[212:215], a[20:23], v[216:219]
  v_mfma_f32_16x16x32_bf16 v[220:223], a[212:215], a[52:55], v[220:223]
  s_waitcnt lgkmcnt(1)
  v_mfma_f32_16x16x32_bf16 v[216:219], a[216:219], a[24:27], v[216:219]
  s_add_u32 m0, s29, 65536
  s_nop 0
  buffer_load_dwordx4 v16, s[8:11], s31 offen nt lds
  v_mfma_f32_16x16x32_bf16 v[220:223], a[216:219], a[56:59], v[220:223]
  s_waitcnt lgkmcnt(0)
  v_mfma_f32_16x16x32_bf16 v[216:219], a[220:223], a[28:31], v[216:219]
  v_mfma_f32_16x16x32_bf16 v[220:223], a[220:223], a[60:63], v[220:223]
  ds_read_b128 a[224:227], v41 offset:40960
  ds_read_b128 a[228:231], v43 offset:40960
  ds_read_b128 a[232:235], v45 offset:40960
  ds_read_b128 a[236:239], v47 offset:40960
  ds_read_b128 a[240:243], v41 offset:41216
  ds_read_b128 a[244:247], v43 offset:41216
  ds_read_b128 a[248:251], v45 offset:41216
  s_waitcnt lgkmcnt(6)
  v_mfma_f32_16x16x32_bf16 v[224:227], a[224:227], a[0:3], 0
  v_max3_f32 v31, v31, v216, v217
  v_max3_f32 v31, v31, v218, v219
  v_mfma_f32_16x16x32_bf16 v[228:231], a[224:227], a[32:35], 0
  v_cvt_pk_bf16_f32 v104, v216, v217
  v_cvt_pk_bf16_f32 v105, v218, v219
  ds_read_b128 a[252:255], v47 offset:41216
  s_waitcnt lgkmcnt(6)
  v_mfma_f32_16x16x32_bf16 v[224:227], a[228:231], a[4:7], v[224:227]
  v_max3_f32 v32, v32, v220, v221
  v_max3_f32 v32, v32, v222, v223
  v_mfma_f32_16x16x32_bf16 v[228:231], a[228:231], a[36:39], v[228:231]
  v_cvt_pk_bf16_f32 v168, v220, v221
  v_cvt_pk_bf16_f32 v169, v222, v223
  s_add_u32 m0, s29, 66560
  s_nop 0
  buffer_load_dwordx4 v17, s[8:11], s31 offen nt lds
  s_waitcnt lgkmcnt(5)
  v_mfma_f32_16x16x32_bf16 v[224:227], a[232:235], a[8:11], v[224:227]
  v_mfma_f32_16x16x32_bf16 v[228:231], a[232:235], a[40:43], v[228:231]
  s_waitcnt lgkmcnt(4)
  v_mfma_f32_16x16x32_bf16 v[224:227], a[236:239], a[12:15], v[224:227]
  v_mfma_f32_16x16x32_bf16 v[228:231], a[236:239], a[44:47], v[228:231]
  s_waitcnt lgkmcnt(3)
  v_mfma_f32_16x16x32_bf16 v[224:227], a[240:243], a[16:19], v[224:227]
  v_mfma_f32_16x16x32_bf16 v[228:231], a[240:243], a[48:51], v[228:231]
  s_waitcnt lgkmcnt(2)
  v_mfma_f32_16x16x32_bf16 v[224:227], a[244:247], a[20:23], v[224:227]
  s_add_u32 m0, s29, 67584
  s_nop 0
  buffer_load_dwordx4 v18, s[8:11], s31 offen nt lds
  v_mfma_f32_16x16x32_bf16 v[228:231], a[244:247], a[52:55], v[228:231]
  s_waitcnt lgkmcnt(1)
  v_mfma_f32_16x16x32_bf16 v[224:227], a[248:251], a[24:27], v[224:227]
  v_mfma_f32_16x16x32_bf16 v[228:231], a[248:251], a[56:59], v[228:231]
  s_waitcnt lgkmcnt(0)
  v_mfma_f32_16x16x32_bf16 v[224:227], a[252:255], a[28:31], v[224:227]
  v_mfma_f32_16x16x32_bf16 v[228:231], a[252:255], a[60:63], v[228:231]
  ds_read_b128 a[192:195], v41 offset:49152
  ds_read_b128 a[196:199], v43 offset:49152
  ds_read_b128 a[200:203], v45 offset:49152
  ds_read_b128 a[204:207], v47 offset:49152
  ds_read_b128 a[208:211], v41 offset:49408
  ds_read_b128 a[212:215], v43 offset:49408
  ds_read_b128 a[216:219], v45 offset:49408
  s_waitcnt lgkmcnt(6)
  v_mfma_f32_16x16x32_bf16 v[216:219], a[192:195], a[0:3], 0
  v_max3_f32 v31, v31, v224, v225
  v_max3_f32 v31, v31, v226, v227
  v_mfma_f32_16x16x32_bf16 v[220:223], a[192:195], a[32:35], 0
  v_cvt_pk_bf16_f32 v106, v224, v225
  v_cvt_pk_bf16_f32 v107, v226, v227
  s_add_u32 m0, s29, 68608
  s_nop 0
  buffer_load_dwordx4 v19, s[8:11], s31 offen nt lds
  ds_read_b128 a[220:223], v47 offset:49408
  s_waitcnt lgkmcnt(6)
  v_mfma_f32_16x16x32_bf16 v[216:219], a[196:199], a[4:7], v[216:219]
  v_max3_f32 v32, v32, v228, v229
  v_max3_f32 v32, v32, v230, v231
  v_mfma_f32_16x16x32_bf16 v[220:223], a[196:199], a[36:39], v[220:223]
  v_cvt_pk_bf16_f32 v170, v228, v229
  v_cvt_pk_bf16_f32 v171, v230, v231
  s_waitcnt lgkmcnt(5)
  v_mfma_f32_16x16x32_bf16 v[216:219], a[200:203], a[8:11], v[216:219]
  v_mfma_f32_16x16x32_bf16 v[220:223], a[200:203], a[40:43], v[220:223]
  s_waitcnt lgkmcnt(4)
  v_mfma_f32_16x16x32_bf16 v[216:219], a[204:207], a[12:15], v[216:219]
  v_mfma_f32_16x16x32_bf16 v[220:223], a[204:207], a[44:47], v[220:223]
  s_waitcnt lgkmcnt(3)
  v_mfma_f32_16x16x32_bf16 v[216:219], a[208:211], a[16:19], v[216:219]
  s_add_u32 m0, s29, 69632
  s_nop 0
  buffer_load_dwordx4 v20, s[8:11], s31 offen nt lds
  v_mfma_f32_16x16x32_bf16 v[220:223], a[208:211], a[48:51], v[220:223]
  s_waitcnt lgkmcnt(2)
  v_mfma_f32_16x16x32_bf16 v[216:219], a[212:215], a[20:23], v[216:219]
  v_mfma_f32_16x16x32_bf16 v[220:223], a[212:215], a[52:55], v[220:223]
  s_waitcnt lgkmcnt(1)
  v_mfma_f32_16x16x32_bf16 v[216:219], a[216:219], a[24:27], v[216:219]
  v_mfma_f32_16x16x32_bf16 v[220:223], a[216:219], a[56:59], v[220:223]
  s_waitcnt lgkmcnt(0)
  v_mfma_f32_16x16x32_bf16 v[216:219], a[220:223], a[28:31], v[216:219]
  v_mfma_f32_16x16x32_bf16 v[220:223], a[220:223], a[60:63], v[220:223]
  s_add_u32 m0, s29, 70656
  s_nop 0
  buffer_load_dwordx4 v21, s[8:11], s31 offen nt lds
  ds_read_b128 a[224:227], v41 offset:57344
  ds_read_b128 a[228:231], v43 offset:57344
  ds_read_b128 a[232:235], v45 offset:57344
  ds_read_b128 a[236:239], v47 offset:57344
  ds_read_b128 a[240:243], v41 offset:57600
  ds_read_b128 a[244:247], v43 offset:57600
  ds_read_b128 a[248:251], v45 offset:57600
  s_waitcnt lgkmcnt(6)
  v_mfma_f32_16x16x32_bf16 v[224:227], a[224:227], a[0:3], 0
  v_max3_f32 v31, v31, v216, v217
  v_max3_f32 v31, v31, v218, v219
  v_mfma_f32_16x16x32_bf16 v[228:231], a[224:227], a[32:35], 0
  v_cvt_pk_bf16_f32 v108, v216, v217
  v_cvt_pk_bf16_f32 v109, v218, v219
  ds_read_b128 a[252:255], v47 offset:57600
  s_waitcnt lgkmcnt(6)
  v_mfma_f32_16x16x32_bf16 v[224:227], a[228:231], a[4:7], v[224:227]
  v_max3_f32 v32, v32, v220, v221
  v_max3_f32 v32, v32, v222, v223
  v_mfma_f32_16x16x32_bf16 v[228:231], a[228:231], a[36:39], v[228:231]
  v_cvt_pk_bf16_f32 v172, v220, v221
  v_cvt_pk_bf16_f32 v173, v222, v223
  s_waitcnt lgkmcnt(5)
  v_mfma_f32_16x16x32_bf16 v[224:227], a[232:235], a[8:11], v[224:227]
  v_mfma_f32_16x16x32_bf16 v[228:231], a[232:235], a[40:43], v[228:231]
  s_waitcnt lgkmcnt(4)
  v_mfma_f32_16x16x32_bf16 v[224:227], a[236:239], a[12:15], v[224:227]
  s_add_u32 m0, s29, 71680
  s_nop 0
  buffer_load_dwordx4 v22, s[8:11], s31 offen nt lds
  v_mfma_f32_16x16x32_bf16 v[228:231], a[236:239], a[44:47], v[228:231]
  s_waitcnt lgkmcnt(3)
  v_mfma_f32_16x16x32_bf16 v[224:227], a[240:243], a[16:19], v[224:227]
  v_mfma_f32_16x16x32_bf16 v[228:231], a[240:243], a[48:51], v[228:231]
  s_waitcnt lgkmcnt(2)
  v_mfma_f32_16x16x32_bf16 v[224:227], a[244:247], a[20:23], v[224:227]
  v_mfma_f32_16x16x32_bf16 v[228:231], a[244:247], a[52:55], v[228:231]
  s_waitcnt lgkmcnt(1)
  v_mfma_f32_16x16x32_bf16 v[224:227], a[248:251], a[24:27], v[224:227]
  v_mfma_f32_16x16x32_bf16 v[228:231], a[248:251], a[56:59], v[228:231]
  s_add_u32 m0, s29, 72704
  s_nop 0
  buffer_load_dwordx4 v23, s[8:11], s31 offen nt lds
  s_waitcnt lgkmcnt(0)
  v_mfma_f32_16x16x32_bf16 v[224:227], a[252:255], a[28:31], v[224:227]
  v_mfma_f32_16x16x32_bf16 v[228:231], a[252:255], a[60:63], v[228:231]
  ds_read_b128 a[192:195], v49 offset:32768
  ds_read_b128 a[196:199], v51 offset:32768
  ds_read_b128 a[200:203], v53 offset:32768
  ds_read_b128 a[204:207], v55 offset:32768
  ds_read_b128 a[208:211], v49 offset:33024
  ds_read_b128 a[212:215], v51 offset:33024
  ds_read_b128 a[216:219], v53 offset:33024
  s_waitcnt lgkmcnt(6)
  v_mfma_f32_16x16x32_bf16 v[232:235], a[192:195], a[64:67], 0
  v_max3_f32 v31, v31, v224, v225
  v_max3_f32 v31, v31, v226, v227
  ds_read_b128 a[220:223], v55 offset:33024
  s_waitcnt lgkmcnt(6)
  v_mfma_f32_16x16x32_bf16 v[232:235], a[196:199], a[68:71], v[232:235]
  v_cvt_pk_bf16_f32 v110, v224, v225
  v_cvt_pk_bf16_f32 v111, v226, v227
  s_waitcnt lgkmcnt(5)
  v_mfma_f32_16x16x32_bf16 v[232:235], a[200:203], a[72:75], v[232:235]
  v_max3_f32 v32, v32, v228, v229
  v_max3_f32 v32, v32, v230, v231
  s_waitcnt lgkmcnt(4)
  v_mfma_f32_16x16x32_bf16 v[232:235], a[204:207], a[76:79], v[232:235]
  v_cvt_pk_bf16_f32 v174, v228, v229
  v_cvt_pk_bf16_f32 v175, v230, v231
  s_waitcnt lgkmcnt(3)
  v_mfma_f32_16x16x32_bf16 v[232:235], a[208:211], a[80:83], v[232:235]
  s_waitcnt lgkmcnt(2)
  v_mfma_f32_16x16x32_bf16 v[232:235], a[212:215], a[84:87], v[232:235]
  s_waitcnt lgkmcnt(1)
  v_mfma_f32_16x16x32_bf16 v[232:235], a[216:219], a[88:91], v[232:235]
  s_waitcnt lgkmcnt(0)
  v_mfma_f32_16x16x32_bf16 v[232:235], a[220:223], a[92:95], v[232:235]
  s_waitcnt vmcnt(16)
  s_barrier
  ds_read_b128 a[224:227], v40 offset:0
  ds_read_b128 a[228:231], v42 offset:0
  ds_read_b128 a[232:235], v44 offset:0
  ds_read_b128 a[236:239], v46 offset:0
  ds_read_b128 a[240:243], v40 offset:256
  ds_read_b128 a[244:247], v42 offset:256
  ds_read_b128 a[248:251], v44 offset:256
  s_waitcnt lgkmcnt(6)
  v_mfma_f32_16x16x32_bf16 v[216:219], a[224:227], a[0:3], 0
  v_max3_f32 v33, v33, v232, v233
  v_max3_f32 v33, v33, v234, v235
  v_mfma_f32_16x16x32_bf16 v[220:223], a[224:227], a[32:35], 0
  v_cvt_pk_bf16_f32 v208, v232, v233
  v_cvt_pk_bf16_f32 v209, v234, v235
  ds_read_b128 a[252:255], v46 offset:256
  s_waitcnt lgkmcnt(6)
  v_mfma_f32_16x16x32_bf16 v[216:219], a[228:231], a[4:7], v[216:219]
  v_mfma_f32_16x16x32_bf16 v[220:223], a[228:231], a[36:39], v[220:223]
  v_xor_b32 v12, 0, v25
  v_lshl_add_u32 v12, v12, 4, v27
  v_add_u32 v16, 0, v12
  v_xor_b32 v12, 4, v25
  v_lshl_add_u32 v12, v12, 4, v27
  v_add_u32 v17, 1024, v12
  v_xor_b32 v12, 8, v25
  v_lshl_add_u32 v12, v12, 4, v27
  v_add_u32 v18, 2048, v12
  v_xor_b32 v12, 12, v25
  v_lshl_add_u32 v12, v12, 4, v27
  v_add_u32 v19, 3072, v12
  v_xor_b32 v12, 0, v25
  v_lshl_add_u32 v12, v12, 4, v27
  v_add_u32 v20, 4096, v12
  v_xor_b32 v12, 4, v25
  v_lshl_add_u32 v12, v12, 4, v27
  v_add_u32 v21, 5120, v12
  v_xor_b32 v12, 8, v25
  v_lshl_add_u32 v12, v12, 4, v27
  v_add_u32 v22, 6144, v12
  v_xor_b32 v12, 12, v25
  v_lshl_add_u32 v12, v12, 4, v27
  v_add_u32 v23, 7168, v12
  s_add_u32 s42, s43, 0
  s_and_b32 s42, s42, 7
  s_lshl_b32 s42, s42, 15
  s_waitcnt lgkmcnt(5)
  v_mfma_f32_16x16x32_bf16 v[216:219], a[232:235], a[8:11], v[216:219]
  v_mfma_f32_16x16x32_bf16 v[220:223], a[232:235], a[40:43], v[220:223]
  s_waitcnt lgkmcnt(4)
  v_mfma_f32_16x16x32_bf16 v[216:219], a[236:239], a[12:15], v[216:219]
  v_mfma_f32_16x16x32_bf16 v[220:223], a[236:239], a[44:47], v[220:223]
  s_waitcnt lgkmcnt(3)
  v_mfma_f32_16x16x32_bf16 v[216:219], a[240:243], a[16:19], v[216:219]
  v_mfma_f32_16x16x32_bf16 v[220:223], a[240:243], a[48:51], v[220:223]
  s_waitcnt lgkmcnt(2)
  v_mfma_f32_16x16x32_bf16 v[216:219], a[244:247], a[20:23], v[216:219]
  s_add_u32 m0, s29, 98304
  s_nop 0
  buffer_load_dwordx4 v16, s[12:15], s42 offen nt lds
  v_mfma_f32_16x16x32_bf16 v[220:223], a[244:247], a[52:55], v[220:223]
  s_waitcnt lgkmcnt(1)
  v_mfma_f32_16x16x32_bf16 v[216:219], a[248:251], a[24:27], v[216:219]
  v_mfma_f32_16x16x32_bf16 v[220:223], a[248:251], a[56:59], v[220:223]
  s_waitcnt lgkmcnt(0)
  v_mfma_f32_16x16x32_bf16 v[216:219], a[252:255], a[28:31], v[216:219]
  v_mfma_f32_16x16x32_bf16 v[220:223], a[252:255], a[60:63], v[220:223]
  ds_read_b128 a[192:195], v40 offset:8192
  ds_read_b128 a[196:199], v42 offset:8192
  ds_read_b128 a[200:203], v44 offset:8192
  ds_read_b128 a[204:207], v46 offset:8192
  ds_read_b128 a[208:211], v40 offset:8448
  ds_read_b128 a[212:215], v42 offset:8448
  ds_read_b128 a[216:219], v44 offset:8448
  s_waitcnt lgkmcnt(6)
  v_mfma_f32_16x16x32_bf16 v[224:227], a[192:195], a[0:3], 0
  v_max3_f32 v31, v31, v216, v217
  v_max3_f32 v31, v31, v218, v219
  v_mfma_f32_16x16x32_bf16 v[228:231], a[192:195], a[32:35], 0
  v_cvt_pk_bf16_f32 v112, v216, v217
  v_cvt_pk_bf16_f32 v113, v218, v219
  s_add_u32 m0, s29, 99328
  s_nop 0
  buffer_load_dwordx4 v17, s[12:15], s42 offen nt lds
  ds_read_b128 a[220:223], v46 offset:8448
  s_waitcnt lgkmcnt(6)
  v_mfma_f32_16x16x32_bf16 v[224:227], a[196:199], a[4:7], v[224:227]
  v_max3_f32 v32, v32, v220, v221
  v_max3_f32 v32, v32, v222, v223
  v_mfma_f32_16x16x32_bf16 v[228:231], a[196:199], a[36:39], v[228:231]
  v_cvt_pk_bf16_f32 v176, v220, v221
  v_cvt_pk_bf16_f32 v177, v222, v223
  s_waitcnt lgkmcnt(5)
  v_mfma_f32_16x16x32_bf16 v[224:227], a[200:203], a[8:11], v[224:227]
  v_mfma_f32_16x16x32_bf16 v[228:231], a[200:203], a[40:43], v[228:231]
  s_waitcnt lgkmcnt(4)
  v_mfma_f32_16x16x32_bf16 v[224:227], a[204:207], a[12:15], v[224:227]
  v_mfma_f32_16x16x32_bf16 v[228:231], a[204:207], a[44:47], v[228:231]
  s_waitcnt lgkmcnt(3)
  v_mfma_f32_16x16x32_bf16 v[224:227], a[208:211], a[16:19], v[224:227]
  s_add_u32 m0, s29, 100352
  s_nop 0
  buffer_load_dwordx4 v18, s[12:15], s42 offen nt lds
  v_mfma_f32_16x16x32_bf16 v[228:231], a[208:211], a[48:51], v[228:231]
  s_waitcnt lgkmcnt(2)
  v_mfma_f32_16x16x32_bf16 v[224:227], a[212:215], a[20:23], v[224:227]
  v_mfma_f32_16x16x32_bf16 v[228:231], a[212:215], a[52:55], v[228:231]
  s_waitcnt lgkmcnt(1)
  v_mfma_f32_16x16x32_bf16 v[224:227], a[216:219], a[24:27], v[224:227]
  v_mfma_f32_16x16x32_bf16 v[228:231], a[216:219], a[56:59], v[228:231]
  s_waitcnt lgkmcnt(0)
  v_mfma_f32_16x16x32_bf16 v[224:227], a[220:223], a[28:31], v[224:227]
  v_mfma_f32_16x16x32_bf16 v[228:231], a[220:223], a[60:63], v[228:231]
  s_add_u32 m0, s29, 101376
  s_nop 0
  buffer_load_dwordx4 v19, s[12:15], s42 offen nt lds
  ds_read_b128 a[224:227], v40 offset:16384
  ds_read_b128 a[228:231], v42 offset:16384
  ds_read_b128 a[232:235], v44 offset:16384
  ds_read_b128 a[236:239], v46 offset:16384
  ds_read_b128 a[240:243], v40 offset:16640
  ds_read_b128 a[244:247], v42 offset:16640
  ds_read_b128 a[248:251], v44 offset:16640
  s_waitcnt lgkmcnt(6)
  v_mfma_f32_16x16x32_bf16 v[216:219], a[224:227], a[0:3], 0
  v_max3_f32 v31, v31, v224, v225
  v_max3_f32 v31, v31, v226, v227
  v_mfma_f32_16x16x32_bf16 v[220:223], a[224:227], a[32:35], 0
  v_cvt_pk_bf16_f32 v114, v224, v225
  v_cvt_pk_bf16_f32 v115, v226, v227
  ds_read_b128 a[252:255], v46 offset:16640
  s_waitcnt lgkmcnt(6)
  v_mfma_f32_16x16x32_bf16 v[216:219], a[228:231], a[4:7], v[216:219]
  v_max3_f32 v32, v32, v228, v229
  v_max3_f32 v32, v32, v230, v231
  v_mfma_f32_16x16x32_bf16 v[220:223], a[228:231], a[36:39], v[220:223]
  v_cvt_pk_bf16_f32 v178, v228, v229
  v_cvt_pk_bf16_f32 v179, v230, v231
  s_waitcnt lgkmcnt(5)
  v_mfma_f32_16x16x32_bf16 v[216:219], a[232:235], a[8:11], v[216:219]
  v_mfma_f32_16x16x32_bf16 v[220:223], a[232:235], a[40:43], v[220:223]
  s_waitcnt lgkmcnt(4)
  v_mfma_f32_16x16x32_bf16 v[216:219], a[236:239], a[12:15], v[216:219]
  s_add_u32 m0, s29, 102400
  s_nop 0
  buffer_load_dwordx4 v20, s[12:15], s42 offen nt lds
  v_mfma_f32_16x16x32_bf16 v[220:223], a[236:239], a[44:47], v[220:223]
  s_waitcnt lgkmcnt(3)
  v_mfma_f32_16x16x32_bf16 v[216:219], a[240:243], a[16:19], v[216:219]
  v_mfma_f32_16x16x32_bf16 v[220:223], a[240:243], a[48:51], v[220:223]
  s_waitcnt lgkmcnt(2)
  v_mfma_f32_16x16x32_bf16 v[216:219], a[244:247], a[20:23], v[216:219]
  v_mfma_f32_16x16x32_bf16 v[220:223], a[244:247], a[52:55], v[220:223]
  s_waitcnt lgkmcnt(1)
  v_mfma_f32_16x16x32_bf16 v[216:219], a[248:251], a[24:27], v[216:219]
  v_mfma_f32_16x16x32_bf16 v[220:223], a[248:251], a[56:59], v[220:223]
  s_add_u32 m0, s29, 103424
  s_nop 0
  buffer_load_dwordx4 v21, s[12:15], s42 offen nt lds
  s_waitcnt lgkmcnt(0)
  v_mfma_f32_16x16x32_bf16 v[216:219], a[252:255], a[28:31], v[216:219]
  v_mfma_f32_16x16x32_bf16 v[220:223], a[252:255], a[60:63], v[220:223]
  ds_read_b128 a[192:195], v40 offset:24576
  ds_read_b128 a[196:199], v42 offset:24576
  ds_read_b128 a[200:203], v44 offset:24576
  ds_read_b128 a[204:207], v46 offset:24576
  ds_read_b128 a[208:211], v40 offset:24832
  ds_read_b128 a[212:215], v42 offset:24832
  ds_read_b128 a[216:219], v44 offset:24832
  s_waitcnt lgkmcnt(6)
  v_mfma_f32_16x16x32_bf16 v[224:227], a[192:195], a[0:3], 0
  v_max3_f32 v31, v31, v216, v217
  v_max3_f32 v31, v31, v218, v219
  v_mfma_f32_16x16x32_bf16 v[228:231], a[192:195], a[32:35], 0
  v_cvt_pk_bf16_f32 v116, v216, v217
  v_cvt_pk_bf16_f32 v117, v218, v219
  ds_read_b128 a[220:223], v46 offset:24832
  s_waitcnt lgkmcnt(6)
  v_mfma_f32_16x16x32_bf16 v[224:227], a[196:199], a[4:7], v[224:227]
  v_max3_f32 v32, v32, v220, v221
  v_max3_f32 v32, v32, v222, v223
  v_mfma_f32_16x16x32_bf16 v[228:231], a[196:199], a[36:39], v[228:231]
  v_cvt_pk_bf16_f32 v180, v220, v221
  v_cvt_pk_bf16_f32 v181, v222, v223
  s_waitcnt lgkmcnt(5)
  v_mfma_f32_16x16x32_bf16 v[224:227], a[200:203], a[8:11], v[224:227]
  s_add_u32 m0, s29, 104448
  s_nop 0
  buffer_load_dwordx4 v22, s[12:15], s42 offen nt lds
  v_mfma_f32_16x16x32_bf16 v[228:231], a[200:203], a[40:43], v[228:231]
  s_waitcnt lgkmcnt(4)
  v_mfma_f32_16x16x32_bf16 v[224:227], a[204:207], a[12:15], v[224:227]
  v_mfma_f32_16x16x32_bf16 v[228:231], a[204:207], a[44:47], v[228:231]
  s_waitcnt lgkmcnt(3)
  v_mfma_f32_16x16x32_bf16 v[224:227], a[208:211], a[16:19], v[224:227]
  v_mfma_f32_16x16x32_bf16 v[228:231], a[208:211], a[48:51], v[228:231]
  s_waitcnt lgkmcnt(2)
  v_mfma_f32_16x16x32_bf16 v[224:227], a[212:215], a[20:23], v[224:227]
  v_mfma_f32_16x16x32_bf16 v[228:231], a[212:215], a[52:55], v[228:231]
  s_add_u32 m0, s29, 105472
  s_nop 0
  buffer_load_dwordx4 v23, s[12:15], s42 offen nt lds
  s_waitcnt lgkmcnt(1)
  v_mfma_f32_16x16x32_bf16 v[224:227], a[216:219], a[24:27], v[224:227]
  v_mfma_f32_16x16x32_bf16 v[228:231], a[216:219], a[56:59], v[228:231]
  s_waitcnt lgkmcnt(0)
  v_mfma_f32_16x16x32_bf16 v[224:227], a[220:223], a[28:31], v[224:227]
  v_mfma_f32_16x16x32_bf16 v[228:231], a[220:223], a[60:63], v[228:231]
  ds_read_b128 a[224:227], v48 offset:0
  ds_read_b128 a[228:231], v50 offset:0
  ds_read_b128 a[232:235], v52 offset:0
  ds_read_b128 a[236:239], v54 offset:0
  ds_read_b128 a[240:243], v48 offset:256
  ds_read_b128 a[244:247], v50 offset:256
  ds_read_b128 a[248:251], v52 offset:256
  s_waitcnt lgkmcnt(6)
  v_mfma_f32_16x16x32_bf16 v[232:235], a[224:227], a[64:67], 0
  v_max3_f32 v31, v31, v224, v225
  v_max3_f32 v31, v31, v226, v227
  ds_read_b128 a[252:255], v54 offset:256
  s_waitcnt lgkmcnt(6)
  v_mfma_f32_16x16x32_bf16 v[232:235], a[228:231], a[68:71], v[232:235]
  v_cvt_pk_bf16_f32 v118, v224, v225
  v_cvt_pk_bf16_f32 v119, v226, v227
  s_waitcnt lgkmcnt(5)
  v_mfma_f32_16x16x32_bf16 v[232:235], a[232:235], a[72:75], v[232:235]
  v_max3_f32 v32, v32, v228, v229
  v_max3_f32 v32, v32, v230, v231
  s_waitcnt lgkmcnt(4)
  v_mfma_f32_16x16x32_bf16 v[232:235], a[236:239], a[76:79], v[232:235]
  v_cvt_pk_bf16_f32 v182, v228, v229
  v_cvt_pk_bf16_f32 v183, v230, v231
  s_waitcnt lgkmcnt(3)
  v_mfma_f32_16x16x32_bf16 v[232:235], a[240:243], a[80:83], v[232:235]
  s_waitcnt lgkmcnt(2)
  v_mfma_f32_16x16x32_bf16 v[232:235], a[244:247], a[84:87], v[232:235]
  s_waitcnt lgkmcnt(1)
  v_mfma_f32_16x16x32_bf16 v[232:235], a[248:251], a[88:91], v[232:235]
  s_waitcnt lgkmcnt(0)
  v_mfma_f32_16x16x32_bf16 v[232:235], a[252:255], a[92:95], v[232:235]
  s_waitcnt vmcnt(16)
  s_barrier
  ds_read_b128 a[192:195], v40 offset:32768
  ds_read_b128 a[196:199], v42 offset:32768
  ds_read_b128 a[200:203], v44 offset:32768
  ds_read_b128 a[204:207], v46 offset:32768
  ds_read_b128 a[208:211], v40 offset:33024
  ds_read_b128 a[212:215], v42 offset:33024
  ds_read_b128 a[216:219], v44 offset:33024
  s_waitcnt lgkmcnt(6)
  v_mfma_f32_16x16x32_bf16 v[216:219], a[192:195], a[0:3], 0
  v_max3_f32 v33, v33, v232, v233
  v_max3_f32 v33, v33, v234, v235
  v_mfma_f32_16x16x32_bf16 v[220:223], a[192:195], a[32:35], 0
  v_cvt_pk_bf16_f32 v210, v232, v233
  v_cvt_pk_bf16_f32 v211, v234, v235
  s_add_u32 s31, s43, 1
  s_and_b32 s31, s31, 7
  s_lshl_b32 s31, s31, 15
  ds_read_b128 a[220:223], v46 offset:33024
  s_waitcnt lgkmcnt(6)
  v_mfma_f32_16x16x32_bf16 v[216:219], a[196:199], a[4:7], v[216:219]
  v_mfma_f32_16x16x32_bf16 v[220:223], a[196:199], a[36:39], v[220:223]
  s_waitcnt lgkmcnt(5)
  v_mfma_f32_16x16x32_bf16 v[216:219], a[200:203], a[8:11], v[216:219]
  v_mfma_f32_16x16x32_bf16 v[220:223], a[200:203], a[40:43], v[220:223]
  s_waitcnt lgkmcnt(4)
  v_mfma_f32_16x16x32_bf16 v[216:219], a[204:207], a[12:15], v[216:219]
  v_mfma_f32_16x16x32_bf16 v[220:223], a[204:207], a[44:47], v[220:223]
  s_waitcnt lgkmcnt(3)
  v_mfma_f32_16x16x32_bf16 v[216:219], a[208:211], a[16:19], v[216:219]
  s_add_u32 m0, s29, 0
  s_nop 0
  buffer_load_dwordx4 v16, s[12:15], s31 offen nt lds
  v_mfma_f32_16x16x32_bf16 v[220:223], a[208:211], a[48:51], v[220:223]
  s_waitcnt lgkmcnt(2)
  v_mfma_f32_16x16x32_bf16 v[216:219], a[212:215], a[20:23], v[216:219]
  v_mfma_f32_16x16x32_bf16 v[220:223], a[212:215], a[52:55], v[220:223]
  s_waitcnt lgkmcnt(1)
  v_mfma_f32_16x16x32_bf16 v[216:219], a[216:219], a[24:27], v[216:219]
  v_mfma_f32_16x16x32_bf16 v[220:223], a[216:219], a[56:59], v[220:223]
  s_waitcnt lgkmcnt(0)
  v_mfma_f32_16x16x32_bf16 v[216:219], a[220:223], a[28:31], v[216:219]
  v_mfma_f32_16x16x32_bf16 v[220:223], a[220:223], a[60:63], v[220:223]
  s_add_u32 m0, s29, 1024
  s_nop 0
  buffer_load_dwordx4 v17, s[12:15], s31 offen nt lds
  ds_read_b128 a[224:227], v40 offset:40960
  ds_read_b128 a[228:231], v42 offset:40960
  ds_read_b128 a[232:235], v44 offset:40960
  ds_read_b128 a[236:239], v46 offset:40960
  ds_read_b128 a[240:243], v40 offset:41216
  ds_read_b128 a[244:247], v42 offset:41216
  ds_read_b128 a[248:251], v44 offset:41216
  s_waitcnt lgkmcnt(6)
  v_mfma_f32_16x16x32_bf16 v[224:227], a[224:227], a[0:3], 0
  v_max3_f32 v31, v31, v216, v217
  v_max3_f32 v31, v31, v218, v219
  v_mfma_f32_16x16x32_bf16 v[228:231], a[224:227], a[32:35], 0
  v_cvt_pk_bf16_f32 v120, v216, v217
  v_cvt_pk_bf16_f32 v121, v218, v219
  ds_read_b128 a[252:255], v46 offset:41216
  s_waitcnt lgkmcnt(6)
  v_mfma_f32_16x16x32_bf16 v[224:227], a[228:231], a[4:7], v[224:227]
  v_max3_f32 v32, v32, v220, v221
  v_max3_f32 v32, v32, v222, v223
  v_mfma_f32_16x16x32_bf16 v[228:231], a[228:231], a[36:39], v[228:231]
  v_cvt_pk_bf16_f32 v184, v220, v221
  v_cvt_pk_bf16_f32 v185, v222, v223
  s_waitcnt lgkmcnt(5)
  v_mfma_f32_16x16x32_bf16 v[224:227], a[232:235], a[8:11], v[224:227]
  v_mfma_f32_16x16x32_bf16 v[228:231], a[232:235], a[40:43], v[228:231]
  s_waitcnt lgkmcnt(4)
  v_mfma_f32_16x16x32_bf16 v[224:227], a[236:239], a[12:15], v[224:227]
  s_add_u32 m0, s29, 2048
  s_nop 0
  buffer_load_dwordx4 v18, s[12:15], s31 offen nt lds
  v_mfma_f32_16x16x32_bf16 v[228:231], a[236:239], a[44:47], v[228:231]
  s_waitcnt lgkmcnt(3)
  v_mfma_f32_16x16x32_bf16 v[224:227], a[240:243], a[16:19], v[224:227]
  v_mfma_f32_16x16x32_bf16 v[228:231], a[240:243], a[48:51], v[228:231]
  s_waitcnt lgkmcnt(2)
  v_mfma_f32_16x16x32_bf16 v[224:227], a[244:247], a[20:23], v[224:227]
  v_mfma_f32_16x16x32_bf16 v[228:231], a[244:247], a[52:55], v[228:231]
  s_waitcnt lgkmcnt(1)
  v_mfma_f32_16x16x32_bf16 v[224:227], a[248:251], a[24:27], v[224:227]
  v_mfma_f32_16x16x32_bf16 v[228:231], a[248:251], a[56:59], v[228:231]
  s_add_u32 m0, s29, 3072
  s_nop 0
  buffer_load_dwordx4 v19, s[12:15], s31 offen nt lds
  s_waitcnt lgkmcnt(0)
  v_mfma_f32_16x16x32_bf16 v[224:227], a[252:255], a[28:31], v[224:227]
  v_mfma_f32_16x16x32_bf16 v[228:231], a[252:255], a[60:63], v[228:231]
  ds_read_b128 a[192:195], v40 offset:49152
  ds_read_b128 a[196:199], v42 offset:49152
  ds_read_b128 a[200:203], v44 offset:49152
  ds_read_b128 a[204:207], v46 offset:49152
  ds_read_b128 a[208:211], v40 offset:49408
  ds_read_b128 a[212:215], v42 offset:49408
  ds_read_b128 a[216:219], v44 offset:49408
  s_waitcnt lgkmcnt(6)
  v_mfma_f32_16x16x32_bf16 v[216:219], a[192:195], a[0:3], 0
  v_max3_f32 v31, v31, v224, v225
  v_max3_f32 v31, v31, v226, v227
  v_mfma_f32_16x16x32_bf16 v[220:223], a[192:195], a[32:35], 0
  v_cvt_pk_bf16_f32 v122, v224, v225
  v_cvt_pk_bf16_f32 v123, v226, v227
  ds_read_b128 a[220:223], v46 offset:49408
  s_waitcnt lgkmcnt(6)
  v_mfma_f32_16x16x32_bf16 v[216:219], a[196:199], a[4:7], v[216:219]
  v_max3_f32 v32, v32, v228, v229
  v_max3_f32 v32, v32, v230, v231
  v_mfma_f32_16x16x32_bf16 v[220:223], a[196:199], a[36:39], v[220:223]
  v_cvt_pk_bf16_f32 v186, v228, v229
  v_cvt_pk_bf16_f32 v187, v230, v231
  s_waitcnt lgkmcnt(5)
  v_mfma_f32_16x16x32_bf16 v[216:219], a[200:203], a[8:11], v[216:219]
  s_add_u32 m0, s29, 4096
  s_nop 0
  buffer_load_dwordx4 v20, s[12:15], s31 offen nt lds
  v_mfma_f32_16x16x32_bf16 v[220:223], a[200:203], a[40:43], v[220:223]
  s_waitcnt lgkmcnt(4)
  v_mfma_f32_16x16x32_bf16 v[216:219], a[204:207], a[12:15], v[216:219]
  v_mfma_f32_16x16x32_bf16 v[220:223], a[204:207], a[44:47], v[220:223]
  s_waitcnt lgkmcnt(3)
  v_mfma_f32_16x16x32_bf16 v[216:219], a[208:211], a[16:19], v[216:219]
  v_mfma_f32_16x16x32_bf16 v[220:223], a[208:211], a[48:51], v[220:223]
  s_waitcnt lgkmcnt(2)
  v_mfma_f32_16x16x32_bf16 v[216:219], a[212:215], a[20:23], v[216:219]
  v_mfma_f32_16x16x32_bf16 v[220:223], a[212:215], a[52:55], v[220:223]
  s_add_u32 m0, s29, 5120
  s_nop 0
  buffer_load_dwordx4 v21, s[12:15], s31 offen nt lds
  s_waitcnt lgkmcnt(1)
  v_mfma_f32_16x16x32_bf16 v[216:219], a[216:219], a[24:27], v[216:219]
  v_mfma_f32_16x16x32_bf16 v[220:223], a[216:219], a[56:59], v[220:223]
  s_waitcnt lgkmcnt(0)
  v_mfma_f32_16x16x32_bf16 v[216:219], a[220:223], a[28:31], v[216:219]
  v_mfma_f32_16x16x32_bf16 v[220:223], a[220:223], a[60:63], v[220:223]
  ds_read_b128 a[224:227], v40 offset:57344
  ds_read_b128 a[228:231], v42 offset:57344
  ds_read_b128 a[232:235], v44 offset:57344
  ds_read_b128 a[236:239], v46 offset:57344
  ds_read_b128 a[240:243], v40 offset:57600
  ds_read_b128 a[244:247], v42 offset:57600
  ds_read_b128 a[248:251], v44 offset:57600
  s_waitcnt lgkmcnt(6)
  v_mfma_f32_16x16x32_bf16 v[224:227], a[224:227], a[0:3], 0
  v_max3_f32 v31, v31, v216, v217
  v_max3_f32 v31, v31, v218, v219
  v_mfma_f32_16x16x32_bf16 v[228:231], a[224:227], a[32:35], 0
  v_cvt_pk_bf16_f32 v124, v216, v217
  v_cvt_pk_bf16_f32 v125, v218, v219
  ds_read_b128 a[252:255], v46 offset:57600
  s_waitcnt lgkmcnt(6)
  v_mfma_f32_16x16x32_bf16 v[224:227], a[228:231], a[4:7], v[224:227]
  v_max3_f32 v32, v32, v220, v221
  v_max3_f32 v32, v32, v222, v223
  s_add_u32 m0, s29, 6144
  s_nop 0
  buffer_load_dwordx4 v22, s[12:15], s31 offen nt lds
  v_mfma_f32_16x16x32_bf16 v[228:231], a[228:231], a[36:39], v[228:231]
  v_cvt_pk_bf16_f32 v188, v220, v221
  v_cvt_pk_bf16_f32 v189, v222, v223
  s_waitcnt lgkmcnt(5)
  v_mfma_f32_16x16x32_bf16 v[224:227], a[232:235], a[8:11], v[224:227]
  v_mfma_f32_16x16x32_bf16 v[228:231], a[232:235], a[40:43], v[228:231]
  s_waitcnt lgkmcnt(4)
  v_mfma_f32_16x16x32_bf16 v[224:227], a[236:239], a[12:15], v[224:227]
  v_mfma_f32_16x16x32_bf16 v[228:231], a[236:239], a[44:47], v[228:231]
  s_waitcnt lgkmcnt(3)
  v_mfma_f32_16x16x32_bf16 v[224:227], a[240:243], a[16:19], v[224:227]
  v_mfma_f32_16x16x32_bf16 v[228:231], a[240:243], a[48:51], v[228:231]
  s_add_u32 m0, s29, 7168
  s_nop 0
  buffer_load_dwordx4 v23, s[12:15], s31 offen nt lds
  s_waitcnt lgkmcnt(2)
  v_mfma_f32_16x16x32_bf16 v[224:227], a[244:247], a[20:23], v[224:227]
  v_mfma_f32_16x16x32_bf16 v[228:231], a[244:247], a[52:55], v[228:231]
  s_waitcnt lgkmcnt(1)
  v_mfma_f32_16x16x32_bf16 v[224:227], a[248:251], a[24:27], v[224:227]
  v_mfma_f32_16x16x32_bf16 v[228:231], a[248:251], a[56:59], v[228:231]
  s_waitcnt lgkmcnt(0)
  v_mfma_f32_16x16x32_bf16 v[224:227], a[252:255], a[28:31], v[224:227]
  v_mfma_f32_16x16x32_bf16 v[228:231], a[252:255], a[60:63], v[228:231]
  ds_read_b128 a[192:195], v48 offset:32768
  ds_read_b128 a[196:199], v50 offset:32768
  ds_read_b128 a[200:203], v52 offset:32768
  ds_read_b128 a[204:207], v54 offset:32768
  ds_read_b128 a[208:211], v48 offset:33024
  ds_read_b128 a[212:215], v50 offset:33024
  ds_read_b128 a[216:219], v52 offset:33024
  s_waitcnt lgkmcnt(6)
  v_mfma_f32_16x16x32_bf16 v[232:235], a[192:195], a[64:67], 0
  v_max3_f32 v31, v31, v224, v225
  v_max3_f32 v31, v31, v226, v227
  ds_read_b128 a[220:223], v54 offset:33024
  s_waitcnt lgkmcnt(6)
  v_mfma_f32_16x16x32_bf16 v[232:235], a[196:199], a[68:71], v[232:235]
  v_cvt_pk_bf16_f32 v126, v224, v225
  v_cvt_pk_bf16_f32 v127, v226, v227
  s_waitcnt lgkmcnt(5)
  v_mfma_f32_16x16x32_bf16 v[232:235], a[200:203], a[72:75], v[232:235]
  v_max3_f32 v32, v32, v228, v229
  v_max3_f32 v32, v32, v230, v231
  s_waitcnt lgkmcnt(4)
  v_mfma_f32_16x16x32_bf16 v[232:235], a[204:207], a[76:79], v[232:235]
  v_cvt_pk_bf16_f32 v190, v228, v229
  v_cvt_pk_bf16_f32 v191, v230, v231
  s_waitcnt lgkmcnt(3)
  v_mfma_f32_16x16x32_bf16 v[232:235], a[208:211], a[80:83], v[232:235]
  s_waitcnt lgkmcnt(2)
  v_mfma_f32_16x16x32_bf16 v[232:235], a[212:215], a[84:87], v[232:235]
  s_waitcnt lgkmcnt(1)
  v_mfma_f32_16x16x32_bf16 v[232:235], a[216:219], a[88:91], v[232:235]
  s_waitcnt lgkmcnt(0)
  v_mfma_f32_16x16x32_bf16 v[232:235], a[220:223], a[92:95], v[232:235]
  s_waitcnt vmcnt(16)
  s_barrier
  ds_read_b128 a[224:227], v41 offset:0
  ds_read_b128 a[228:231], v43 offset:0
  ds_read_b128 a[232:235], v45 offset:0
  ds_read_b128 a[236:239], v47 offset:0
  ds_read_b128 a[240:243], v41 offset:256
  ds_read_b128 a[244:247], v43 offset:256
  ds_read_b128 a[248:251], v45 offset:256
  s_waitcnt lgkmcnt(6)
  v_mfma_f32_16x16x32_bf16 v[216:219], a[224:227], a[0:3], 0
  v_max3_f32 v33, v33, v232, v233
  v_max3_f32 v33, v33, v234, v235
  v_mfma_f32_16x16x32_bf16 v[220:223], a[224:227], a[32:35], 0
  v_cvt_pk_bf16_f32 v212, v232, v233
  v_cvt_pk_bf16_f32 v213, v234, v235
  ds_read_b128 a[252:255], v47 offset:256
  s_waitcnt lgkmcnt(6)
  v_mfma_f32_16x16x32_bf16 v[216:219], a[228:231], a[4:7], v[216:219]
  v_mfma_f32_16x16x32_bf16 v[220:223], a[228:231], a[36:39], v[220:223]
  s_waitcnt lgkmcnt(5)
  v_mfma_f32_16x16x32_bf16 v[216:219], a[232:235], a[8:11], v[216:219]
  v_mfma_f32_16x16x32_bf16 v[220:223], a[232:235], a[40:43], v[220:223]
  s_waitcnt lgkmcnt(4)
  v_mfma_f32_16x16x32_bf16 v[216:219], a[236:239], a[12:15], v[216:219]
  s_add_u32 s42, s43, 2
  s_and_b32 s42, s42, 7
  s_lshl_b32 s42, s42, 15
  v_mfma_f32_16x16x32_bf16 v[220:223], a[236:239], a[44:47], v[220:223]
  s_waitcnt lgkmcnt(3)
  v_mfma_f32_16x16x32_bf16 v[216:219], a[240:243], a[16:19], v[216:219]
  v_mfma_f32_16x16x32_bf16 v[220:223], a[240:243], a[48:51], v[220:223]
  s_waitcnt lgkmcnt(2)
  v_mfma_f32_16x16x32_bf16 v[216:219], a[244:247], a[20:23], v[216:219]
  v_mfma_f32_16x16x32_bf16 v[220:223], a[244:247], a[52:55], v[220:223]
  s_waitcnt lgkmcnt(1)
  v_mfma_f32_16x16x32_bf16 v[216:219], a[248:251], a[24:27], v[216:219]
  v_mfma_f32_16x16x32_bf16 v[220:223], a[248:251], a[56:59], v[220:223]
  s_add_u32 m0, s29, 32768
  s_nop 0
  buffer_load_dwordx4 v16, s[12:15], s42 offen nt lds
  s_waitcnt lgkmcnt(0)
  v_mfma_f32_16x16x32_bf16 v[216:219], a[252:255], a[28:31], v[216:219]
  v_mfma_f32_16x16x32_bf16 v[220:223], a[252:255], a[60:63], v[220:223]
  ds_read_b128 a[192:195], v41 offset:8192
  ds_read_b128 a[196:199], v43 offset:8192
  ds_read_b128 a[200:203], v45 offset:8192
  ds_read_b128 a[204:207], v47 offset:8192
  ds_read_b128 a[208:211], v41 offset:8448
  ds_read_b128 a[212:215], v43 offset:8448
  ds_read_b128 a[216:219], v45 offset:8448
  s_waitcnt lgkmcnt(6)
  v_mfma_f32_16x16x32_bf16 v[224:227], a[192:195], a[0:3], 0
  v_max3_f32 v31, v31, v216, v217
  v_max3_f32 v31, v31, v218, v219
  v_mfma_f32_16x16x32_bf16 v[228:231], a[192:195], a[32:35], 0
  v_cvt_pk_bf16_f32 v128, v216, v217
  v_cvt_pk_bf16_f32 v129, v218, v219
  ds_read_b128 a[220:223], v47 offset:8448
  s_waitcnt lgkmcnt(6)
  v_mfma_f32_16x16x32_bf16 v[224:227], a[196:199], a[4:7], v[224:227]
  v_max3_f32 v32, v32, v220, v221
  v_max3_f32 v32, v32, v222, v223
  v_mfma_f32_16x16x32_bf16 v[228:231], a[196:199], a[36:39], v[228:231]
  v_cvt_pk_bf16_f32 v192, v220, v221
  v_cvt_pk_bf16_f32 v193, v222, v223
  s_waitcnt lgkmcnt(5)
  v_mfma_f32_16x16x32_bf16 v[224:227], a[200:203], a[8:11], v[224:227]
  s_add_u32 m0, s29, 33792
  s_nop 0
  buffer_load_dwordx4 v17, s[12:15], s42 offen nt lds
  v_mfma_f32_16x16x32_bf16 v[228:231], a[200:203], a[40:43], v[228:231]
  s_waitcnt lgkmcnt(4)
  v_mfma_f32_16x16x32_bf16 v[224:227], a[204:207], a[12:15], v[224:227]
  v_mfma_f32_16x16x32_bf16 v[228:231], a[204:207], a[44:47], v[228:231]
  s_waitcnt lgkmcnt(3)
  v_mfma_f32_16x16x32_bf16 v[224:227], a[208:211], a[16:19], v[224:227]
  v_mfma_f32_16x16x32_bf16 v[228:231], a[208:211], a[48:51], v[228:231]
  s_waitcnt lgkmcnt(2)
  v_mfma_f32_16x16x32_bf16 v[224:227], a[212:215], a[20:23], v[224:227]
  v_mfma_f32_16x16x32_bf16 v[228:231], a[212:215], a[52:55], v[228:231]
  s_add_u32 m0, s29, 34816
  s_nop 0
  buffer_load_dwordx4 v18, s[12:15], s42 offen nt lds
  s_waitcnt lgkmcnt(1)
  v_mfma_f32_16x16x32_bf16 v[224:227], a[216:219], a[24:27], v[224:227]
  v_mfma_f32_16x16x32_bf16 v[228:231], a[216:219], a[56:59], v[228:231]
  s_waitcnt lgkmcnt(0)
  v_mfma_f32_16x16x32_bf16 v[224:227], a[220:223], a[28:31], v[224:227]
  v_mfma_f32_16x16x32_bf16 v[228:231], a[220:223], a[60:63], v[228:231]
  ds_read_b128 a[224:227], v41 offset:16384
  ds_read_b128 a[228:231], v43 offset:16384
  ds_read_b128 a[232:235], v45 offset:16384
  ds_read_b128 a[236:239], v47 offset:16384
  ds_read_b128 a[240:243], v41 offset:16640
  ds_read_b128 a[244:247], v43 offset:16640
  ds_read_b128 a[248:251], v45 offset:16640
  s_waitcnt lgkmcnt(6)
  v_mfma_f32_16x16x32_bf16 v[216:219], a[224:227], a[0:3], 0
  v_max3_f32 v31, v31, v224, v225
  v_max3_f32 v31, v31, v226, v227
  v_mfma_f32_16x16x32_bf16 v[220:223], a[224:227], a[32:35], 0
  v_cvt_pk_bf16_f32 v130, v224, v225
  v_cvt_pk_bf16_f32 v131, v226, v227
  ds_read_b128 a[252:255], v47 offset:16640
  s_waitcnt lgkmcnt(6)
  v_mfma_f32_16x16x32_bf16 v[216:219], a[228:231], a[4:7], v[216:219]
  v_max3_f32 v32, v32, v228, v229
  v_max3_f32 v32, v32, v230, v231
  s_add_u32 m0, s29, 35840
  s_nop 0
  buffer_load_dwordx4 v19, s[12:15], s42 offen nt lds
  v_mfma_f32_16x16x32_bf16 v[220:223], a[228:231], a[36:39], v[220:223]
  v_cvt_pk_bf16_f32 v194, v228, v229
  v_cvt_pk_bf16_f32 v195, v230, v231
  s_waitcnt lgkmcnt(5)
  v_mfma_f32_16x16x32_bf16 v[216:219], a[232:235], a[8:11], v[216:219]
  v_mfma_f32_16x16x32_bf16 v[220:223], a[232:235], a[40:43], v[220:223]
  s_waitcnt lgkmcnt(4)
  v_mfma_f32_16x16x32_bf16 v[216:219], a[236:239], a[12:15], v[216:219]
  v_mfma_f32_16x16x32_bf16 v[220:223], a[236:239], a[44:47], v[220:223]
  s_waitcnt lgkmcnt(3)
  v_mfma_f32_16x16x32_bf16 v[216:219], a[240:243], a[16:19], v[216:219]
  v_mfma_f32_16x16x32_bf16 v[220:223], a[240:243], a[48:51], v[220:223]
  s_add_u32 m0, s29, 36864
  s_nop 0
  buffer_load_dwordx4 v20, s[12:15], s42 offen nt lds
  s_waitcnt lgkmcnt(2)
  v_mfma_f32_16x16x32_bf16 v[216:219], a[244:247], a[20:23], v[216:219]
  v_mfma_f32_16x16x32_bf16 v[220:223], a[244:247], a[52:55], v[220:223]
  s_waitcnt lgkmcnt(1)
  v_mfma_f32_16x16x32_bf16 v[216:219], a[248:251], a[24:27], v[216:219]
  v_mfma_f32_16x16x32_bf16 v[220:223], a[248:251], a[56:59], v[220:223]
  s_waitcnt lgkmcnt(0)
  v_mfma_f32_16x16x32_bf16 v[216:219], a[252:255], a[28:31], v[216:219]
  v_mfma_f32_16x16x32_bf16 v[220:223], a[252:255], a[60:63], v[220:223]
  ds_read_b128 a[192:195], v41 offset:24576
  ds_read_b128 a[196:199], v43 offset:24576
  ds_read_b128 a[200:203], v45 offset:24576
  ds_read_b128 a[204:207], v47 offset:24576
  ds_read_b128 a[208:211], v41 offset:24832
  ds_read_b128 a[212:215], v43 offset:24832
  ds_read_b128 a[216:219], v45 offset:24832
  s_waitcnt lgkmcnt(6)
  v_mfma_f32_16x16x32_bf16 v[224:227], a[192:195], a[0:3], 0
  v_max3_f32 v31, v31, v216, v217
  v_max3_f32 v31, v31, v218, v219
  s_add_u32 m0, s29, 37888
  s_nop 0
  buffer_load_dwordx4 v21, s[12:15], s42 offen nt lds
  v_mfma_f32_16x16x32_bf16 v[228:231], a[192:195], a[32:35], 0
  v_cvt_pk_bf16_f32 v132, v216, v217
  v_cvt_pk_bf16_f32 v133, v218, v219
  ds_read_b128 a[220:223], v47 offset:24832
  s_waitcnt lgkmcnt(6)
  v_mfma_f32_16x16x32_bf16 v[224:227], a[196:199], a[4:7], v[224:227]
  v_max3_f32 v32, v32, v220, v221
  v_max3_f32 v32, v32, v222, v223
  v_mfma_f32_16x16x32_bf16 v[228:231], a[196:199], a[36:39], v[228:231]
  v_cvt_pk_bf16_f32 v196, v220, v221
  v_cvt_pk_bf16_f32 v197, v222, v223
  s_waitcnt lgkmcnt(5)
  v_mfma_f32_16x16x32_bf16 v[224:227], a[200:203], a[8:11], v[224:227]
  v_mfma_f32_16x16x32_bf16 v[228:231], a[200:203], a[40:43], v[228:231]
  s_waitcnt lgkmcnt(4)
  v_mfma_f32_16x16x32_bf16 v[224:227], a[204:207], a[12:15], v[224:227]
  v_mfma_f32_16x16x32_bf16 v[228:231], a[204:207], a[44:47], v[228:231]
  s_add_u32 m0, s29, 38912
  s_nop 0
  buffer_load_dwordx4 v22, s[12:15], s42 offen nt lds
  s_waitcnt lgkmcnt(3)
  v_mfma_f32_16x16x32_bf16 v[224:227], a[208:211], a[16:19], v[224:227]
  v_mfma_f32_16x16x32_bf16 v[228:231], a[208:211], a[48:51], v[228:231]
  s_waitcnt lgkmcnt(2)
  v_mfma_f32_16x16x32_bf16 v[224:227], a[212:215], a[20:23], v[224:227]
  v_mfma_f32_16x16x32_bf16 v[228:231], a[212:215], a[52:55], v[228:231]
  s_waitcnt lgkmcnt(1)
  v_mfma_f32_16x16x32_bf16 v[224:227], a[216:219], a[24:27], v[224:227]
  v_mfma_f32_16x16x32_bf16 v[228:231], a[216:219], a[56:59], v[228:231]
  s_waitcnt lgkmcnt(0)
  v_mfma_f32_16x16x32_bf16 v[224:227], a[220:223], a[28:31], v[224:227]
  s_add_u32 m0, s29, 39936
  s_nop 0
  buffer_load_dwordx4 v23, s[12:15], s42 offen nt lds
  v_mfma_f32_16x16x32_bf16 v[228:231], a[220:223], a[60:63], v[228:231]
  ds_read_b128 a[224:227], v49 offset:0
  ds_read_b128 a[228:231], v51 offset:0
  ds_read_b128 a[232:235], v53 offset:0
  ds_read_b128 a[236:239], v55 offset:0
  ds_read_b128 a[240:243], v49 offset:256
  ds_read_b128 a[244:247], v51 offset:256
  ds_read_b128 a[248:251], v53 offset:256
  s_waitcnt lgkmcnt(6)
  v_mfma_f32_16x16x32_bf16 v[232:235], a[224:227], a[64:67], 0
  v_max3_f32 v31, v31, v224, v225
  v_max3_f32 v31, v31, v226, v227
  ds_read_b128 a[252:255], v55 offset:256
  s_waitcnt lgkmcnt(6)
  v_mfma_f32_16x16x32_bf16 v[232:235], a[228:231], a[68:71], v[232:235]
  v_cvt_pk_bf16_f32 v134, v224, v225
  v_cvt_pk_bf16_f32 v135, v226, v227
  s_waitcnt lgkmcnt(5)
  v_mfma_f32_16x16x32_bf16 v[232:235], a[232:235], a[72:75], v[232:235]
  v_max3_f32 v32, v32, v228, v229
  v_max3_f32 v32, v32, v230, v231
  s_waitcnt lgkmcnt(4)
  v_mfma_f32_16x16x32_bf16 v[232:235], a[236:239], a[76:79], v[232:235]
  v_cvt_pk_bf16_f32 v198, v228, v229
  v_cvt_pk_bf16_f32 v199, v230, v231
  s_waitcnt lgkmcnt(3)
  v_mfma_f32_16x16x32_bf16 v[232:235], a[240:243], a[80:83], v[232:235]
  s_waitcnt lgkmcnt(2)
  v_mfma_f32_16x16x32_bf16 v[232:235], a[244:247], a[84:87], v[232:235]
  s_waitcnt lgkmcnt(1)
  v_mfma_f32_16x16x32_bf16 v[232:235], a[248:251], a[88:91], v[232:235]
  s_waitcnt lgkmcnt(0)
  v_mfma_f32_16x16x32_bf16 v[232:235], a[252:255], a[92:95], v[232:235]
  s_nop 7
  v_max3_f32 v33, v33, v232, v233
  v_max3_f32 v33, v33, v234, v235
  v_cvt_pk_bf16_f32 v214, v232, v233
  v_cvt_pk_bf16_f32 v215, v234, v235
  ds_bpermute_b32 v4, v29, v31
  s_waitcnt lgkmcnt(0)
  v_max_f32 v31, v31, v4
  ds_bpermute_b32 v4, v30, v31
  s_waitcnt lgkmcnt(0)
  v_max_f32 v31, v31, v4
  ds_bpermute_b32 v4, v29, v32
  s_waitcnt lgkmcnt(0)
  v_max_f32 v32, v32, v4
  ds_bpermute_b32 v4, v30, v32
  s_waitcnt lgkmcnt(0)
  v_max_f32 v32, v32, v4
  ds_bpermute_b32 v4, v29, v33
  s_waitcnt lgkmcnt(0)
  v_max_f32 v33, v33, v4
  ds_bpermute_b32 v4, v30, v33
  s_waitcnt lgkmcnt(0)
  v_max_f32 v33, v33, v4
  v_lshlrev_b32 v8, 2, v1
  v_add_u32 v8, 131072, v8
  s_lshl_b32 s3, s28, 8
  v_add_u32 v9, s3, v8
  ds_write_b32 v9, v33 offset:0
  s_waitcnt lgkmcnt(0)
  v_lshrrev_b32 v4, 2, v3
  v_and_b32 v5, 3, v3
  v_lshl_add_u32 v6, v2, 2, v4
  v_and_b32 v8, 7, v6
  v_lshlrev_b32 v6, 9, v6
  v_and_b32 v9, 1, v5
  v_lshl_add_u32 v6, v9, 3, v6
  v_lshrrev_b32 v9, 1, v5
  s_lshl_b32 s5, s28, 13
  v_xor_b32 v7, 0, v8
  v_lshl_add_u32 v7, v7, 1, v9
  v_lshl_add_u32 v40, v7, 4, v6
  v_add_u32 v41, 0x10000, v40
  v_add_u32 v56, s5, v40
  v_add_u32 v57, s5, v41
  v_xor_b32 v7, 1, v8
  v_lshl_add_u32 v7, v7, 1, v9
  v_lshl_add_u32 v42, v7, 4, v6
  v_add_u32 v43, 0x10000, v42
  v_add_u32 v58, s5, v42
  v_add_u32 v59, s5, v43
  v_xor_b32 v7, 2, v8
  v_lshl_add_u32 v7, v7, 1, v9
  v_lshl_add_u32 v44, v7, 4, v6
  v_add_u32 v45, 0x10000, v44
  v_add_u32 v60, s5, v44
  v_add_u32 v61, s5, v45
  v_xor_b32 v7, 3, v8
  v_lshl_add_u32 v7, v7, 1, v9
  v_lshl_add_u32 v46, v7, 4, v6
  v_add_u32 v47, 0x10000, v46
  v_add_u32 v62, s5, v46
  v_add_u32 v63, s5, v47
  v_xor_b32 v7, 4, v8
  v_lshl_add_u32 v7, v7, 1, v9
  v_lshl_add_u32 v48, v7, 4, v6
  v_add_u32 v49, 0x10000, v48
  v_add_u32 v64, s5, v48
  v_add_u32 v65, s5, v49
  v_xor_b32 v7, 5, v8
  v_lshl_add_u32 v7, v7, 1, v9
  v_lshl_add_u32 v50, v7, 4, v6
  v_add_u32 v51, 0x10000, v50
  v_add_u32 v66, s5, v50
  v_add_u32 v67, s5, v51
  v_xor_b32 v7, 6, v8
  v_lshl_add_u32 v7, v7, 1, v9
  v_lshl_add_u32 v52, v7, 4, v6
  v_add_u32 v53, 0x10000, v52
  v_add_u32 v68, s5, v52
  v_add_u32 v69, s5, v53
  v_xor_b32 v7, 7, v8
  v_lshl_add_u32 v7, v7, 1, v9
  v_lshl_add_u32 v54, v7, 4, v6
  v_add_u32 v55, 0x10000, v54
  v_add_u32 v70, s5, v54
  v_add_u32 v71, s5, v55
  s_waitcnt vmcnt(16)
  s_barrier
  v_lshlrev_b32 v8, 2, v1
  v_add_u32 v8, 131072, v8
  ds_read_b32 v240, v8 offset:0
  ds_read_b32 v241, v8 offset:256
  ds_read_b32 v242, v8 offset:512
  ds_read_b32 v243, v8 offset:768
  s_waitcnt lgkmcnt(2)
  v_max_f32 v240, v240, v241
  s_waitcnt lgkmcnt(0)
  v_max_f32 v242, v242, v243
  v_max_f32 v33, v240, v242
  v_mul_f32 v37, s30, v31
  v_mov_b32 v34, 0
  v_mul_f32 v38, s30, v32
  v_mov_b32 v35, 0
  v_mul_f32 v39, s30, v33
  v_mov_b32 v36, 0
  v_lshlrev_b32 v240, 16, v72
  v_and_b32 v241, 0xffff0000, v72
  v_fma_f32 v240, v240, s30, -v37
  v_fma_f32 v241, v241, s30, -v37
  v_exp_f32 v242, v240
  v_exp_f32 v243, v241
  v_add_f32 v34, v34, v242
  v_add_f32 v34, v34, v243
  v_cvt_pk_bf16_f32 v72, v242, v243
  v_lshlrev_b32 v244, 16, v73
  v_and_b32 v245, 0xffff0000, v73
  v_fma_f32 v244, v244, s30, -v37
  v_fma_f32 v245, v245, s30, -v37
  v_exp_f32 v246, v244
  v_exp_f32 v247, v245
  v_add_f32 v34, v34, v246
  v_add_f32 v34, v34, v247
  v_cvt_pk_bf16_f32 v73, v246, v247
  v_lshlrev_b32 v248, 16, v74
  v_and_b32 v249, 0xffff0000, v74
  v_fma_f32 v248, v248, s30, -v37
  v_fma_f32 v249, v249, s30, -v37
  v_exp_f32 v250, v248
  v_exp_f32 v251, v249
  v_add_f32 v34, v34, v250
  v_add_f32 v34, v34, v251
  v_cvt_pk_bf16_f32 v74, v250, v251
  v_lshlrev_b32 v252, 16, v75
  v_and_b32 v253, 0xffff0000, v75
  v_fma_f32 v252, v252, s30, -v37
  v_fma_f32 v253, v253, s30, -v37
  v_exp_f32 v254, v252
  v_exp_f32 v255, v253
  v_add_f32 v34, v34, v254
  v_add_f32 v34, v34, v255
  v_cvt_pk_bf16_f32 v75, v254, v255
  v_lshlrev_b32 v240, 16, v76
  v_and_b32 v241, 0xffff0000, v76
  v_fma_f32 v240, v240, s30, -v37
  v_fma_f32 v241, v241, s30, -v37
  v_exp_f32 v242, v240
  v_exp_f32 v243, v241
  v_add_f32 v34, v34, v242
  v_add_f32 v34, v34, v243
  v_cvt_pk_bf16_f32 v76, v242, v243
  v_lshlrev_b32 v244, 16, v77
  v_and_b32 v245, 0xffff0000, v77
  v_fma_f32 v244, v244, s30, -v37
  v_fma_f32 v245, v245, s30, -v37
  v_exp_f32 v246, v244
  v_exp_f32 v247, v245
  v_add_f32 v34, v34, v246
  v_add_f32 v34, v34, v247
  v_cvt_pk_bf16_f32 v77, v246, v247
  v_lshlrev_b32 v248, 16, v78
  v_and_b32 v249, 0xffff0000, v78
  v_fma_f32 v248, v248, s30, -v37
  v_fma_f32 v249, v249, s30, -v37
  v_exp_f32 v250, v248
  v_exp_f32 v251, v249
  v_add_f32 v34, v34, v250
  v_add_f32 v34, v34, v251
  v_cvt_pk_bf16_f32 v78, v250, v251
  v_lshlrev_b32 v252, 16, v79
  v_and_b32 v253, 0xffff0000, v79
  v_fma_f32 v252, v252, s30, -v37
  v_fma_f32 v253, v253, s30, -v37
  v_exp_f32 v254, v252
  v_exp_f32 v255, v253
  v_add_f32 v34, v34, v254
  v_add_f32 v34, v34, v255
  v_cvt_pk_bf16_f32 v79, v254, v255
  v_lshlrev_b32 v240, 16, v136
  v_and_b32 v241, 0xffff0000, v136
  v_fma_f32 v240, v240, s30, -v38
  v_fma_f32 v241, v241, s30, -v38
  v_exp_f32 v242, v240
  v_exp_f32 v243, v241
  v_add_f32 v35, v35, v242
  v_add_f32 v35, v35, v243
  v_cvt_pk_bf16_f32 v136, v242, v243
  v_lshlrev_b32 v244, 16, v137
  v_and_b32 v245, 0xffff0000, v137
  v_fma_f32 v244, v244, s30, -v38
  v_fma_f32 v245, v245, s30, -v38
  v_exp_f32 v246, v244
  v_exp_f32 v247, v245
  v_add_f32 v35, v35, v246
  v_add_f32 v35, v35, v247
  v_cvt_pk_bf16_f32 v137, v246, v247
  v_lshlrev_b32 v248, 16, v138
  v_and_b32 v249, 0xffff0000, v138
  v_fma_f32 v248, v248, s30, -v38
  v_fma_f32 v249, v249, s30, -v38
  v_exp_f32 v250, v248
  v_exp_f32 v251, v249
  v_add_f32 v35, v35, v250
  v_add_f32 v35, v35, v251
  v_cvt_pk_bf16_f32 v138, v250, v251
  v_lshlrev_b32 v252, 16, v139
  v_and_b32 v253, 0xffff0000, v139
  v_fma_f32 v252, v252, s30, -v38
  v_fma_f32 v253, v253, s30, -v38
  v_exp_f32 v254, v252
  v_exp_f32 v255, v253
  v_add_f32 v35, v35, v254
  v_add_f32 v35, v35, v255
  v_cvt_pk_bf16_f32 v139, v254, v255
  v_lshlrev_b32 v240, 16, v140
  v_and_b32 v241, 0xffff0000, v140
  v_fma_f32 v240, v240, s30, -v38
  v_fma_f32 v241, v241, s30, -v38
  v_exp_f32 v242, v240
  v_exp_f32 v243, v241
  v_add_f32 v35, v35, v242
  v_add_f32 v35, v35, v243
  v_cvt_pk_bf16_f32 v140, v242, v243
  v_lshlrev_b32 v244, 16, v141
  v_and_b32 v245, 0xffff0000, v141
  v_fma_f32 v244, v244, s30, -v38
  v_fma_f32 v245, v245, s30, -v38
  v_exp_f32 v246, v244
  v_exp_f32 v247, v245
  v_add_f32 v35, v35, v246
  v_add_f32 v35, v35, v247
  v_cvt_pk_bf16_f32 v141, v246, v247
  v_lshlrev_b32 v248, 16, v142
  v_and_b32 v249, 0xffff0000, v142
  v_fma_f32 v248, v248, s30, -v38
  v_fma_f32 v249, v249, s30, -v38
  v_exp_f32 v250, v248
  v_exp_f32 v251, v249
  v_add_f32 v35, v35, v250
  v_add_f32 v35, v35, v251
  v_cvt_pk_bf16_f32 v142, v250, v251
  v_lshlrev_b32 v252, 16, v143
  v_and_b32 v253, 0xffff0000, v143
  v_fma_f32 v252, v252, s30, -v38
  v_fma_f32 v253, v253, s30, -v38
  v_exp_f32 v254, v252
  v_exp_f32 v255, v253
  v_add_f32 v35, v35, v254
  v_add_f32 v35, v35, v255
  v_cvt_pk_bf16_f32 v143, v254, v255
  v_lshlrev_b32 v240, 16, v200
  v_and_b32 v241, 0xffff0000, v200
  v_fma_f32 v240, v240, s30, -v39
  v_fma_f32 v241, v241, s30, -v39
  v_exp_f32 v242, v240
  v_exp_f32 v243, v241
  v_add_f32 v36, v36, v242
  v_add_f32 v36, v36, v243
  v_cvt_pk_bf16_f32 v200, v242, v243
  v_lshlrev_b32 v244, 16, v201
  v_and_b32 v245, 0xffff0000, v201
  v_fma_f32 v244, v244, s30, -v39
  v_fma_f32 v245, v245, s30, -v39
  v_exp_f32 v246, v244
  v_exp_f32 v247, v245
  v_add_f32 v36, v36, v246
  v_add_f32 v36, v36, v247
  v_cvt_pk_bf16_f32 v201, v246, v247
  ds_read_b64_tr_b16 a[192:193], v41 offset:32768
  ds_read_b64_tr_b16 a[194:195], v41 offset:40960
  ds_read_b64_tr_b16 a[196:197], v43 offset:32768
  ds_read_b64_tr_b16 a[198:199], v43 offset:40960
  ds_read_b64_tr_b16 a[200:201], v45 offset:32768
  ds_read_b64_tr_b16 a[202:203], v45 offset:40960
  ds_read_b64_tr_b16 a[204:205], v47 offset:32768
  ds_read_b64_tr_b16 a[206:207], v47 offset:40960
  ds_read_b64_tr_b16 a[208:209], v49 offset:32768
  ds_read_b64_tr_b16 a[210:211], v49 offset:40960
  ds_read_b64_tr_b16 a[212:213], v51 offset:32768
  ds_read_b64_tr_b16 a[214:215], v51 offset:40960
  ds_read_b64_tr_b16 a[216:217], v53 offset:32768
  ds_read_b64_tr_b16 a[218:219], v53 offset:40960
  s_waitcnt lgkmcnt(12)
  v_mfma_f32_16x16x32_bf16 a[0:3], a[192:195], v[72:75], 0
  v_lshlrev_b32 v240, 16, v80
  v_and_b32 v241, 0xffff0000, v80
  v_mfma_f32_16x16x32_bf16 a[64:67], a[192:195], v[136:139], 0
  v_fma_f32 v240, v240, s30, -v37
  v_fma_f32 v241, v241, s30, -v37
  ds_read_b64_tr_b16 a[220:221], v55 offset:32768
  ds_read_b64_tr_b16 a[222:223], v55 offset:40960
  s_waitcnt lgkmcnt(12)
  v_mfma_f32_16x16x32_bf16 a[4:7], a[196:199], v[72:75], 0
  v_exp_f32 v242, v240
  v_exp_f32 v243, v241
  v_mfma_f32_16x16x32_bf16 a[68:71], a[196:199], v[136:139], 0
  v_add_f32 v34, v34, v242
  v_add_f32 v34, v34, v243
  ds_read_b64_tr_b16 a[224:225], v41 offset:33024
  ds_read_b64_tr_b16 a[226:227], v41 offset:41216
  s_waitcnt lgkmcnt(12)
  v_mfma_f32_16x16x32_bf16 a[8:11], a[200:203], v[72:75], 0
  v_cvt_pk_bf16_f32 v80, v242, v243
  v_lshlrev_b32 v244, 16, v81
  v_mfma_f32_16x16x32_bf16 a[72:75], a[200:203], v[136:139], 0
  v_and_b32 v245, 0xffff0000, v81
  v_fma_f32 v244, v244, s30, -v37
  ds_read_b64_tr_b16 a[228:229], v43 offset:33024
  ds_read_b64_tr_b16 a[230:231], v43 offset:41216
  s_waitcnt lgkmcnt(12)
  v_mfma_f32_16x16x32_bf16 a[12:15], a[204:207], v[72:75], 0
  v_fma_f32 v245, v245, s30, -v37
  v_exp_f32 v246, v244
  v_mfma_f32_16x16x32_bf16 a[76:79], a[204:207], v[136:139], 0
  v_exp_f32 v247, v245
  v_add_f32 v34, v34, v246
  s_add_u32 s31, s43, 3
  s_and_b32 s31, s31, 7
  s_lshl_b32 s31, s31, 15
  ds_read_b64_tr_b16 a[232:233], v45 offset:33024
  ds_read_b64_tr_b16 a[234:235], v45 offset:41216
  s_waitcnt lgkmcnt(12)
  v_mfma_f32_16x16x32_bf16 a[16:19], a[208:211], v[72:75], 0
  v_add_f32 v34, v34, v247
  v_cvt_pk_bf16_f32 v81, v246, v247
  v_mfma_f32_16x16x32_bf16 a[80:83], a[208:211], v[136:139], 0
  v_lshlrev_b32 v248, 16, v82
  v_and_b32 v249, 0xffff0000, v82
  ds_read_b64_tr_b16 a[236:237], v47 offset:33024
  ds_read_b64_tr_b16 a[238:239], v47 offset:41216
  s_waitcnt lgkmcnt(12)
  v_mfma_f32_16x16x32_bf16 a[20:23], a[212:215], v[72:75], 0
  v_fma_f32 v248, v248, s30, -v37
  v_fma_f32 v249, v249, s30, -v37
  v_mfma_f32_16x16x32_bf16 a[84:87], a[212:215], v[136:139], 0
  v_exp_f32 v250, v248
  v_exp_f32 v251, v249
  ds_read_b64_tr_b16 a[240:241], v49 offset:33024
  ds_read_b64_tr_b16 a[242:243], v49 offset:41216
  s_waitcnt lgkmcnt(12)
  v_mfma_f32_16x16x32_bf16 a[24:27], a[216:219], v[72:75], 0
  v_add_f32 v34, v34, v250
  v_add_f32 v34, v34, v251
  v_mfma_f32_16x16x32_bf16 a[88:91], a[216:219], v[136:139], 0
  v_cvt_pk_bf16_f32 v82, v250, v251
  v_lshlrev_b32 v252, 16, v83
  ds_read_b64_tr_b16 a[244:245], v51 offset:33024
  ds_read_b64_tr_b16 a[246:247], v51 offset:41216
  s_waitcnt lgkmcnt(12)
  v_mfma_f32_16x16x32_bf16 a[28:31], a[220:223], v[72:75], 0
  v_and_b32 v253, 0xffff0000, v83
  v_fma_f32 v252, v252, s30, -v37
  v_mfma_f32_16x16x32_bf16 a[92:95], a[220:223], v[136:139], 0
  v_fma_f32 v253, v253, s30, -v37
  v_exp_f32 v254, v252
  s_add_u32 m0, s29, 65536
  s_nop 0
  buffer_load_dwordx4 v16, s[12:15], s31 offen nt lds
  ds_read_b64_tr_b16 a[248:249], v53 offset:33024
  ds_read_b64_tr_b16 a[250:251], v53 offset:41216
  s_waitcnt lgkmcnt(12)
  v_mfma_f32_16x16x32_bf16 a[32:35], a[224:227], v[72:75], 0
  v_exp_f32 v255, v253
  v_add_f32 v34, v34, v254
  v_mfma_f32_16x16x32_bf16 a[96:99], a[224:227], v[136:139], 0
  v_add_f32 v34, v34, v255
  v_cvt_pk_bf16_f32 v83, v254, v255
  ds_read_b64_tr_b16 a[252:253], v55 offset:33024
  ds_read_b64_tr_b16 a[254:255], v55 offset:41216
  s_waitcnt lgkmcnt(12)
  v_mfma_f32_16x16x32_bf16 a[36:39], a[228:231], v[72:75], 0
  v_lshlrev_b32 v240, 16, v84
  v_and_b32 v241, 0xffff0000, v84
  v_mfma_f32_16x16x32_bf16 a[100:103], a[228:231], v[136:139], 0
  v_fma_f32 v240, v240, s30, -v37
  v_fma_f32 v241, v241, s30, -v37
  ds_read_b64_tr_b16 a[192:193], v41 offset:49152
  ds_read_b64_tr_b16 a[194:195], v41 offset:57344
  s_waitcnt lgkmcnt(12)
  v_mfma_f32_16x16x32_bf16 a[40:43], a[232:235], v[72:75], 0
  v_exp_f32 v242, v240
  v_exp_f32 v243, v241
  v_mfma_f32_16x16x32_bf16 a[104:107], a[232:235], v[136:139], 0
  v_add_f32 v34, v34, v242
  v_add_f32 v34, v34, v243
  ds_read_b64_tr_b16 a[196:197], v43 offset:49152
  ds_read_b64_tr_b16 a[198:199], v43 offset:57344
  s_waitcnt lgkmcnt(12)
  v_mfma_f32_16x16x32_bf16 a[44:47], a[236:239], v[72:75], 0
  v_cvt_pk_bf16_f32 v84, v242, v243
  v_lshlrev_b32 v244, 16, v85
  v_mfma_f32_16x16x32_bf16 a[108:111], a[236:239], v[136:139], 0
  v_and_b32 v245, 0xffff0000, v85
  v_fma_f32 v244, v244, s30, -v37
  s_add_u32 m0, s29, 66560
  s_nop 0
  buffer_load_dwordx4 v17, s[12:15], s31 offen nt lds
  ds_read_b64_tr_b16 a[200:201], v45 offset:49152
  ds_read_b64_tr_b16 a[202:203], v45 offset:57344
  s_waitcnt lgkmcnt(12)
  v_mfma_f32_16x16x32_bf16 a[48:51], a[240:243], v[72:75], 0
  v_fma_f32 v245, v245, s30, -v37
  v_exp_f32 v246, v244
  v_mfma_f32_16x16x32_bf16 a[112:115], a[240:243], v[136:139], 0
  v_exp_f32 v247, v245
  v_add_f32 v34, v34, v246
  ds_read_b64_tr_b16 a[204:205], v47 offset:49152
  ds_read_b64_tr_b16 a[206:207], v47 offset:57344
  s_waitcnt lgkmcnt(12)
  v_mfma_f32_16x16x32_bf16 a[52:55], a[244:247], v[72:75], 0
  v_add_f32 v34, v34, v247
  v_cvt_pk_bf16_f32 v85, v246, v247
  v_mfma_f32_16x16x32_bf16 a[116:119], a[244:247], v[136:139], 0
  v_lshlrev_b32 v248, 16, v86
  v_and_b32 v249, 0xffff0000, v86
  ds_read_b64_tr_b16 a[208:209], v49 offset:49152
  ds_read_b64_tr_b16 a[210:211], v49 offset:57344
  s_waitcnt lgkmcnt(12)
  v_mfma_f32_16x16x32_bf16 a[56:59], a[248:251], v[72:75], 0
  v_fma_f32 v248, v248, s30, -v37
  v_fma_f32 v249, v249, s30, -v37
  v_mfma_f32_16x16x32_bf16 a[120:123], a[248:251], v[136:139], 0
  v_exp_f32 v250, v248
  v_exp_f32 v251, v249
  ds_read_b64_tr_b16 a[212:213], v51 offset:49152
  ds_read_b64_tr_b16 a[214:215], v51 offset:57344
  s_waitcnt lgkmcnt(12)
  v_mfma_f32_16x16x32_bf16 a[60:63], a[252:255], v[72:75], 0
  v_add_f32 v34, v34, v250
  v_add_f32 v34, v34, v251
  v_mfma_f32_16x16x32_bf16 a[124:127], a[252:255], v[136:139], 0
  v_cvt_pk_bf16_f32 v86, v250, v251
  v_lshlrev_b32 v252, 16, v87
  s_add_u32 m0, s29, 67584
  s_nop 0
  buffer_load_dwordx4 v18, s[12:15], s31 offen nt lds
  ds_read_b64_tr_b16 a[216:217], v53 offset:49152
  ds_read_b64_tr_b16 a[218:219], v53 offset:57344
  s_waitcnt lgkmcnt(12)
  v_mfma_f32_16x16x32_bf16 a[0:3], a[192:195], v[76:79], a[0:3]
  v_and_b32 v253, 0xffff0000, v87
  v_fma_f32 v252, v252, s30, -v37
  v_mfma_f32_16x16x32_bf16 a[64:67], a[192:195], v[140:143], a[64:67]
  v_fma_f32 v253, v253, s30, -v37
  v_exp_f32 v254, v252
  ds_read_b64_tr_b16 a[220:221], v55 offset:49152
  ds_read_b64_tr_b16 a[222:223], v55 offset:57344
  s_waitcnt lgkmcnt(12)
  v_mfma_f32_16x16x32_bf16 a[4:7], a[196:199], v[76:79], a[4:7]
  v_exp_f32 v255, v253
  v_add_f32 v34, v34, v254
  v_mfma_f32_16x16x32_bf16 a[68:71], a[196:199], v[140:143], a[68:71]
  v_add_f32 v34, v34, v255
  v_cvt_pk_bf16_f32 v87, v254, v255
  ds_read_b64_tr_b16 a[224:225], v41 offset:49408
  ds_read_b64_tr_b16 a[226:227], v41 offset:57600
  s_waitcnt lgkmcnt(12)
  v_mfma_f32_16x16x32_bf16 a[8:11], a[200:203], v[76:79], a[8:11]
  v_lshlrev_b32 v240, 16, v144
  v_and_b32 v241, 0xffff0000, v144
  v_mfma_f32_16x16x32_bf16 a[72:75], a[200:203], v[140:143], a[72:75]
  v_fma_f32 v240, v240, s30, -v38
  v_fma_f32 v241, v241, s30, -v38
  ds_read_b64_tr_b16 a[228:229], v43 offset:49408
  ds_read_b64_tr_b16 a[230:231], v43 offset:57600
  s_waitcnt lgkmcnt(12)
  v_mfma_f32_16x16x32_bf16 a[12:15], a[204:207], v[76:79], a[12:15]
  v_exp_f32 v242, v240
  v_exp_f32 v243, v241
  v_mfma_f32_16x16x32_bf16 a[76:79], a[204:207], v[140:143], a[76:79]
  v_add_f32 v35, v35, v242
  v_add_f32 v35, v35, v243
  s_add_u32 m0, s29, 68608
  s_nop 0
  buffer_load_dwordx4 v19, s[12:15], s31 offen nt lds
  ds_read_b64_tr_b16 a[232:233], v45 offset:49408
  ds_read_b64_tr_b16 a[234:235], v45 offset:57600
  s_waitcnt lgkmcnt(12)
  v_mfma_f32_16x16x32_bf16 a[16:19], a[208:211], v[76:79], a[16:19]
  v_cvt_pk_bf16_f32 v144, v242, v243
  v_lshlrev_b32 v244, 16, v145
  v_mfma_f32_16x16x32_bf16 a[80:83], a[208:211], v[140:143], a[80:83]
  v_and_b32 v245, 0xffff0000, v145
  v_fma_f32 v244, v244, s30, -v38
  ds_read_b64_tr_b16 a[236:237], v47 offset:49408
  ds_read_b64_tr_b16 a[238:239], v47 offset:57600
  s_waitcnt lgkmcnt(12)
  v_mfma_f32_16x16x32_bf16 a[20:23], a[212:215], v[76:79], a[20:23]
  v_fma_f32 v245, v245, s30, -v38
  v_exp_f32 v246, v244
  v_mfma_f32_16x16x32_bf16 a[84:87], a[212:215], v[140:143], a[84:87]
  v_exp_f32 v247, v245
  v_add_f32 v35, v35, v246
  ds_read_b64_tr_b16 a[240:241], v49 offset:49408
  ds_read_b64_tr_b16 a[242:243], v49 offset:57600
  s_waitcnt lgkmcnt(12)
  v_mfma_f32_16x16x32_bf16 a[24:27], a[216:219], v[76:79], a[24:27]
  v_add_f32 v35, v35, v247
  v_cvt_pk_bf16_f32 v145, v246, v247
  v_mfma_f32_16x16x32_bf16 a[88:91], a[216:219], v[140:143], a[88:91]
  v_lshlrev_b32 v248, 16, v146
  v_and_b32 v249, 0xffff0000, v146
  ds_read_b64_tr_b16 a[244:245], v51 offset:49408
  ds_read_b64_tr_b16 a[246:247], v51 offset:57600
  s_waitcnt lgkmcnt(12)
  v_mfma_f32_16x16x32_bf16 a[28:31], a[220:223], v[76:79], a[28:31]
  v_fma_f32 v248, v248, s30, -v38
  v_fma_f32 v249, v249, s30, -v38
  v_mfma_f32_16x16x32_bf16 a[92:95], a[220:223], v[140:143], a[92:95]
  v_exp_f32 v250, v248
  v_exp_f32 v251, v249
  s_add_u32 m0, s29, 69632
  s_nop 0
  buffer_load_dwordx4 v20, s[12:15], s31 offen nt lds
  ds_read_b64_tr_b16 a[248:249], v53 offset:49408
  ds_read_b64_tr_b16 a[250:251], v53 offset:57600
  s_waitcnt lgkmcnt(12)
  v_mfma_f32_16x16x32_bf16 a[32:35], a[224:227], v[76:79], a[32:35]
  v_add_f32 v35, v35, v250
  v_add_f32 v35, v35, v251
  v_mfma_f32_16x16x32_bf16 a[96:99], a[224:227], v[140:143], a[96:99]
  v_cvt_pk_bf16_f32 v146, v250, v251
  v_lshlrev_b32 v252, 16, v147
  ds_read_b64_tr_b16 a[252:253], v55 offset:49408
  ds_read_b64_tr_b16 a[254:255], v55 offset:57600
  s_waitcnt lgkmcnt(12)
  v_mfma_f32_16x16x32_bf16 a[36:39], a[228:231], v[76:79], a[36:39]
  v_and_b32 v253, 0xffff0000, v147
  v_fma_f32 v252, v252, s30, -v38
  v_mfma_f32_16x16x32_bf16 a[100:103], a[228:231], v[140:143], a[100:103]
  v_fma_f32 v253, v253, s30, -v38
  v_exp_f32 v254, v252
  ds_read_b64_tr_b16 a[192:193], v57 offset:32768
  s_waitcnt lgkmcnt(11)
  v_mfma_f32_16x16x32_bf16 a[40:43], a[232:235], v[76:79], a[40:43]
  v_exp_f32 v255, v253
  v_add_f32 v35, v35, v254
  v_mfma_f32_16x16x32_bf16 a[104:107], a[232:235], v[140:143], a[104:107]
  v_add_f32 v35, v35, v255
  v_cvt_pk_bf16_f32 v147, v254, v255
  ds_read_b64_tr_b16 a[196:197], v59 offset:32768
  s_waitcnt lgkmcnt(10)
  v_mfma_f32_16x16x32_bf16 a[44:47], a[236:239], v[76:79], a[44:47]
  v_lshlrev_b32 v240, 16, v148
  v_and_b32 v241, 0xffff0000, v148
  v_mfma_f32_16x16x32_bf16 a[108:111], a[236:239], v[140:143], a[108:111]
  v_fma_f32 v240, v240, s30, -v38
  v_fma_f32 v241, v241, s30, -v38
  s_add_u32 m0, s29, 70656
  s_nop 0
  buffer_load_dwordx4 v21, s[12:15], s31 offen nt lds
  ds_read_b64_tr_b16 a[200:201], v61 offset:32768
  s_waitcnt lgkmcnt(9)
  v_mfma_f32_16x16x32_bf16 a[48:51], a[240:243], v[76:79], a[48:51]
  v_exp_f32 v242, v240
  v_exp_f32 v243, v241
  v_mfma_f32_16x16x32_bf16 a[112:115], a[240:243], v[140:143], a[112:115]
  v_add_f32 v35, v35, v242
  v_add_f32 v35, v35, v243
  ds_read_b64_tr_b16 a[204:205], v63 offset:32768
  s_waitcnt lgkmcnt(8)
  v_mfma_f32_16x16x32_bf16 a[52:55], a[244:247], v[76:79], a[52:55]
  v_cvt_pk_bf16_f32 v148, v242, v243
  v_lshlrev_b32 v244, 16, v149
  v_mfma_f32_16x16x32_bf16 a[116:119], a[244:247], v[140:143], a[116:119]
  v_and_b32 v245, 0xffff0000, v149
  v_fma_f32 v244, v244, s30, -v38
  ds_read_b64_tr_b16 a[208:209], v65 offset:32768
  s_waitcnt lgkmcnt(7)
  v_mfma_f32_16x16x32_bf16 a[56:59], a[248:251], v[76:79], a[56:59]
  v_fma_f32 v245, v245, s30, -v38
  v_exp_f32 v246, v244
  v_mfma_f32_16x16x32_bf16 a[120:123], a[248:251], v[140:143], a[120:123]
  v_exp_f32 v247, v245
  v_add_f32 v35, v35, v246
  ds_read_b64_tr_b16 a[212:213], v67 offset:32768
  s_waitcnt lgkmcnt(6)
  v_mfma_f32_16x16x32_bf16 a[60:63], a[252:255], v[76:79], a[60:63]
  v_add_f32 v35, v35, v247
  v_cvt_pk_bf16_f32 v149, v246, v247
  v_mfma_f32_16x16x32_bf16 a[124:127], a[252:255], v[140:143], a[124:127]
  v_lshlrev_b32 v248, 16, v150
  v_and_b32 v249, 0xffff0000, v150
  s_add_u32 m0, s29, 71680
  s_nop 0
  buffer_load_dwordx4 v22, s[12:15], s31 offen nt lds
  ds_read_b64_tr_b16 a[216:217], v69 offset:32768
  s_waitcnt lgkmcnt(6)
  v_mfma_f32_16x16x16_bf16 a[128:131], a[192:193], v[200:201], 0
  v_fma_f32 v248, v248, s30, -v38
  v_fma_f32 v249, v249, s30, -v38
  ds_read_b64_tr_b16 a[220:221], v71 offset:32768
  s_waitcnt lgkmcnt(6)
  v_mfma_f32_16x16x16_bf16 a[132:135], a[196:197], v[200:201], 0
  v_exp_f32 v250, v248
  v_exp_f32 v251, v249
  ds_read_b64_tr_b16 a[224:225], v57 offset:33024
  s_waitcnt lgkmcnt(6)
  v_mfma_f32_16x16x16_bf16 a[136:139], a[200:201], v[200:201], 0
  v_add_f32 v35, v35, v250
  v_add_f32 v35, v35, v251
  ds_read_b64_tr_b16 a[228:229], v59 offset:33024
  s_waitcnt lgkmcnt(6)
  v_mfma_f32_16x16x16_bf16 a[140:143], a[204:205], v[200:201], 0
  v_cvt_pk_bf16_f32 v150, v250, v251
  v_lshlrev_b32 v252, 16, v151
  ds_read_b64_tr_b16 a[232:233], v61 offset:33024
  s_waitcnt lgkmcnt(6)
  v_mfma_f32_16x16x16_bf16 a[144:147], a[208:209], v[200:201], 0
  v_and_b32 v253, 0xffff0000, v151
  v_fma_f32 v252, v252, s30, -v38
  ds_read_b64_tr_b16 a[236:237], v63 offset:33024
  s_waitcnt lgkmcnt(6)
  v_mfma_f32_16x16x16_bf16 a[148:151], a[212:213], v[200:201], 0
  v_fma_f32 v253, v253, s30, -v38
  v_exp_f32 v254, v252
  ds_read_b64_tr_b16 a[240:241], v65 offset:33024
  s_waitcnt lgkmcnt(6)
  v_mfma_f32_16x16x16_bf16 a[152:155], a[216:217], v[200:201], 0
  v_exp_f32 v255, v253
  v_add_f32 v35, v35, v254
  ds_read_b64_tr_b16 a[244:245], v67 offset:33024
  s_waitcnt lgkmcnt(6)
  v_mfma_f32_16x16x16_bf16 a[156:159], a[220:221], v[200:201], 0
  v_add_f32 v35, v35, v255
  v_cvt_pk_bf16_f32 v151, v254, v255
  s_add_u32 m0, s29, 72704
  s_nop 0
  buffer_load_dwordx4 v23, s[12:15], s31 offen nt lds
  ds_read_b64_tr_b16 a[248:249], v69 offset:33024
  s_waitcnt lgkmcnt(6)
  v_mfma_f32_16x16x16_bf16 a[160:163], a[224:225], v[200:201], 0
  v_lshlrev_b32 v240, 16, v202
  v_and_b32 v241, 0xffff0000, v202
  ds_read_b64_tr_b16 a[252:253], v71 offset:33024
  s_waitcnt lgkmcnt(6)
  v_mfma_f32_16x16x16_bf16 a[164:167], a[228:229], v[200:201], 0
  v_fma_f32 v240, v240, s30, -v39
  v_fma_f32 v241, v241, s30, -v39
  s_waitcnt lgkmcnt(5)
  v_mfma_f32_16x16x16_bf16 a[168:171], a[232:233], v[200:201], 0
  v_exp_f32 v242, v240
  v_exp_f32 v243, v241
  s_waitcnt lgkmcnt(4)
  v_mfma_f32_16x16x16_bf16 a[172:175], a[236:237], v[200:201], 0
  v_add_f32 v36, v36, v242
  v_add_f32 v36, v36, v243
  s_waitcnt lgkmcnt(3)
  v_mfma_f32_16x16x16_bf16 a[176:179], a[240:241], v[200:201], 0
  v_cvt_pk_bf16_f32 v202, v242, v243
  v_lshlrev_b32 v244, 16, v203
  s_waitcnt lgkmcnt(2)
  v_mfma_f32_16x16x16_bf16 a[180:183], a[244:245], v[200:201], 0
  v_and_b32 v245, 0xffff0000, v203
  v_fma_f32 v244, v244, s30, -v39
  s_waitcnt lgkmcnt(1)
  v_mfma_f32_16x16x16_bf16 a[184:187], a[248:249], v[200:201], 0
  v_fma_f32 v245, v245, s30, -v39
  v_exp_f32 v246, v244
  s_waitcnt lgkmcnt(0)
  v_mfma_f32_16x16x16_bf16 a[188:191], a[252:253], v[200:201], 0
  v_exp_f32 v247, v245
  v_add_f32 v36, v36, v246
  v_add_f32 v36, v36, v247
  v_cvt_pk_bf16_f32 v203, v246, v247
  s_waitcnt vmcnt(16)
  s_barrier
  ds_read_b64_tr_b16 a[192:193], v40 offset:0
  ds_read_b64_tr_b16 a[194:195], v40 offset:8192
  ds_read_b64_tr_b16 a[196:197], v42 offset:0
  ds_read_b64_tr_b16 a[198:199], v42 offset:8192
  ds_read_b64_tr_b16 a[200:201], v44 offset:0
  ds_read_b64_tr_b16 a[202:203], v44 offset:8192
  ds_read_b64_tr_b16 a[204:205], v46 offset:0
  ds_read_b64_tr_b16 a[206:207], v46 offset:8192
  ds_read_b64_tr_b16 a[208:209], v48 offset:0
  ds_read_b64_tr_b16 a[210:211], v48 offset:8192
  ds_read_b64_tr_b16 a[212:213], v50 offset:0
  ds_read_b64_tr_b16 a[214:215], v50 offset:8192
  ds_read_b64_tr_b16 a[216:217], v52 offset:0
  ds_read_b64_tr_b16 a[218:219], v52 offset:8192
  s_waitcnt lgkmcnt(12)
  v_mfma_f32_16x16x32_bf16 a[0:3], a[192:195], v[80:83], a[0:3]
  v_lshlrev_b32 v240, 16, v88
  v_and_b32 v241, 0xffff0000, v88
  v_mfma_f32_16x16x32_bf16 a[64:67], a[192:195], v[144:147], a[64:67]
  v_fma_f32 v240, v240, s30, -v37
  v_fma_f32 v241, v241, s30, -v37
  ds_read_b64_tr_b16 a[220:221], v54 offset:0
  ds_read_b64_tr_b16 a[222:223], v54 offset:8192
  s_waitcnt lgkmcnt(12)
  v_mfma_f32_16x16x32_bf16 a[4:7], a[196:199], v[80:83], a[4:7]
  v_exp_f32 v242, v240
  v_exp_f32 v243, v241
  v_mfma_f32_16x16x32_bf16 a[68:71], a[196:199], v[144:147], a[68:71]
  v_add_f32 v34, v34, v242
  v_add_f32 v34, v34, v243
  ds_read_b64_tr_b16 a[224:225], v40 offset:256
  ds_read_b64_tr_b16 a[226:227], v40 offset:8448
  s_waitcnt lgkmcnt(12)
  v_mfma_f32_16x16x32_bf16 a[8:11], a[200:203], v[80:83], a[8:11]
  v_cvt_pk_bf16_f32 v88, v242, v243
  v_lshlrev_b32 v244, 16, v89
  v_mfma_f32_16x16x32_bf16 a[72:75], a[200:203], v[144:147], a[72:75]
  v_and_b32 v245, 0xffff0000, v89
  v_fma_f32 v244, v244, s30, -v37
  ds_read_b64_tr_b16 a[228:229], v42 offset:256
  ds_read_b64_tr_b16 a[230:231], v42 offset:8448
  s_waitcnt lgkmcnt(12)
  v_mfma_f32_16x16x32_bf16 a[12:15], a[204:207], v[80:83], a[12:15]
  v_fma_f32 v245, v245, s30, -v37
  v_exp_f32 v246, v244
  v_mfma_f32_16x16x32_bf16 a[76:79], a[204:207], v[144:147], a[76:79]
  v_exp_f32 v247, v245
  v_add_f32 v34, v34, v246
  s_add_u32 s42, s43, 4
  s_and_b32 s42, s42, 7
  s_lshl_b32 s42, s42, 15
  ds_read_b64_tr_b16 a[232:233], v44 offset:256
  ds_read_b64_tr_b16 a[234:235], v44 offset:8448
  s_waitcnt lgkmcnt(12)
  v_mfma_f32_16x16x32_bf16 a[16:19], a[208:211], v[80:83], a[16:19]
  v_add_f32 v34, v34, v247
  v_cvt_pk_bf16_f32 v89, v246, v247
  v_mfma_f32_16x16x32_bf16 a[80:83], a[208:211], v[144:147], a[80:83]
  v_lshlrev_b32 v248, 16, v90
  v_and_b32 v249, 0xffff0000, v90
  ds_read_b64_tr_b16 a[236:237], v46 offset:256
  ds_read_b64_tr_b16 a[238:239], v46 offset:8448
  s_waitcnt lgkmcnt(12)
  v_mfma_f32_16x16x32_bf16 a[20:23], a[212:215], v[80:83], a[20:23]
  v_fma_f32 v248, v248, s30, -v37
  v_fma_f32 v249, v249, s30, -v37
  v_mfma_f32_16x16x32_bf16 a[84:87], a[212:215], v[144:147], a[84:87]
  v_exp_f32 v250, v248
  v_exp_f32 v251, v249
  ds_read_b64_tr_b16 a[240:241], v48 offset:256
  ds_read_b64_tr_b16 a[242:243], v48 offset:8448
  s_waitcnt lgkmcnt(12)
  v_mfma_f32_16x16x32_bf16 a[24:27], a[216:219], v[80:83], a[24:27]
  v_add_f32 v34, v34, v250
  v_add_f32 v34, v34, v251
  v_mfma_f32_16x16x32_bf16 a[88:91], a[216:219], v[144:147], a[88:91]
  v_cvt_pk_bf16_f32 v90, v250, v251
  v_lshlrev_b32 v252, 16, v91
  ds_read_b64_tr_b16 a[244:245], v50 offset:256
  ds_read_b64_tr_b16 a[246:247], v50 offset:8448
  s_waitcnt lgkmcnt(12)
  v_mfma_f32_16x16x32_bf16 a[28:31], a[220:223], v[80:83], a[28:31]
  v_and_b32 v253, 0xffff0000, v91
  v_fma_f32 v252, v252, s30, -v37
  v_mfma_f32_16x16x32_bf16 a[92:95], a[220:223], v[144:147], a[92:95]
  v_fma_f32 v253, v253, s30, -v37
  v_exp_f32 v254, v252
  s_add_u32 m0, s29, 98304
  s_nop 0
  buffer_load_dwordx4 v16, s[12:15], s42 offen nt lds
  ds_read_b64_tr_b16 a[248:249], v52 offset:256
  ds_read_b64_tr_b16 a[250:251], v52 offset:8448
  s_waitcnt lgkmcnt(12)
  v_mfma_f32_16x16x32_bf16 a[32:35], a[224:227], v[80:83], a[32:35]
  v_exp_f32 v255, v253
  v_add_f32 v34, v34, v254
  v_mfma_f32_16x16x32_bf16 a[96:99], a[224:227], v[144:147], a[96:99]
  v_add_f32 v34, v34, v255
  v_cvt_pk_bf16_f32 v91, v254, v255
  ds_read_b64_tr_b16 a[252:253], v54 offset:256
  ds_read_b64_tr_b16 a[254:255], v54 offset:8448
  s_waitcnt lgkmcnt(12)
  v_mfma_f32_16x16x32_bf16 a[36:39], a[228:231], v[80:83], a[36:39]
  v_lshlrev_b32 v240, 16, v92
  v_and_b32 v241, 0xffff0000, v92
  v_mfma_f32_16x16x32_bf16 a[100:103], a[228:231], v[144:147], a[100:103]
  v_fma_f32 v240, v240, s30, -v37
  v_fma_f32 v241, v241, s30, -v37
  ds_read_b64_tr_b16 a[192:193], v40 offset:16384
  ds_read_b64_tr_b16 a[194:195], v40 offset:24576
  s_waitcnt lgkmcnt(12)
  v_mfma_f32_16x16x32_bf16 a[40:43], a[232:235], v[80:83], a[40:43]
  v_exp_f32 v242, v240
  v_exp_f32 v243, v241
  v_mfma_f32_16x16x32_bf16 a[104:107], a[232:235], v[144:147], a[104:107]
  v_add_f32 v34, v34, v242
  v_add_f32 v34, v34, v243
  ds_read_b64_tr_b16 a[196:197], v42 offset:16384
  ds_read_b64_tr_b16 a[198:199], v42 offset:24576
  s_waitcnt lgkmcnt(12)
  v_mfma_f32_16x16x32_bf16 a[44:47], a[236:239], v[80:83], a[44:47]
  v_cvt_pk_bf16_f32 v92, v242, v243
  v_lshlrev_b32 v244, 16, v93
  v_mfma_f32_16x16x32_bf16 a[108:111], a[236:239], v[144:147], a[108:111]
  v_and_b32 v245, 0xffff0000, v93
  v_fma_f32 v244, v244, s30, -v37
  s_add_u32 m0, s29, 99328
  s_nop 0
  buffer_load_dwordx4 v17, s[12:15], s42 offen nt lds
  ds_read_b64_tr_b16 a[200:201], v44 offset:16384
  ds_read_b64_tr_b16 a[202:203], v44 offset:24576
  s_waitcnt lgkmcnt(12)
  v_mfma_f32_16x16x32_bf16 a[48:51], a[240:243], v[80:83], a[48:51]
  v_fma_f32 v245, v245, s30, -v37
  v_exp_f32 v246, v244
  v_mfma_f32_16x16x32_bf16 a[112:115], a[240:243], v[144:147], a[112:115]
  v_exp_f32 v247, v245
  v_add_f32 v34, v34, v246
  ds_read_b64_tr_b16 a[204:205], v46 offset:16384
  ds_read_b64_tr_b16 a[206:207], v46 offset:24576
  s_waitcnt lgkmcnt(12)
  v_mfma_f32_16x16x32_bf16 a[52:55], a[244:247], v[80:83], a[52:55]
  v_add_f32 v34, v34, v247
  v_cvt_pk_bf16_f32 v93, v246, v247
  v_mfma_f32_16x16x32_bf16 a[116:119], a[244:247], v[144:147], a[116:119]
  v_lshlrev_b32 v248, 16, v94
  v_and_b32 v249, 0xffff0000, v94
  ds_read_b64_tr_b16 a[208:209], v48 offset:16384
  ds_read_b64_tr_b16 a[210:211], v48 offset:24576
  s_waitcnt lgkmcnt(12)
  v_mfma_f32_16x16x32_bf16 a[56:59], a[248:251], v[80:83], a[56:59]
  v_fma_f32 v248, v248, s30, -v37
  v_fma_f32 v249, v249, s30, -v37
  v_mfma_f32_16x16x32_bf16 a[120:123], a[248:251], v[144:147], a[120:123]
  v_exp_f32 v250, v248
  v_exp_f32 v251, v249
  ds_read_b64_tr_b16 a[212:213], v50 offset:16384
  ds_read_b64_tr_b16 a[214:215], v50 offset:24576
  s_waitcnt lgkmcnt(12)
  v_mfma_f32_16x16x32_bf16 a[60:63], a[252:255], v[80:83], a[60:63]
  v_add_f32 v34, v34, v250
  v_add_f32 v34, v34, v251
  v_mfma_f32_16x16x32_bf16 a[124:127], a[252:255], v[144:147], a[124:127]
  v_cvt_pk_bf16_f32 v94, v250, v251
  v_lshlrev_b32 v252, 16, v95
  s_add_u32 m0, s29, 100352
  s_nop 0
  buffer_load_dwordx4 v18, s[12:15], s42 offen nt lds
  ds_read_b64_tr_b16 a[216:217], v52 offset:16384
  ds_read_b64_tr_b16 a[218:219], v52 offset:24576
  s_waitcnt lgkmcnt(12)
  v_mfma_f32_16x16x32_bf16 a[0:3], a[192:195], v[84:87], a[0:3]
  v_and_b32 v253, 0xffff0000, v95
  v_fma_f32 v252, v252, s30, -v37
  v_mfma_f32_16x16x32_bf16 a[64:67], a[192:195], v[148:151], a[64:67]
  v_fma_f32 v253, v253, s30, -v37
  v_exp_f32 v254, v252
  ds_read_b64_tr_b16 a[220:221], v54 offset:16384
  ds_read_b64_tr_b16 a[222:223], v54 offset:24576
  s_waitcnt lgkmcnt(12)
  v_mfma_f32_16x16x32_bf16 a[4:7], a[196:199], v[84:87], a[4:7]
  v_exp_f32 v255, v253
  v_add_f32 v34, v34, v254
  v_mfma_f32_16x16x32_bf16 a[68:71], a[196:199], v[148:151], a[68:71]
  v_add_f32 v34, v34, v255
  v_cvt_pk_bf16_f32 v95, v254, v255
  ds_read_b64_tr_b16 a[224:225], v40 offset:16640
  ds_read_b64_tr_b16 a[226:227], v40 offset:24832
  s_waitcnt lgkmcnt(12)
  v_mfma_f32_16x16x32_bf16 a[8:11], a[200:203], v[84:87], a[8:11]
  v_lshlrev_b32 v240, 16, v152
  v_and_b32 v241, 0xffff0000, v152
  v_mfma_f32_16x16x32_bf16 a[72:75], a[200:203], v[148:151], a[72:75]
  v_fma_f32 v240, v240, s30, -v38
  v_fma_f32 v241, v241, s30, -v38
  ds_read_b64_tr_b16 a[228:229], v42 offset:16640
  ds_read_b64_tr_b16 a[230:231], v42 offset:24832
  s_waitcnt lgkmcnt(12)
  v_mfma_f32_16x16x32_bf16 a[12:15], a[204:207], v[84:87], a[12:15]
  v_exp_f32 v242, v240
  v_exp_f32 v243, v241
  v_mfma_f32_16x16x32_bf16 a[76:79], a[204:207], v[148:151], a[76:79]
  v_add_f32 v35, v35, v242
  v_add_f32 v35, v35, v243
  s_add_u32 m0, s29, 101376
  s_nop 0
  buffer_load_dwordx4 v19, s[12:15], s42 offen nt lds
  ds_read_b64_tr_b16 a[232:233], v44 offset:16640
  ds_read_b64_tr_b16 a[234:235], v44 offset:24832
  s_waitcnt lgkmcnt(12)
  v_mfma_f32_16x16x32_bf16 a[16:19], a[208:211], v[84:87], a[16:19]
  v_cvt_pk_bf16_f32 v152, v242, v243
  v_lshlrev_b32 v244, 16, v153
  v_mfma_f32_16x16x32_bf16 a[80:83], a[208:211], v[148:151], a[80:83]
  v_and_b32 v245, 0xffff0000, v153
  v_fma_f32 v244, v244, s30, -v38
  ds_read_b64_tr_b16 a[236:237], v46 offset:16640
  ds_read_b64_tr_b16 a[238:239], v46 offset:24832
  s_waitcnt lgkmcnt(12)
  v_mfma_f32_16x16x32_bf16 a[20:23], a[212:215], v[84:87], a[20:23]
  v_fma_f32 v245, v245, s30, -v38
  v_exp_f32 v246, v244
  v_mfma_f32_16x16x32_bf16 a[84:87], a[212:215], v[148:151], a[84:87]
  v_exp_f32 v247, v245
  v_add_f32 v35, v35, v246
  ds_read_b64_tr_b16 a[240:241], v48 offset:16640
  ds_read_b64_tr_b16 a[242:243], v48 offset:24832
  s_waitcnt lgkmcnt(12)
  v_mfma_f32_16x16x32_bf16 a[24:27], a[216:219], v[84:87], a[24:27]
  v_add_f32 v35, v35, v247
  v_cvt_pk_bf16_f32 v153, v246, v247
  v_mfma_f32_16x16x32_bf16 a[88:91], a[216:219], v[148:151], a[88:91]
  v_lshlrev_b32 v248, 16, v154
  v_and_b32 v249, 0xffff0000, v154
  ds_read_b64_tr_b16 a[244:245], v50 offset:16640
  ds_read_b64_tr_b16 a[246:247], v50 offset:24832
  s_waitcnt lgkmcnt(12)
  v_mfma_f32_16x16x32_bf16 a[28:31], a[220:223], v[84:87], a[28:31]
  v_fma_f32 v248, v248, s30, -v38
  v_fma_f32 v249, v249, s30, -v38
  v_mfma_f32_16x16x32_bf16 a[92:95], a[220:223], v[148:151], a[92:95]
  v_exp_f32 v250, v248
  v_exp_f32 v251, v249
  s_add_u32 m0, s29, 102400
  s_nop 0
  buffer_load_dwordx4 v20, s[12:15], s42 offen nt lds
  ds_read_b64_tr_b16 a[248:249], v52 offset:16640
  ds_read_b64_tr_b16 a[250:251], v52 offset:24832
  s_waitcnt lgkmcnt(12)
  v_mfma_f32_16x16x32_bf16 a[32:35], a[224:227], v[84:87], a[32:35]
  v_add_f32 v35, v35, v250
  v_add_f32 v35, v35, v251
  v_mfma_f32_16x16x32_bf16 a[96:99], a[224:227], v[148:151], a[96:99]
  v_cvt_pk_bf16_f32 v154, v250, v251
  v_lshlrev_b32 v252, 16, v155
  ds_read_b64_tr_b16 a[252:253], v54 offset:16640
  ds_read_b64_tr_b16 a[254:255], v54 offset:24832
  s_waitcnt lgkmcnt(12)
  v_mfma_f32_16x16x32_bf16 a[36:39], a[228:231], v[84:87], a[36:39]
  v_and_b32 v253, 0xffff0000, v155
  v_fma_f32 v252, v252, s30, -v38
  v_mfma_f32_16x16x32_bf16 a[100:103], a[228:231], v[148:151], a[100:103]
  v_fma_f32 v253, v253, s30, -v38
  v_exp_f32 v254, v252
  ds_read_b64_tr_b16 a[192:193], v56 offset:0
  s_waitcnt lgkmcnt(11)
  v_mfma_f32_16x16x32_bf16 a[40:43], a[232:235], v[84:87], a[40:43]
  v_exp_f32 v255, v253
  v_add_f32 v35, v35, v254
  v_mfma_f32_16x16x32_bf16 a[104:107], a[232:235], v[148:151], a[104:107]
  v_add_f32 v35, v35, v255
  v_cvt_pk_bf16_f32 v155, v254, v255
  ds_read_b64_tr_b16 a[196:197], v58 offset:0
  s_waitcnt lgkmcnt(10)
  v_mfma_f32_16x16x32_bf16 a[44:47], a[236:239], v[84:87], a[44:47]
  v_lshlrev_b32 v240, 16, v156
  v_and_b32 v241, 0xffff0000, v156
  v_mfma_f32_16x16x32_bf16 a[108:111], a[236:239], v[148:151], a[108:111]
  v_fma_f32 v240, v240, s30, -v38
  v_fma_f32 v241, v241, s30, -v38
  s_add_u32 m0, s29, 103424
  s_nop 0
  buffer_load_dwordx4 v21, s[12:15], s42 offen nt lds
  ds_read_b64_tr_b16 a[200:201], v60 offset:0
  s_waitcnt lgkmcnt(9)
  v_mfma_f32_16x16x32_bf16 a[48:51], a[240:243], v[84:87], a[48:51]
  v_exp_f32 v242, v240
  v_exp_f32 v243, v241
  v_mfma_f32_16x16x32_bf16 a[112:115], a[240:243], v[148:151], a[112:115]
  v_add_f32 v35, v35, v242
  v_add_f32 v35, v35, v243
  ds_read_b64_tr_b16 a[204:205], v62 offset:0
  s_waitcnt lgkmcnt(8)
  v_mfma_f32_16x16x32_bf16 a[52:55], a[244:247], v[84:87], a[52:55]
  v_cvt_pk_bf16_f32 v156, v242, v243
  v_lshlrev_b32 v244, 16, v157
  v_mfma_f32_16x16x32_bf16 a[116:119], a[244:247], v[148:151], a[116:119]
  v_and_b32 v245, 0xffff0000, v157
  v_fma_f32 v244, v244, s30, -v38
  ds_read_b64_tr_b16 a[208:209], v64 offset:0
  s_waitcnt lgkmcnt(7)
  v_mfma_f32_16x16x32_bf16 a[56:59], a[248:251], v[84:87], a[56:59]
  v_fma_f32 v245, v245, s30, -v38
  v_exp_f32 v246, v244
  v_mfma_f32_16x16x32_bf16 a[120:123], a[248:251], v[148:151], a[120:123]
  v_exp_f32 v247, v245
  v_add_f32 v35, v35, v246
  ds_read_b64_tr_b16 a[212:213], v66 offset:0
  s_waitcnt lgkmcnt(6)
  v_mfma_f32_16x16x32_bf16 a[60:63], a[252:255], v[84:87], a[60:63]
  v_add_f32 v35, v35, v247
  v_cvt_pk_bf16_f32 v157, v246, v247
  v_mfma_f32_16x16x32_bf16 a[124:127], a[252:255], v[148:151], a[124:127]
  v_lshlrev_b32 v248, 16, v158
  v_and_b32 v249, 0xffff0000, v158
  s_add_u32 m0, s29, 104448
  s_nop 0
  buffer_load_dwordx4 v22, s[12:15], s42 offen nt lds
  ds_read_b64_tr_b16 a[216:217], v68 offset:0
  s_waitcnt lgkmcnt(6)
  v_mfma_f32_16x16x16_bf16 a[128:131], a[192:193], v[202:203], a[128:131]
  v_fma_f32 v248, v248, s30, -v38
  v_fma_f32 v249, v249, s30, -v38
  ds_read_b64_tr_b16 a[220:221], v70 offset:0
  s_waitcnt lgkmcnt(6)
  v_mfma_f32_16x16x16_bf16 a[132:135], a[196:197], v[202:203], a[132:135]
  v_exp_f32 v250, v248
  v_exp_f32 v251, v249
  ds_read_b64_tr_b16 a[224:225], v56 offset:256
  s_waitcnt lgkmcnt(6)
  v_mfma_f32_16x16x16_bf16 a[136:139], a[200:201], v[202:203], a[136:139]
  v_add_f32 v35, v35, v250
  v_add_f32 v35, v35, v251
  ds_read_b64_tr_b16 a[228:229], v58 offset:256
  s_waitcnt lgkmcnt(6)
  v_mfma_f32_16x16x16_bf16 a[140:143], a[204:205], v[202:203], a[140:143]
  v_cvt_pk_bf16_f32 v158, v250, v251
  v_lshlrev_b32 v252, 16, v159
  ds_read_b64_tr_b16 a[232:233], v60 offset:256
  s_waitcnt lgkmcnt(6)
  v_mfma_f32_16x16x16_bf16 a[144:147], a[208:209], v[202:203], a[144:147]
  v_and_b32 v253, 0xffff0000, v159
  v_fma_f32 v252, v252, s30, -v38
  ds_read_b64_tr_b16 a[236:237], v62 offset:256
  s_waitcnt lgkmcnt(6)
  v_mfma_f32_16x16x16_bf16 a[148:151], a[212:213], v[202:203], a[148:151]
  v_fma_f32 v253, v253, s30, -v38
  v_exp_f32 v254, v252
  ds_read_b64_tr_b16 a[240:241], v64 offset:256
  s_waitcnt lgkmcnt(6)
  v_mfma_f32_16x16x16_bf16 a[152:155], a[216:217], v[202:203], a[152:155]
  v_exp_f32 v255, v253
  v_add_f32 v35, v35, v254
  ds_read_b64_tr_b16 a[244:245], v66 offset:256
  s_waitcnt lgkmcnt(6)
  v_mfma_f32_16x16x16_bf16 a[156:159], a[220:221], v[202:203], a[156:159]
  v_add_f32 v35, v35, v255
  v_cvt_pk_bf16_f32 v159, v254, v255
  s_add_u32 m0, s29, 105472
  s_nop 0
  buffer_load_dwordx4 v23, s[12:15], s42 offen nt lds
  ds_read_b64_tr_b16 a[248:249], v68 offset:256
  s_waitcnt lgkmcnt(6)
  v_mfma_f32_16x16x16_bf16 a[160:163], a[224:225], v[202:203], a[160:163]
  v_lshlrev_b32 v240, 16, v204
  v_and_b32 v241, 0xffff0000, v204
  ds_read_b64_tr_b16 a[252:253], v70 offset:256
  s_waitcnt lgkmcnt(6)
  v_mfma_f32_16x16x16_bf16 a[164:167], a[228:229], v[202:203], a[164:167]
  v_fma_f32 v240, v240, s30, -v39
  v_fma_f32 v241, v241, s30, -v39
  s_waitcnt lgkmcnt(5)
  v_mfma_f32_16x16x16_bf16 a[168:171], a[232:233], v[202:203], a[168:171]
  v_exp_f32 v242, v240
  v_exp_f32 v243, v241
  s_waitcnt lgkmcnt(4)
  v_mfma_f32_16x16x16_bf16 a[172:175], a[236:237], v[202:203], a[172:175]
  v_add_f32 v36, v36, v242
  v_add_f32 v36, v36, v243
  s_waitcnt lgkmcnt(3)
  v_mfma_f32_16x16x16_bf16 a[176:179], a[240:241], v[202:203], a[176:179]
  v_cvt_pk_bf16_f32 v204, v242, v243
  v_lshlrev_b32 v244, 16, v205
  s_waitcnt lgkmcnt(2)
  v_mfma_f32_16x16x16_bf16 a[180:183], a[244:245], v[202:203], a[180:183]
  v_and_b32 v245, 0xffff0000, v205
  v_fma_f32 v244, v244, s30, -v39
  s_waitcnt lgkmcnt(1)
  v_mfma_f32_16x16x16_bf16 a[184:187], a[248:249], v[202:203], a[184:187]
  v_fma_f32 v245, v245, s30, -v39
  v_exp_f32 v246, v244
  s_waitcnt lgkmcnt(0)
  v_mfma_f32_16x16x16_bf16 a[188:191], a[252:253], v[202:203], a[188:191]
  v_exp_f32 v247, v245
  v_add_f32 v36, v36, v246
  v_add_f32 v36, v36, v247
  v_cvt_pk_bf16_f32 v205, v246, v247
  s_waitcnt vmcnt(16)
  s_barrier
  ds_read_b64_tr_b16 a[192:193], v40 offset:32768
  ds_read_b64_tr_b16 a[194:195], v40 offset:40960
  ds_read_b64_tr_b16 a[196:197], v42 offset:32768
  ds_read_b64_tr_b16 a[198:199], v42 offset:40960
  ds_read_b64_tr_b16 a[200:201], v44 offset:32768
  ds_read_b64_tr_b16 a[202:203], v44 offset:40960
  ds_read_b64_tr_b16 a[204:205], v46 offset:32768
  ds_read_b64_tr_b16 a[206:207], v46 offset:40960
  ds_read_b64_tr_b16 a[208:209], v48 offset:32768
  ds_read_b64_tr_b16 a[210:211], v48 offset:40960
  ds_read_b64_tr_b16 a[212:213], v50 offset:32768
  ds_read_b64_tr_b16 a[214:215], v50 offset:40960
  ds_read_b64_tr_b16 a[216:217], v52 offset:32768
  ds_read_b64_tr_b16 a[218:219], v52 offset:40960
  s_waitcnt lgkmcnt(12)
  v_mfma_f32_16x16x32_bf16 a[0:3], a[192:195], v[88:91], a[0:3]
  v_lshlrev_b32 v240, 16, v96
  v_and_b32 v241, 0xffff0000, v96
  v_mfma_f32_16x16x32_bf16 a[64:67], a[192:195], v[152:155], a[64:67]
  v_fma_f32 v240, v240, s30, -v37
  v_fma_f32 v241, v241, s30, -v37
  ds_read_b64_tr_b16 a[220:221], v54 offset:32768
  ds_read_b64_tr_b16 a[222:223], v54 offset:40960
  s_waitcnt lgkmcnt(12)
  v_mfma_f32_16x16x32_bf16 a[4:7], a[196:199], v[88:91], a[4:7]
  v_exp_f32 v242, v240
  v_exp_f32 v243, v241
  v_mfma_f32_16x16x32_bf16 a[68:71], a[196:199], v[152:155], a[68:71]
  v_add_f32 v34, v34, v242
  v_add_f32 v34, v34, v243
  ds_read_b64_tr_b16 a[224:225], v40 offset:33024
  ds_read_b64_tr_b16 a[226:227], v40 offset:41216
  s_waitcnt lgkmcnt(12)
  v_mfma_f32_16x16x32_bf16 a[8:11], a[200:203], v[88:91], a[8:11]
  v_cvt_pk_bf16_f32 v96, v242, v243
  v_lshlrev_b32 v244, 16, v97
  v_mfma_f32_16x16x32_bf16 a[72:75], a[200:203], v[152:155], a[72:75]
  v_and_b32 v245, 0xffff0000, v97
  v_fma_f32 v244, v244, s30, -v37
  ds_read_b64_tr_b16 a[228:229], v42 offset:33024
  ds_read_b64_tr_b16 a[230:231], v42 offset:41216
  s_waitcnt lgkmcnt(12)
  v_mfma_f32_16x16x32_bf16 a[12:15], a[204:207], v[88:91], a[12:15]
  v_fma_f32 v245, v245, s30, -v37
  v_exp_f32 v246, v244
  v_mfma_f32_16x16x32_bf16 a[76:79], a[204:207], v[152:155], a[76:79]
  v_exp_f32 v247, v245
  v_add_f32 v34, v34, v246
  s_add_u32 s31, s43, 5
  s_and_b32 s31, s31, 7
  s_lshl_b32 s31, s31, 15
  ds_read_b64_tr_b16 a[232:233], v44 offset:33024
  ds_read_b64_tr_b16 a[234:235], v44 offset:41216
  s_waitcnt lgkmcnt(12)
  v_mfma_f32_16x16x32_bf16 a[16:19], a[208:211], v[88:91], a[16:19]
  v_add_f32 v34, v34, v247
  v_cvt_pk_bf16_f32 v97, v246, v247
  v_mfma_f32_16x16x32_bf16 a[80:83], a[208:211], v[152:155], a[80:83]
  v_lshlrev_b32 v248, 16, v98
  v_and_b32 v249, 0xffff0000, v98
  ds_read_b64_tr_b16 a[236:237], v46 offset:33024
  ds_read_b64_tr_b16 a[238:239], v46 offset:41216
  s_waitcnt lgkmcnt(12)
  v_mfma_f32_16x16x32_bf16 a[20:23], a[212:215], v[88:91], a[20:23]
  v_fma_f32 v248, v248, s30, -v37
  v_fma_f32 v249, v249, s30, -v37
  v_mfma_f32_16x16x32_bf16 a[84:87], a[212:215], v[152:155], a[84:87]
  v_exp_f32 v250, v248
  v_exp_f32 v251, v249
  ds_read_b64_tr_b16 a[240:241], v48 offset:33024
  ds_read_b64_tr_b16 a[242:243], v48 offset:41216
  s_waitcnt lgkmcnt(12)
  v_mfma_f32_16x16x32_bf16 a[24:27], a[216:219], v[88:91], a[24:27]
  v_add_f32 v34, v34, v250
  v_add_f32 v34, v34, v251
  v_mfma_f32_16x16x32_bf16 a[88:91], a[216:219], v[152:155], a[88:91]
  v_cvt_pk_bf16_f32 v98, v250, v251
  v_lshlrev_b32 v252, 16, v99
  ds_read_b64_tr_b16 a[244:245], v50 offset:33024
  ds_read_b64_tr_b16 a[246:247], v50 offset:41216
  s_waitcnt lgkmcnt(12)
  v_mfma_f32_16x16x32_bf16 a[28:31], a[220:223], v[88:91], a[28:31]
  v_and_b32 v253, 0xffff0000, v99
  v_fma_f32 v252, v252, s30, -v37
  v_mfma_f32_16x16x32_bf16 a[92:95], a[220:223], v[152:155], a[92:95]
  v_fma_f32 v253, v253, s30, -v37
  v_exp_f32 v254, v252
  s_add_u32 m0, s29, 0
  s_nop 0
  buffer_load_dwordx4 v16, s[12:15], s31 offen nt lds
  ds_read_b64_tr_b16 a[248:249], v52 offset:33024
  ds_read_b64_tr_b16 a[250:251], v52 offset:41216
  s_waitcnt lgkmcnt(12)
  v_mfma_f32_16x16x32_bf16 a[32:35], a[224:227], v[88:91], a[32:35]
  v_exp_f32 v255, v253
  v_add_f32 v34, v34, v254
  v_mfma_f32_16x16x32_bf16 a[96:99], a[224:227], v[152:155], a[96:99]
  v_add_f32 v34, v34, v255
  v_cvt_pk_bf16_f32 v99, v254, v255
  ds_read_b64_tr_b16 a[252:253], v54 offset:33024
  ds_read_b64_tr_b16 a[254:255], v54 offset:41216
  s_waitcnt lgkmcnt(12)
  v_mfma_f32_16x16x32_bf16 a[36:39], a[228:231], v[88:91], a[36:39]
  v_lshlrev_b32 v240, 16, v100
  v_and_b32 v241, 0xffff0000, v100
  v_mfma_f32_16x16x32_bf16 a[100:103], a[228:231], v[152:155], a[100:103]
  v_fma_f32 v240, v240, s30, -v37
  v_fma_f32 v241, v241, s30, -v37
  ds_read_b64_tr_b16 a[192:193], v40 offset:49152
  ds_read_b64_tr_b16 a[194:195], v40 offset:57344
  s_waitcnt lgkmcnt(12)
  v_mfma_f32_16x16x32_bf16 a[40:43], a[232:235], v[88:91], a[40:43]
  v_exp_f32 v242, v240
  v_exp_f32 v243, v241
  v_mfma_f32_16x16x32_bf16 a[104:107], a[232:235], v[152:155], a[104:107]
  v_add_f32 v34, v34, v242
  v_add_f32 v34, v34, v243
  ds_read_b64_tr_b16 a[196:197], v42 offset:49152
  ds_read_b64_tr_b16 a[198:199], v42 offset:57344
  s_waitcnt lgkmcnt(12)
  v_mfma_f32_16x16x32_bf16 a[44:47], a[236:239], v[88:91], a[44:47]
  v_cvt_pk_bf16_f32 v100, v242, v243
  v_lshlrev_b32 v244, 16, v101
  v_mfma_f32_16x16x32_bf16 a[108:111], a[236:239], v[152:155], a[108:111]
  v_and_b32 v245, 0xffff0000, v101
  v_fma_f32 v244, v244, s30, -v37
  s_add_u32 m0, s29, 1024
  s_nop 0
  buffer_load_dwordx4 v17, s[12:15], s31 offen nt lds
  ds_read_b64_tr_b16 a[200:201], v44 offset:49152
  ds_read_b64_tr_b16 a[202:203], v44 offset:57344
  s_waitcnt lgkmcnt(12)
  v_mfma_f32_16x16x32_bf16 a[48:51], a[240:243], v[88:91], a[48:51]
  v_fma_f32 v245, v245, s30, -v37
  v_exp_f32 v246, v244
  v_mfma_f32_16x16x32_bf16 a[112:115], a[240:243], v[152:155], a[112:115]
  v_exp_f32 v247, v245
  v_add_f32 v34, v34, v246
  ds_read_b64_tr_b16 a[204:205], v46 offset:49152
  ds_read_b64_tr_b16 a[206:207], v46 offset:57344
  s_waitcnt lgkmcnt(12)
  v_mfma_f32_16x16x32_bf16 a[52:55], a[244:247], v[88:91], a[52:55]
  v_add_f32 v34, v34, v247
  v_cvt_pk_bf16_f32 v101, v246, v247
  v_mfma_f32_16x16x32_bf16 a[116:119], a[244:247], v[152:155], a[116:119]
  v_lshlrev_b32 v248, 16, v102
  v_and_b32 v249, 0xffff0000, v102
  ds_read_b64_tr_b16 a[208:209], v48 offset:49152
  ds_read_b64_tr_b16 a[210:211], v48 offset:57344
  s_waitcnt lgkmcnt(12)
  v_mfma_f32_16x16x32_bf16 a[56:59], a[248:251], v[88:91], a[56:59]
  v_fma_f32 v248, v248, s30, -v37
  v_fma_f32 v249, v249, s30, -v37
  v_mfma_f32_16x16x32_bf16 a[120:123], a[248:251], v[152:155], a[120:123]
  v_exp_f32 v250, v248
  v_exp_f32 v251, v249
  ds_read_b64_tr_b16 a[212:213], v50 offset:49152
  ds_read_b64_tr_b16 a[214:215], v50 offset:57344
  s_waitcnt lgkmcnt(12)
  v_mfma_f32_16x16x32_bf16 a[60:63], a[252:255], v[88:91], a[60:63]
  v_add_f32 v34, v34, v250
  v_add_f32 v34, v34, v251
  v_mfma_f32_16x16x32_bf16 a[124:127], a[252:255], v[152:155], a[124:127]
  v_cvt_pk_bf16_f32 v102, v250, v251
  v_lshlrev_b32 v252, 16, v103
  s_add_u32 m0, s29, 2048
  s_nop 0
  buffer_load_dwordx4 v18, s[12:15], s31 offen nt lds
  ds_read_b64_tr_b16 a[216:217], v52 offset:49152
  ds_read_b64_tr_b16 a[218:219], v52 offset:57344
  s_waitcnt lgkmcnt(12)
  v_mfma_f32_16x16x32_bf16 a[0:3], a[192:195], v[92:95], a[0:3]
  v_and_b32 v253, 0xffff0000, v103
  v_fma_f32 v252, v252, s30, -v37
  v_mfma_f32_16x16x32_bf16 a[64:67], a[192:195], v[156:159], a[64:67]
  v_fma_f32 v253, v253, s30, -v37
  v_exp_f32 v254, v252
  ds_read_b64_tr_b16 a[220:221], v54 offset:49152
  ds_read_b64_tr_b16 a[222:223], v54 offset:57344
  s_waitcnt lgkmcnt(12)
  v_mfma_f32_16x16x32_bf16 a[4:7], a[196:199], v[92:95], a[4:7]
  v_exp_f32 v255, v253
  v_add_f32 v34, v34, v254
  v_mfma_f32_16x16x32_bf16 a[68:71], a[196:199], v[156:159], a[68:71]
  v_add_f32 v34, v34, v255
  v_cvt_pk_bf16_f32 v103, v254, v255
  ds_read_b64_tr_b16 a[224:225], v40 offset:49408
  ds_read_b64_tr_b16 a[226:227], v40 offset:57600
  s_waitcnt lgkmcnt(12)
  v_mfma_f32_16x16x32_bf16 a[8:11], a[200:203], v[92:95], a[8:11]
  v_lshlrev_b32 v240, 16, v160
  v_and_b32 v241, 0xffff0000, v160
  v_mfma_f32_16x16x32_bf16 a[72:75], a[200:203], v[156:159], a[72:75]
  v_fma_f32 v240, v240, s30, -v38
  v_fma_f32 v241, v241, s30, -v38
  ds_read_b64_tr_b16 a[228:229], v42 offset:49408
  ds_read_b64_tr_b16 a[230:231], v42 offset:57600
  s_waitcnt lgkmcnt(12)
  v_mfma_f32_16x16x32_bf16 a[12:15], a[204:207], v[92:95], a[12:15]
  v_exp_f32 v242, v240
  v_exp_f32 v243, v241
  v_mfma_f32_16x16x32_bf16 a[76:79], a[204:207], v[156:159], a[76:79]
  v_add_f32 v35, v35, v242
  v_add_f32 v35, v35, v243
  s_add_u32 m0, s29, 3072
  s_nop 0
  buffer_load_dwordx4 v19, s[12:15], s31 offen nt lds
  ds_read_b64_tr_b16 a[232:233], v44 offset:49408
  ds_read_b64_tr_b16 a[234:235], v44 offset:57600
  s_waitcnt lgkmcnt(12)
  v_mfma_f32_16x16x32_bf16 a[16:19], a[208:211], v[92:95], a[16:19]
  v_cvt_pk_bf16_f32 v160, v242, v243
  v_lshlrev_b32 v244, 16, v161
  v_mfma_f32_16x16x32_bf16 a[80:83], a[208:211], v[156:159], a[80:83]
  v_and_b32 v245, 0xffff0000, v161
  v_fma_f32 v244, v244, s30, -v38
  ds_read_b64_tr_b16 a[236:237], v46 offset:49408
  ds_read_b64_tr_b16 a[238:239], v46 offset:57600
  s_waitcnt lgkmcnt(12)
  v_mfma_f32_16x16x32_bf16 a[20:23], a[212:215], v[92:95], a[20:23]
  v_fma_f32 v245, v245, s30, -v38
  v_exp_f32 v246, v244
  v_mfma_f32_16x16x32_bf16 a[84:87], a[212:215], v[156:159], a[84:87]
  v_exp_f32 v247, v245
  v_add_f32 v35, v35, v246
  ds_read_b64_tr_b16 a[240:241], v48 offset:49408
  ds_read_b64_tr_b16 a[242:243], v48 offset:57600
  s_waitcnt lgkmcnt(12)
  v_mfma_f32_16x16x32_bf16 a[24:27], a[216:219], v[92:95], a[24:27]
  v_add_f32 v35, v35, v247
  v_cvt_pk_bf16_f32 v161, v246, v247
  v_mfma_f32_16x16x32_bf16 a[88:91], a[216:219], v[156:159], a[88:91]
  v_lshlrev_b32 v248, 16, v162
  v_and_b32 v249, 0xffff0000, v162
  ds_read_b64_tr_b16 a[244:245], v50 offset:49408
  ds_read_b64_tr_b16 a[246:247], v50 offset:57600
  s_waitcnt lgkmcnt(12)
  v_mfma_f32_16x16x32_bf16 a[28:31], a[220:223], v[92:95], a[28:31]
  v_fma_f32 v248, v248, s30, -v38
  v_fma_f32 v249, v249, s30, -v38
  v_mfma_f32_16x16x32_bf16 a[92:95], a[220:223], v[156:159], a[92:95]
  v_exp_f32 v250, v248
  v_exp_f32 v251, v249
  s_add_u32 m0, s29, 4096
  s_nop 0
  buffer_load_dwordx4 v20, s[12:15], s31 offen nt lds
  ds_read_b64_tr_b16 a[248:249], v52 offset:49408
  ds_read_b64_tr_b16 a[250:251], v52 offset:57600
  s_waitcnt lgkmcnt(12)
  v_mfma_f32_16x16x32_bf16 a[32:35], a[224:227], v[92:95], a[32:35]
  v_add_f32 v35, v35, v250
  v_add_f32 v35, v35, v251
  v_mfma_f32_16x16x32_bf16 a[96:99], a[224:227], v[156:159], a[96:99]
  v_cvt_pk_bf16_f32 v162, v250, v251
  v_lshlrev_b32 v252, 16, v163
  ds_read_b64_tr_b16 a[252:253], v54 offset:49408
  ds_read_b64_tr_b16 a[254:255], v54 offset:57600
  s_waitcnt lgkmcnt(12)
  v_mfma_f32_16x16x32_bf16 a[36:39], a[228:231], v[92:95], a[36:39]
  v_and_b32 v253, 0xffff0000, v163
  v_fma_f32 v252, v252, s30, -v38
  v_mfma_f32_16x16x32_bf16 a[100:103], a[228:231], v[156:159], a[100:103]
  v_fma_f32 v253, v253, s30, -v38
  v_exp_f32 v254, v252
  ds_read_b64_tr_b16 a[192:193], v56 offset:32768
  s_waitcnt lgkmcnt(11)
  v_mfma_f32_16x16x32_bf16 a[40:43], a[232:235], v[92:95], a[40:43]
  v_exp_f32 v255, v253
  v_add_f32 v35, v35, v254
  v_mfma_f32_16x16x32_bf16 a[104:107], a[232:235], v[156:159], a[104:107]
  v_add_f32 v35, v35, v255
  v_cvt_pk_bf16_f32 v163, v254, v255
  ds_read_b64_tr_b16 a[196:197], v58 offset:32768
  s_waitcnt lgkmcnt(10)
  v_mfma_f32_16x16x32_bf16 a[44:47], a[236:239], v[92:95], a[44:47]
  v_lshlrev_b32 v240, 16, v164
  v_and_b32 v241, 0xffff0000, v164
  v_mfma_f32_16x16x32_bf16 a[108:111], a[236:239], v[156:159], a[108:111]
  v_fma_f32 v240, v240, s30, -v38
  v_fma_f32 v241, v241, s30, -v38
  s_add_u32 m0, s29, 5120
  s_nop 0
  buffer_load_dwordx4 v21, s[12:15], s31 offen nt lds
  ds_read_b64_tr_b16 a[200:201], v60 offset:32768
  s_waitcnt lgkmcnt(9)
  v_mfma_f32_16x16x32_bf16 a[48:51], a[240:243], v[92:95], a[48:51]
  v_exp_f32 v242, v240
  v_exp_f32 v243, v241
  v_mfma_f32_16x16x32_bf16 a[112:115], a[240:243], v[156:159], a[112:115]
  v_add_f32 v35, v35, v242
  v_add_f32 v35, v35, v243
  ds_read_b64_tr_b16 a[204:205], v62 offset:32768
  s_waitcnt lgkmcnt(8)
  v_mfma_f32_16x16x32_bf16 a[52:55], a[244:247], v[92:95], a[52:55]
  v_cvt_pk_bf16_f32 v164, v242, v243
  v_lshlrev_b32 v244, 16, v165
  v_mfma_f32_16x16x32_bf16 a[116:119], a[244:247], v[156:159], a[116:119]
  v_and_b32 v245, 0xffff0000, v165
  v_fma_f32 v244, v244, s30, -v38
  ds_read_b64_tr_b16 a[208:209], v64 offset:32768
  s_waitcnt lgkmcnt(7)
  v_mfma_f32_16x16x32_bf16 a[56:59], a[248:251], v[92:95], a[56:59]
  v_fma_f32 v245, v245, s30, -v38
  v_exp_f32 v246, v244
  v_mfma_f32_16x16x32_bf16 a[120:123], a[248:251], v[156:159], a[120:123]
  v_exp_f32 v247, v245
  v_add_f32 v35, v35, v246
  ds_read_b64_tr_b16 a[212:213], v66 offset:32768
  s_waitcnt lgkmcnt(6)
  v_mfma_f32_16x16x32_bf16 a[60:63], a[252:255], v[92:95], a[60:63]
  v_add_f32 v35, v35, v247
  v_cvt_pk_bf16_f32 v165, v246, v247
  v_mfma_f32_16x16x32_bf16 a[124:127], a[252:255], v[156:159], a[124:127]
  v_lshlrev_b32 v248, 16, v166
  v_and_b32 v249, 0xffff0000, v166
  s_add_u32 m0, s29, 6144
  s_nop 0
  buffer_load_dwordx4 v22, s[12:15], s31 offen nt lds
  ds_read_b64_tr_b16 a[216:217], v68 offset:32768
  s_waitcnt lgkmcnt(6)
  v_mfma_f32_16x16x16_bf16 a[128:131], a[192:193], v[204:205], a[128:131]
  v_fma_f32 v248, v248, s30, -v38
  v_fma_f32 v249, v249, s30, -v38
  ds_read_b64_tr_b16 a[220:221], v70 offset:32768
  s_waitcnt lgkmcnt(6)
  v_mfma_f32_16x16x16_bf16 a[132:135], a[196:197], v[204:205], a[132:135]
  v_exp_f32 v250, v248
  v_exp_f32 v251, v249
  ds_read_b64_tr_b16 a[224:225], v56 offset:33024
  s_waitcnt lgkmcnt(6)
  v_mfma_f32_16x16x16_bf16 a[136:139], a[200:201], v[204:205], a[136:139]
  v_add_f32 v35, v35, v250
  v_add_f32 v35, v35, v251
  ds_read_b64_tr_b16 a[228:229], v58 offset:33024
  s_waitcnt lgkmcnt(6)
  v_mfma_f32_16x16x16_bf16 a[140:143], a[204:205], v[204:205], a[140:143]
  v_cvt_pk_bf16_f32 v166, v250, v251
  v_lshlrev_b32 v252, 16, v167
  ds_read_b64_tr_b16 a[232:233], v60 offset:33024
  s_waitcnt lgkmcnt(6)
  v_mfma_f32_16x16x16_bf16 a[144:147], a[208:209], v[204:205], a[144:147]
  v_and_b32 v253, 0xffff0000, v167
  v_fma_f32 v252, v252, s30, -v38
  ds_read_b64_tr_b16 a[236:237], v62 offset:33024
  s_waitcnt lgkmcnt(6)
  v_mfma_f32_16x16x16_bf16 a[148:151], a[212:213], v[204:205], a[148:151]
  v_fma_f32 v253, v253, s30, -v38
  v_exp_f32 v254, v252
  ds_read_b64_tr_b16 a[240:241], v64 offset:33024
  s_waitcnt lgkmcnt(6)
  v_mfma_f32_16x16x16_bf16 a[152:155], a[216:217], v[204:205], a[152:155]
  v_exp_f32 v255, v253
  v_add_f32 v35, v35, v254
  ds_read_b64_tr_b16 a[244:245], v66 offset:33024
  s_waitcnt lgkmcnt(6)
  v_mfma_f32_16x16x16_bf16 a[156:159], a[220:221], v[204:205], a[156:159]
  v_add_f32 v35, v35, v255
  v_cvt_pk_bf16_f32 v167, v254, v255
  s_add_u32 m0, s29, 7168
  s_nop 0
  buffer_load_dwordx4 v23, s[12:15], s31 offen nt lds
  ds_read_b64_tr_b16 a[248:249], v68 offset:33024
  s_waitcnt lgkmcnt(6)
  v_mfma_f32_16x16x16_bf16 a[160:163], a[224:225], v[204:205], a[160:163]
  v_lshlrev_b32 v240, 16, v206
  v_and_b32 v241, 0xffff0000, v206
  ds_read_b64_tr_b16 a[252:253], v70 offset:33024
  s_waitcnt lgkmcnt(6)
  v_mfma_f32_16x16x16_bf16 a[164:167], a[228:229], v[204:205], a[164:167]
  v_fma_f32 v240, v240, s30, -v39
  v_fma_f32 v241, v241, s30, -v39
  s_waitcnt lgkmcnt(5)
  v_mfma_f32_16x16x16_bf16 a[168:171], a[232:233], v[204:205], a[168:171]
  v_exp_f32 v242, v240
  v_exp_f32 v243, v241
  s_waitcnt lgkmcnt(4)
  v_mfma_f32_16x16x16_bf16 a[172:175], a[236:237], v[204:205], a[172:175]
  v_add_f32 v36, v36, v242
  v_add_f32 v36, v36, v243
  s_waitcnt lgkmcnt(3)
  v_mfma_f32_16x16x16_bf16 a[176:179], a[240:241], v[204:205], a[176:179]
  v_cvt_pk_bf16_f32 v206, v242, v243
  v_lshlrev_b32 v244, 16, v207
  s_waitcnt lgkmcnt(2)
  v_mfma_f32_16x16x16_bf16 a[180:183], a[244:245], v[204:205], a[180:183]
  v_and_b32 v245, 0xffff0000, v207
  v_fma_f32 v244, v244, s30, -v39
  s_waitcnt lgkmcnt(1)
  v_mfma_f32_16x16x16_bf16 a[184:187], a[248:249], v[204:205], a[184:187]
  v_fma_f32 v245, v245, s30, -v39
  v_exp_f32 v246, v244
  s_waitcnt lgkmcnt(0)
  v_mfma_f32_16x16x16_bf16 a[188:191], a[252:253], v[204:205], a[188:191]
  v_exp_f32 v247, v245
  v_add_f32 v36, v36, v246
  v_add_f32 v36, v36, v247
  v_cvt_pk_bf16_f32 v207, v246, v247
  s_waitcnt vmcnt(16)
  s_barrier
  ds_read_b64_tr_b16 a[192:193], v41 offset:0
  ds_read_b64_tr_b16 a[194:195], v41 offset:8192
  ds_read_b64_tr_b16 a[196:197], v43 offset:0
  ds_read_b64_tr_b16 a[198:199], v43 offset:8192
  ds_read_b64_tr_b16 a[200:201], v45 offset:0
  ds_read_b64_tr_b16 a[202:203], v45 offset:8192
  ds_read_b64_tr_b16 a[204:205], v47 offset:0
  ds_read_b64_tr_b16 a[206:207], v47 offset:8192
  ds_read_b64_tr_b16 a[208:209], v49 offset:0
  ds_read_b64_tr_b16 a[210:211], v49 offset:8192
  ds_read_b64_tr_b16 a[212:213], v51 offset:0
  ds_read_b64_tr_b16 a[214:215], v51 offset:8192
  ds_read_b64_tr_b16 a[216:217], v53 offset:0
  ds_read_b64_tr_b16 a[218:219], v53 offset:8192
  s_waitcnt lgkmcnt(12)
  v_mfma_f32_16x16x32_bf16 a[0:3], a[192:195], v[96:99], a[0:3]
  v_lshlrev_b32 v240, 16, v104
  v_and_b32 v241, 0xffff0000, v104
  v_mfma_f32_16x16x32_bf16 a[64:67], a[192:195], v[160:163], a[64:67]
  v_fma_f32 v240, v240, s30, -v37
  v_fma_f32 v241, v241, s30, -v37
  ds_read_b64_tr_b16 a[220:221], v55 offset:0
  ds_read_b64_tr_b16 a[222:223], v55 offset:8192
  s_waitcnt lgkmcnt(12)
  v_mfma_f32_16x16x32_bf16 a[4:7], a[196:199], v[96:99], a[4:7]
  v_exp_f32 v242, v240
  v_exp_f32 v243, v241
  v_mfma_f32_16x16x32_bf16 a[68:71], a[196:199], v[160:163], a[68:71]
  v_add_f32 v34, v34, v242
  v_add_f32 v34, v34, v243
  ds_read_b64_tr_b16 a[224:225], v41 offset:256
  ds_read_b64_tr_b16 a[226:227], v41 offset:8448
  s_waitcnt lgkmcnt(12)
  v_mfma_f32_16x16x32_bf16 a[8:11], a[200:203], v[96:99], a[8:11]
  v_cvt_pk_bf16_f32 v104, v242, v243
  v_lshlrev_b32 v244, 16, v105
  v_mfma_f32_16x16x32_bf16 a[72:75], a[200:203], v[160:163], a[72:75]
  v_and_b32 v245, 0xffff0000, v105
  v_fma_f32 v244, v244, s30, -v37
  ds_read_b64_tr_b16 a[228:229], v43 offset:256
  ds_read_b64_tr_b16 a[230:231], v43 offset:8448
  s_waitcnt lgkmcnt(12)
  v_mfma_f32_16x16x32_bf16 a[12:15], a[204:207], v[96:99], a[12:15]
  v_fma_f32 v245, v245, s30, -v37
  v_exp_f32 v246, v244
  v_mfma_f32_16x16x32_bf16 a[76:79], a[204:207], v[160:163], a[76:79]
  v_exp_f32 v247, v245
  v_add_f32 v34, v34, v246
  s_add_u32 s42, s43, 6
  s_and_b32 s42, s42, 7
  s_lshl_b32 s42, s42, 15
  ds_read_b64_tr_b16 a[232:233], v45 offset:256
  ds_read_b64_tr_b16 a[234:235], v45 offset:8448
  s_waitcnt lgkmcnt(12)
  v_mfma_f32_16x16x32_bf16 a[16:19], a[208:211], v[96:99], a[16:19]
  v_add_f32 v34, v34, v247
  v_cvt_pk_bf16_f32 v105, v246, v247
  v_mfma_f32_16x16x32_bf16 a[80:83], a[208:211], v[160:163], a[80:83]
  v_lshlrev_b32 v248, 16, v106
  v_and_b32 v249, 0xffff0000, v106
  ds_read_b64_tr_b16 a[236:237], v47 offset:256
  ds_read_b64_tr_b16 a[238:239], v47 offset:8448
  s_waitcnt lgkmcnt(12)
  v_mfma_f32_16x16x32_bf16 a[20:23], a[212:215], v[96:99], a[20:23]
  v_fma_f32 v248, v248, s30, -v37
  v_fma_f32 v249, v249, s30, -v37
  v_mfma_f32_16x16x32_bf16 a[84:87], a[212:215], v[160:163], a[84:87]
  v_exp_f32 v250, v248
  v_exp_f32 v251, v249
  ds_read_b64_tr_b16 a[240:241], v49 offset:256
  ds_read_b64_tr_b16 a[242:243], v49 offset:8448
  s_waitcnt lgkmcnt(12)
  v_mfma_f32_16x16x32_bf16 a[24:27], a[216:219], v[96:99], a[24:27]
  v_add_f32 v34, v34, v250
  v_add_f32 v34, v34, v251
  v_mfma_f32_16x16x32_bf16 a[88:91], a[216:219], v[160:163], a[88:91]
  v_cvt_pk_bf16_f32 v106, v250, v251
  v_lshlrev_b32 v252, 16, v107
  ds_read_b64_tr_b16 a[244:245], v51 offset:256
  ds_read_b64_tr_b16 a[246:247], v51 offset:8448
  s_waitcnt lgkmcnt(12)
  v_mfma_f32_16x16x32_bf16 a[28:31], a[220:223], v[96:99], a[28:31]
  v_and_b32 v253, 0xffff0000, v107
  v_fma_f32 v252, v252, s30, -v37
  v_mfma_f32_16x16x32_bf16 a[92:95], a[220:223], v[160:163], a[92:95]
  v_fma_f32 v253, v253, s30, -v37
  v_exp_f32 v254, v252
  s_add_u32 m0, s29, 32768
  s_nop 0
  buffer_load_dwordx4 v16, s[12:15], s42 offen nt lds
  ds_read_b64_tr_b16 a[248:249], v53 offset:256
  ds_read_b64_tr_b16 a[250:251], v53 offset:8448
  s_waitcnt lgkmcnt(12)
  v_mfma_f32_16x16x32_bf16 a[32:35], a[224:227], v[96:99], a[32:35]
  v_exp_f32 v255, v253
  v_add_f32 v34, v34, v254
  v_mfma_f32_16x16x32_bf16 a[96:99], a[224:227], v[160:163], a[96:99]
  v_add_f32 v34, v34, v255
  v_cvt_pk_bf16_f32 v107, v254, v255
  ds_read_b64_tr_b16 a[252:253], v55 offset:256
  ds_read_b64_tr_b16 a[254:255], v55 offset:8448
  s_waitcnt lgkmcnt(12)
  v_mfma_f32_16x16x32_bf16 a[36:39], a[228:231], v[96:99], a[36:39]
  v_lshlrev_b32 v240, 16, v108
  v_and_b32 v241, 0xffff0000, v108
  v_mfma_f32_16x16x32_bf16 a[100:103], a[228:231], v[160:163], a[100:103]
  v_fma_f32 v240, v240, s30, -v37
  v_fma_f32 v241, v241, s30, -v37
  ds_read_b64_tr_b16 a[192:193], v41 offset:16384
  ds_read_b64_tr_b16 a[194:195], v41 offset:24576
  s_waitcnt lgkmcnt(12)
  v_mfma_f32_16x16x32_bf16 a[40:43], a[232:235], v[96:99], a[40:43]
  v_exp_f32 v242, v240
  v_exp_f32 v243, v241
  v_mfma_f32_16x16x32_bf16 a[104:107], a[232:235], v[160:163], a[104:107]
  v_add_f32 v34, v34, v242
  v_add_f32 v34, v34, v243
  ds_read_b64_tr_b16 a[196:197], v43 offset:16384
  ds_read_b64_tr_b16 a[198:199], v43 offset:24576
  s_waitcnt lgkmcnt(12)
  v_mfma_f32_16x16x32_bf16 a[44:47], a[236:239], v[96:99], a[44:47]
  v_cvt_pk_bf16_f32 v108, v242, v243
  v_lshlrev_b32 v244, 16, v109
  v_mfma_f32_16x16x32_bf16 a[108:111], a[236:239], v[160:163], a[108:111]
  v_and_b32 v245, 0xffff0000, v109
  v_fma_f32 v244, v244, s30, -v37
  s_add_u32 m0, s29, 33792
  s_nop 0
  buffer_load_dwordx4 v17, s[12:15], s42 offen nt lds
  ds_read_b64_tr_b16 a[200:201], v45 offset:16384
  ds_read_b64_tr_b16 a[202:203], v45 offset:24576
  s_waitcnt lgkmcnt(12)
  v_mfma_f32_16x16x32_bf16 a[48:51], a[240:243], v[96:99], a[48:51]
  v_fma_f32 v245, v245, s30, -v37
  v_exp_f32 v246, v244
  v_mfma_f32_16x16x32_bf16 a[112:115], a[240:243], v[160:163], a[112:115]
  v_exp_f32 v247, v245
  v_add_f32 v34, v34, v246
  ds_read_b64_tr_b16 a[204:205], v47 offset:16384
  ds_read_b64_tr_b16 a[206:207], v47 offset:24576
  s_waitcnt lgkmcnt(12)
  v_mfma_f32_16x16x32_bf16 a[52:55], a[244:247], v[96:99], a[52:55]
  v_add_f32 v34, v34, v247
  v_cvt_pk_bf16_f32 v109, v246, v247
  v_mfma_f32_16x16x32_bf16 a[116:119], a[244:247], v[160:163], a[116:119]
  v_lshlrev_b32 v248, 16, v110
  v_and_b32 v249, 0xffff0000, v110
  ds_read_b64_tr_b16 a[208:209], v49 offset:16384
  ds_read_b64_tr_b16 a[210:211], v49 offset:24576
  s_waitcnt lgkmcnt(12)
  v_mfma_f32_16x16x32_bf16 a[56:59], a[248:251], v[96:99], a[56:59]
  v_fma_f32 v248, v248, s30, -v37
  v_fma_f32 v249, v249, s30, -v37
  v_mfma_f32_16x16x32_bf16 a[120:123], a[248:251], v[160:163], a[120:123]
  v_exp_f32 v250, v248
  v_exp_f32 v251, v249
  ds_read_b64_tr_b16 a[212:213], v51 offset:16384
  ds_read_b64_tr_b16 a[214:215], v51 offset:24576
  s_waitcnt lgkmcnt(12)
  v_mfma_f32_16x16x32_bf16 a[60:63], a[252:255], v[96:99], a[60:63]
  v_add_f32 v34, v34, v250
  v_add_f32 v34, v34, v251
  v_mfma_f32_16x16x32_bf16 a[124:127], a[252:255], v[160:163], a[124:127]
  v_cvt_pk_bf16_f32 v110, v250, v251
  v_lshlrev_b32 v252, 16, v111
  s_add_u32 m0, s29, 34816
  s_nop 0
  buffer_load_dwordx4 v18, s[12:15], s42 offen nt lds
  ds_read_b64_tr_b16 a[216:217], v53 offset:16384
  ds_read_b64_tr_b16 a[218:219], v53 offset:24576
  s_waitcnt lgkmcnt(12)
  v_mfma_f32_16x16x32_bf16 a[0:3], a[192:195], v[100:103], a[0:3]
  v_and_b32 v253, 0xffff0000, v111
  v_fma_f32 v252, v252, s30, -v37
  v_mfma_f32_16x16x32_bf16 a[64:67], a[192:195], v[164:167], a[64:67]
  v_fma_f32 v253, v253, s30, -v37
  v_exp_f32 v254, v252
  ds_read_b64_tr_b16 a[220:221], v55 offset:16384
  ds_read_b64_tr_b16 a[222:223], v55 offset:24576
  s_waitcnt lgkmcnt(12)
  v_mfma_f32_16x16x32_bf16 a[4:7], a[196:199], v[100:103], a[4:7]
  v_exp_f32 v255, v253
  v_add_f32 v34, v34, v254
  v_mfma_f32_16x16x32_bf16 a[68:71], a[196:199], v[164:167], a[68:71]
  v_add_f32 v34, v34, v255
  v_cvt_pk_bf16_f32 v111, v254, v255
  ds_read_b64_tr_b16 a[224:225], v41 offset:16640
  ds_read_b64_tr_b16 a[226:227], v41 offset:24832
  s_waitcnt lgkmcnt(12)
  v_mfma_f32_16x16x32_bf16 a[8:11], a[200:203], v[100:103], a[8:11]
  v_lshlrev_b32 v240, 16, v168
  v_and_b32 v241, 0xffff0000, v168
  v_mfma_f32_16x16x32_bf16 a[72:75], a[200:203], v[164:167], a[72:75]
  v_fma_f32 v240, v240, s30, -v38
  v_fma_f32 v241, v241, s30, -v38
  ds_read_b64_tr_b16 a[228:229], v43 offset:16640
  ds_read_b64_tr_b16 a[230:231], v43 offset:24832
  s_waitcnt lgkmcnt(12)
  v_mfma_f32_16x16x32_bf16 a[12:15], a[204:207], v[100:103], a[12:15]
  v_exp_f32 v242, v240
  v_exp_f32 v243, v241
  v_mfma_f32_16x16x32_bf16 a[76:79], a[204:207], v[164:167], a[76:79]
  v_add_f32 v35, v35, v242
  v_add_f32 v35, v35, v243
  s_add_u32 m0, s29, 35840
  s_nop 0
  buffer_load_dwordx4 v19, s[12:15], s42 offen nt lds
  ds_read_b64_tr_b16 a[232:233], v45 offset:16640
  ds_read_b64_tr_b16 a[234:235], v45 offset:24832
  s_waitcnt lgkmcnt(12)
  v_mfma_f32_16x16x32_bf16 a[16:19], a[208:211], v[100:103], a[16:19]
  v_cvt_pk_bf16_f32 v168, v242, v243
  v_lshlrev_b32 v244, 16, v169
  v_mfma_f32_16x16x32_bf16 a[80:83], a[208:211], v[164:167], a[80:83]
  v_and_b32 v245, 0xffff0000, v169
  v_fma_f32 v244, v244, s30, -v38
  ds_read_b64_tr_b16 a[236:237], v47 offset:16640
  ds_read_b64_tr_b16 a[238:239], v47 offset:24832
  s_waitcnt lgkmcnt(12)
  v_mfma_f32_16x16x32_bf16 a[20:23], a[212:215], v[100:103], a[20:23]
  v_fma_f32 v245, v245, s30, -v38
  v_exp_f32 v246, v244
  v_mfma_f32_16x16x32_bf16 a[84:87], a[212:215], v[164:167], a[84:87]
  v_exp_f32 v247, v245
  v_add_f32 v35, v35, v246
  ds_read_b64_tr_b16 a[240:241], v49 offset:16640
  ds_read_b64_tr_b16 a[242:243], v49 offset:24832
  s_waitcnt lgkmcnt(12)
  v_mfma_f32_16x16x32_bf16 a[24:27], a[216:219], v[100:103], a[24:27]
  v_add_f32 v35, v35, v247
  v_cvt_pk_bf16_f32 v169, v246, v247
  v_mfma_f32_16x16x32_bf16 a[88:91], a[216:219], v[164:167], a[88:91]
  v_lshlrev_b32 v248, 16, v170
  v_and_b32 v249, 0xffff0000, v170
  ds_read_b64_tr_b16 a[244:245], v51 offset:16640
  ds_read_b64_tr_b16 a[246:247], v51 offset:24832
  s_waitcnt lgkmcnt(12)
  v_mfma_f32_16x16x32_bf16 a[28:31], a[220:223], v[100:103], a[28:31]
  v_fma_f32 v248, v248, s30, -v38
  v_fma_f32 v249, v249, s30, -v38
  v_mfma_f32_16x16x32_bf16 a[92:95], a[220:223], v[164:167], a[92:95]
  v_exp_f32 v250, v248
  v_exp_f32 v251, v249
  s_add_u32 m0, s29, 36864
  s_nop 0
  buffer_load_dwordx4 v20, s[12:15], s42 offen nt lds
  ds_read_b64_tr_b16 a[248:249], v53 offset:16640
  ds_read_b64_tr_b16 a[250:251], v53 offset:24832
  s_waitcnt lgkmcnt(12)
  v_mfma_f32_16x16x32_bf16 a[32:35], a[224:227], v[100:103], a[32:35]
  v_add_f32 v35, v35, v250
  v_add_f32 v35, v35, v251
  v_mfma_f32_16x16x32_bf16 a[96:99], a[224:227], v[164:167], a[96:99]
  v_cvt_pk_bf16_f32 v170, v250, v251
  v_lshlrev_b32 v252, 16, v171
  ds_read_b64_tr_b16 a[252:253], v55 offset:16640
  ds_read_b64_tr_b16 a[254:255], v55 offset:24832
  s_waitcnt lgkmcnt(12)
  v_mfma_f32_16x16x32_bf16 a[36:39], a[228:231], v[100:103], a[36:39]
  v_and_b32 v253, 0xffff0000, v171
  v_fma_f32 v252, v252, s30, -v38
  v_mfma_f32_16x16x32_bf16 a[100:103], a[228:231], v[164:167], a[100:103]
  v_fma_f32 v253, v253, s30, -v38
  v_exp_f32 v254, v252
  ds_read_b64_tr_b16 a[192:193], v57 offset:0
  s_waitcnt lgkmcnt(11)
  v_mfma_f32_16x16x32_bf16 a[40:43], a[232:235], v[100:103], a[40:43]
  v_exp_f32 v255, v253
  v_add_f32 v35, v35, v254
  v_mfma_f32_16x16x32_bf16 a[104:107], a[232:235], v[164:167], a[104:107]
  v_add_f32 v35, v35, v255
  v_cvt_pk_bf16_f32 v171, v254, v255
  ds_read_b64_tr_b16 a[196:197], v59 offset:0
  s_waitcnt lgkmcnt(10)
  v_mfma_f32_16x16x32_bf16 a[44:47], a[236:239], v[100:103], a[44:47]
  v_lshlrev_b32 v240, 16, v172
  v_and_b32 v241, 0xffff0000, v172
  v_mfma_f32_16x16x32_bf16 a[108:111], a[236:239], v[164:167], a[108:111]
  v_fma_f32 v240, v240, s30, -v38
  v_fma_f32 v241, v241, s30, -v38
  s_add_u32 m0, s29, 37888
  s_nop 0
  buffer_load_dwordx4 v21, s[12:15], s42 offen nt lds
  ds_read_b64_tr_b16 a[200:201], v61 offset:0
  s_waitcnt lgkmcnt(9)
  v_mfma_f32_16x16x32_bf16 a[48:51], a[240:243], v[100:103], a[48:51]
  v_exp_f32 v242, v240
  v_exp_f32 v243, v241
  v_mfma_f32_16x16x32_bf16 a[112:115], a[240:243], v[164:167], a[112:115]
  v_add_f32 v35, v35, v242
  v_add_f32 v35, v35, v243
  ds_read_b64_tr_b16 a[204:205], v63 offset:0
  s_waitcnt lgkmcnt(8)
  v_mfma_f32_16x16x32_bf16 a[52:55], a[244:247], v[100:103], a[52:55]
  v_cvt_pk_bf16_f32 v172, v242, v243
  v_lshlrev_b32 v244, 16, v173
  v_mfma_f32_16x16x32_bf16 a[116:119], a[244:247], v[164:167], a[116:119]
  v_and_b32 v245, 0xffff0000, v173
  v_fma_f32 v244, v244, s30, -v38
  ds_read_b64_tr_b16 a[208:209], v65 offset:0
  s_waitcnt lgkmcnt(7)
  v_mfma_f32_16x16x32_bf16 a[56:59], a[248:251], v[100:103], a[56:59]
  v_fma_f32 v245, v245, s30, -v38
  v_exp_f32 v246, v244
  v_mfma_f32_16x16x32_bf16 a[120:123], a[248:251], v[164:167], a[120:123]
  v_exp_f32 v247, v245
  v_add_f32 v35, v35, v246
  ds_read_b64_tr_b16 a[212:213], v67 offset:0
  s_waitcnt lgkmcnt(6)
  v_mfma_f32_16x16x32_bf16 a[60:63], a[252:255], v[100:103], a[60:63]
  v_add_f32 v35, v35, v247
  v_cvt_pk_bf16_f32 v173, v246, v247
  v_mfma_f32_16x16x32_bf16 a[124:127], a[252:255], v[164:167], a[124:127]
  v_lshlrev_b32 v248, 16, v174
  v_and_b32 v249, 0xffff0000, v174
  s_add_u32 m0, s29, 38912
  s_nop 0
  buffer_load_dwordx4 v22, s[12:15], s42 offen nt lds
  ds_read_b64_tr_b16 a[216:217], v69 offset:0
  s_waitcnt lgkmcnt(6)
  v_mfma_f32_16x16x16_bf16 a[128:131], a[192:193], v[206:207], a[128:131]
  v_fma_f32 v248, v248, s30, -v38
  v_fma_f32 v249, v249, s30, -v38
  ds_read_b64_tr_b16 a[220:221], v71 offset:0
  s_waitcnt lgkmcnt(6)
  v_mfma_f32_16x16x16_bf16 a[132:135], a[196:197], v[206:207], a[132:135]
  v_exp_f32 v250, v248
  v_exp_f32 v251, v249
  ds_read_b64_tr_b16 a[224:225], v57 offset:256
  s_waitcnt lgkmcnt(6)
  v_mfma_f32_16x16x16_bf16 a[136:139], a[200:201], v[206:207], a[136:139]
  v_add_f32 v35, v35, v250
  v_add_f32 v35, v35, v251
  ds_read_b64_tr_b16 a[228:229], v59 offset:256
  s_waitcnt lgkmcnt(6)
  v_mfma_f32_16x16x16_bf16 a[140:143], a[204:205], v[206:207], a[140:143]
  v_cvt_pk_bf16_f32 v174, v250, v251
  v_lshlrev_b32 v252, 16, v175
  ds_read_b64_tr_b16 a[232:233], v61 offset:256
  s_waitcnt lgkmcnt(6)
  v_mfma_f32_16x16x16_bf16 a[144:147], a[208:209], v[206:207], a[144:147]
  v_and_b32 v253, 0xffff0000, v175
  v_fma_f32 v252, v252, s30, -v38
  ds_read_b64_tr_b16 a[236:237], v63 offset:256
  s_waitcnt lgkmcnt(6)
  v_mfma_f32_16x16x16_bf16 a[148:151], a[212:213], v[206:207], a[148:151]
  v_fma_f32 v253, v253, s30, -v38
  v_exp_f32 v254, v252
  ds_read_b64_tr_b16 a[240:241], v65 offset:256
  s_waitcnt lgkmcnt(6)
  v_mfma_f32_16x16x16_bf16 a[152:155], a[216:217], v[206:207], a[152:155]
  v_exp_f32 v255, v253
  v_add_f32 v35, v35, v254
  ds_read_b64_tr_b16 a[244:245], v67 offset:256
  s_waitcnt lgkmcnt(6)
  v_mfma_f32_16x16x16_bf16 a[156:159], a[220:221], v[206:207], a[156:159]
  v_add_f32 v35, v35, v255
  v_cvt_pk_bf16_f32 v175, v254, v255
  s_add_u32 m0, s29, 39936
  s_nop 0
  buffer_load_dwordx4 v23, s[12:15], s42 offen nt lds
  ds_read_b64_tr_b16 a[248:249], v69 offset:256
  s_waitcnt lgkmcnt(6)
  v_mfma_f32_16x16x16_bf16 a[160:163], a[224:225], v[206:207], a[160:163]
  v_lshlrev_b32 v240, 16, v208
  v_and_b32 v241, 0xffff0000, v208
  ds_read_b64_tr_b16 a[252:253], v71 offset:256
  s_waitcnt lgkmcnt(6)
  v_mfma_f32_16x16x16_bf16 a[164:167], a[228:229], v[206:207], a[164:167]
  v_fma_f32 v240, v240, s30, -v39
  v_fma_f32 v241, v241, s30, -v39
  s_waitcnt lgkmcnt(5)
  v_mfma_f32_16x16x16_bf16 a[168:171], a[232:233], v[206:207], a[168:171]
  v_exp_f32 v242, v240
  v_exp_f32 v243, v241
  s_waitcnt lgkmcnt(4)
  v_mfma_f32_16x16x16_bf16 a[172:175], a[236:237], v[206:207], a[172:175]
  v_add_f32 v36, v36, v242
  v_add_f32 v36, v36, v243
  s_waitcnt lgkmcnt(3)
  v_mfma_f32_16x16x16_bf16 a[176:179], a[240:241], v[206:207], a[176:179]
  v_cvt_pk_bf16_f32 v208, v242, v243
  v_lshlrev_b32 v244, 16, v209
  s_waitcnt lgkmcnt(2)
  v_mfma_f32_16x16x16_bf16 a[180:183], a[244:245], v[206:207], a[180:183]
  v_and_b32 v245, 0xffff0000, v209
  v_fma_f32 v244, v244, s30, -v39
  s_waitcnt lgkmcnt(1)
  v_mfma_f32_16x16x16_bf16 a[184:187], a[248:249], v[206:207], a[184:187]
  v_fma_f32 v245, v245, s30, -v39
  v_exp_f32 v246, v244
  s_waitcnt lgkmcnt(0)
  v_mfma_f32_16x16x16_bf16 a[188:191], a[252:253], v[206:207], a[188:191]
  v_exp_f32 v247, v245
  v_add_f32 v36, v36, v246
  v_add_f32 v36, v36, v247
  v_cvt_pk_bf16_f32 v209, v246, v247
  s_waitcnt vmcnt(16)
  s_barrier
  ds_read_b64_tr_b16 a[192:193], v41 offset:32768
  ds_read_b64_tr_b16 a[194:195], v41 offset:40960
  ds_read_b64_tr_b16 a[196:197], v43 offset:32768
  ds_read_b64_tr_b16 a[198:199], v43 offset:40960
  ds_read_b64_tr_b16 a[200:201], v45 offset:32768
  ds_read_b64_tr_b16 a[202:203], v45 offset:40960
  ds_read_b64_tr_b16 a[204:205], v47 offset:32768
  ds_read_b64_tr_b16 a[206:207], v47 offset:40960
  ds_read_b64_tr_b16 a[208:209], v49 offset:32768
  ds_read_b64_tr_b16 a[210:211], v49 offset:40960
  ds_read_b64_tr_b16 a[212:213], v51 offset:32768
  ds_read_b64_tr_b16 a[214:215], v51 offset:40960
  ds_read_b64_tr_b16 a[216:217], v53 offset:32768
  ds_read_b64_tr_b16 a[218:219], v53 offset:40960
  s_waitcnt lgkmcnt(12)
  v_mfma_f32_16x16x32_bf16 a[0:3], a[192:195], v[104:107], a[0:3]
  v_lshlrev_b32 v240, 16, v112
  v_and_b32 v241, 0xffff0000, v112
  v_mfma_f32_16x16x32_bf16 a[64:67], a[192:195], v[168:171], a[64:67]
  v_fma_f32 v240, v240, s30, -v37
  v_fma_f32 v241, v241, s30, -v37
  ds_read_b64_tr_b16 a[220:221], v55 offset:32768
  ds_read_b64_tr_b16 a[222:223], v55 offset:40960
  s_waitcnt lgkmcnt(12)
  v_mfma_f32_16x16x32_bf16 a[4:7], a[196:199], v[104:107], a[4:7]
  v_exp_f32 v242, v240
  v_exp_f32 v243, v241
  v_mfma_f32_16x16x32_bf16 a[68:71], a[196:199], v[168:171], a[68:71]
  v_add_f32 v34, v34, v242
  v_add_f32 v34, v34, v243
  ds_read_b64_tr_b16 a[224:225], v41 offset:33024
  ds_read_b64_tr_b16 a[226:227], v41 offset:41216
  s_waitcnt lgkmcnt(12)
  v_mfma_f32_16x16x32_bf16 a[8:11], a[200:203], v[104:107], a[8:11]
  v_cvt_pk_bf16_f32 v112, v242, v243
  v_lshlrev_b32 v244, 16, v113
  v_mfma_f32_16x16x32_bf16 a[72:75], a[200:203], v[168:171], a[72:75]
  v_and_b32 v245, 0xffff0000, v113
  v_fma_f32 v244, v244, s30, -v37
  ds_read_b64_tr_b16 a[228:229], v43 offset:33024
  ds_read_b64_tr_b16 a[230:231], v43 offset:41216
  s_waitcnt lgkmcnt(12)
  v_mfma_f32_16x16x32_bf16 a[12:15], a[204:207], v[104:107], a[12:15]
  v_fma_f32 v245, v245, s30, -v37
  v_exp_f32 v246, v244
  v_mfma_f32_16x16x32_bf16 a[76:79], a[204:207], v[168:171], a[76:79]
  v_exp_f32 v247, v245
  v_add_f32 v34, v34, v246
  s_add_u32 s31, s43, 7
  s_and_b32 s31, s31, 7
  s_lshl_b32 s31, s31, 15
  ds_read_b64_tr_b16 a[232:233], v45 offset:33024
  ds_read_b64_tr_b16 a[234:235], v45 offset:41216
  s_waitcnt lgkmcnt(12)
  v_mfma_f32_16x16x32_bf16 a[16:19], a[208:211], v[104:107], a[16:19]
  v_add_f32 v34, v34, v247
  v_cvt_pk_bf16_f32 v113, v246, v247
  v_mfma_f32_16x16x32_bf16 a[80:83], a[208:211], v[168:171], a[80:83]
  v_lshlrev_b32 v248, 16, v114
  v_and_b32 v249, 0xffff0000, v114
  ds_read_b64_tr_b16 a[236:237], v47 offset:33024
  ds_read_b64_tr_b16 a[238:239], v47 offset:41216
  s_waitcnt lgkmcnt(12)
  v_mfma_f32_16x16x32_bf16 a[20:23], a[212:215], v[104:107], a[20:23]
  v_fma_f32 v248, v248, s30, -v37
  v_fma_f32 v249, v249, s30, -v37
  v_mfma_f32_16x16x32_bf16 a[84:87], a[212:215], v[168:171], a[84:87]
  v_exp_f32 v250, v248
  v_exp_f32 v251, v249
  ds_read_b64_tr_b16 a[240:241], v49 offset:33024
  ds_read_b64_tr_b16 a[242:243], v49 offset:41216
  s_waitcnt lgkmcnt(12)
  v_mfma_f32_16x16x32_bf16 a[24:27], a[216:219], v[104:107], a[24:27]
  v_add_f32 v34, v34, v250
  v_add_f32 v34, v34, v251
  v_mfma_f32_16x16x32_bf16 a[88:91], a[216:219], v[168:171], a[88:91]
  v_cvt_pk_bf16_f32 v114, v250, v251
  v_lshlrev_b32 v252, 16, v115
  ds_read_b64_tr_b16 a[244:245], v51 offset:33024
  ds_read_b64_tr_b16 a[246:247], v51 offset:41216
  s_waitcnt lgkmcnt(12)
  v_mfma_f32_16x16x32_bf16 a[28:31], a[220:223], v[104:107], a[28:31]
  v_and_b32 v253, 0xffff0000, v115
  v_fma_f32 v252, v252, s30, -v37
  v_mfma_f32_16x16x32_bf16 a[92:95], a[220:223], v[168:171], a[92:95]
  v_fma_f32 v253, v253, s30, -v37
  v_exp_f32 v254, v252
  s_add_u32 m0, s29, 65536
  s_nop 0
  buffer_load_dwordx4 v16, s[12:15], s31 offen nt lds
  ds_read_b64_tr_b16 a[248:249], v53 offset:33024
  ds_read_b64_tr_b16 a[250:251], v53 offset:41216
  s_waitcnt lgkmcnt(12)
  v_mfma_f32_16x16x32_bf16 a[32:35], a[224:227], v[104:107], a[32:35]
  v_exp_f32 v255, v253
  v_add_f32 v34, v34, v254
  v_mfma_f32_16x16x32_bf16 a[96:99], a[224:227], v[168:171], a[96:99]
  v_add_f32 v34, v34, v255
  v_cvt_pk_bf16_f32 v115, v254, v255
  ds_read_b64_tr_b16 a[252:253], v55 offset:33024
  ds_read_b64_tr_b16 a[254:255], v55 offset:41216
  s_waitcnt lgkmcnt(12)
  v_mfma_f32_16x16x32_bf16 a[36:39], a[228:231], v[104:107], a[36:39]
  v_lshlrev_b32 v240, 16, v116
  v_and_b32 v241, 0xffff0000, v116
  v_mfma_f32_16x16x32_bf16 a[100:103], a[228:231], v[168:171], a[100:103]
  v_fma_f32 v240, v240, s30, -v37
  v_fma_f32 v241, v241, s30, -v37
  ds_read_b64_tr_b16 a[192:193], v41 offset:49152
  ds_read_b64_tr_b16 a[194:195], v41 offset:57344
  s_waitcnt lgkmcnt(12)
  v_mfma_f32_16x16x32_bf16 a[40:43], a[232:235], v[104:107], a[40:43]
  v_exp_f32 v242, v240
  v_exp_f32 v243, v241
  v_mfma_f32_16x16x32_bf16 a[104:107], a[232:235], v[168:171], a[104:107]
  v_add_f32 v34, v34, v242
  v_add_f32 v34, v34, v243
  ds_read_b64_tr_b16 a[196:197], v43 offset:49152
  ds_read_b64_tr_b16 a[198:199], v43 offset:57344
  s_waitcnt lgkmcnt(12)
  v_mfma_f32_16x16x32_bf16 a[44:47], a[236:239], v[104:107], a[44:47]
  v_cvt_pk_bf16_f32 v116, v242, v243
  v_lshlrev_b32 v244, 16, v117
  v_mfma_f32_16x16x32_bf16 a[108:111], a[236:239], v[168:171], a[108:111]
  v_and_b32 v245, 0xffff0000, v117
  v_fma_f32 v244, v244, s30, -v37
  s_add_u32 m0, s29, 66560
  s_nop 0
  buffer_load_dwordx4 v17, s[12:15], s31 offen nt lds
  ds_read_b64_tr_b16 a[200:201], v45 offset:49152
  ds_read_b64_tr_b16 a[202:203], v45 offset:57344
  s_waitcnt lgkmcnt(12)
  v_mfma_f32_16x16x32_bf16 a[48:51], a[240:243], v[104:107], a[48:51]
  v_fma_f32 v245, v245, s30, -v37
  v_exp_f32 v246, v244
  v_mfma_f32_16x16x32_bf16 a[112:115], a[240:243], v[168:171], a[112:115]
  v_exp_f32 v247, v245
  v_add_f32 v34, v34, v246
  ds_read_b64_tr_b16 a[204:205], v47 offset:49152
  ds_read_b64_tr_b16 a[206:207], v47 offset:57344
  s_waitcnt lgkmcnt(12)
  v_mfma_f32_16x16x32_bf16 a[52:55], a[244:247], v[104:107], a[52:55]
  v_add_f32 v34, v34, v247
  v_cvt_pk_bf16_f32 v117, v246, v247
  v_mfma_f32_16x16x32_bf16 a[116:119], a[244:247], v[168:171], a[116:119]
  v_lshlrev_b32 v248, 16, v118
  v_and_b32 v249, 0xffff0000, v118
  ds_read_b64_tr_b16 a[208:209], v49 offset:49152
  ds_read_b64_tr_b16 a[210:211], v49 offset:57344
  s_waitcnt lgkmcnt(12)
  v_mfma_f32_16x16x32_bf16 a[56:59], a[248:251], v[104:107], a[56:59]
  v_fma_f32 v248, v248, s30, -v37
  v_fma_f32 v249, v249, s30, -v37
  v_mfma_f32_16x16x32_bf16 a[120:123], a[248:251], v[168:171], a[120:123]
  v_exp_f32 v250, v248
  v_exp_f32 v251, v249
  ds_read_b64_tr_b16 a[212:213], v51 offset:49152
  ds_read_b64_tr_b16 a[214:215], v51 offset:57344
  s_waitcnt lgkmcnt(12)
  v_mfma_f32_16x16x32_bf16 a[60:63], a[252:255], v[104:107], a[60:63]
  v_add_f32 v34, v34, v250
  v_add_f32 v34, v34, v251
  v_mfma_f32_16x16x32_bf16 a[124:127], a[252:255], v[168:171], a[124:127]
  v_cvt_pk_bf16_f32 v118, v250, v251
  v_lshlrev_b32 v252, 16, v119
  s_add_u32 m0, s29, 67584
  s_nop 0
  buffer_load_dwordx4 v18, s[12:15], s31 offen nt lds
  ds_read_b64_tr_b16 a[216:217], v53 offset:49152
  ds_read_b64_tr_b16 a[218:219], v53 offset:57344
  s_waitcnt lgkmcnt(12)
  v_mfma_f32_16x16x32_bf16 a[0:3], a[192:195], v[108:111], a[0:3]
  v_and_b32 v253, 0xffff0000, v119
  v_fma_f32 v252, v252, s30, -v37
  v_mfma_f32_16x16x32_bf16 a[64:67], a[192:195], v[172:175], a[64:67]
  v_fma_f32 v253, v253, s30, -v37
  v_exp_f32 v254, v252
  ds_read_b64_tr_b16 a[220:221], v55 offset:49152
  ds_read_b64_tr_b16 a[222:223], v55 offset:57344
  s_waitcnt lgkmcnt(12)
  v_mfma_f32_16x16x32_bf16 a[4:7], a[196:199], v[108:111], a[4:7]
  v_exp_f32 v255, v253
  v_add_f32 v34, v34, v254
  v_mfma_f32_16x16x32_bf16 a[68:71], a[196:199], v[172:175], a[68:71]
  v_add_f32 v34, v34, v255
  v_cvt_pk_bf16_f32 v119, v254, v255
  ds_read_b64_tr_b16 a[224:225], v41 offset:49408
  ds_read_b64_tr_b16 a[226:227], v41 offset:57600
  s_waitcnt lgkmcnt(12)
  v_mfma_f32_16x16x32_bf16 a[8:11], a[200:203], v[108:111], a[8:11]
  v_lshlrev_b32 v240, 16, v176
  v_and_b32 v241, 0xffff0000, v176
  v_mfma_f32_16x16x32_bf16 a[72:75], a[200:203], v[172:175], a[72:75]
  v_fma_f32 v240, v240, s30, -v38
  v_fma_f32 v241, v241, s30, -v38
  ds_read_b64_tr_b16 a[228:229], v43 offset:49408
  ds_read_b64_tr_b16 a[230:231], v43 offset:57600
  s_waitcnt lgkmcnt(12)
  v_mfma_f32_16x16x32_bf16 a[12:15], a[204:207], v[108:111], a[12:15]
  v_exp_f32 v242, v240
  v_exp_f32 v243, v241
  v_mfma_f32_16x16x32_bf16 a[76:79], a[204:207], v[172:175], a[76:79]
  v_add_f32 v35, v35, v242
  v_add_f32 v35, v35, v243
  s_add_u32 m0, s29, 68608
  s_nop 0
  buffer_load_dwordx4 v19, s[12:15], s31 offen nt lds
  ds_read_b64_tr_b16 a[232:233], v45 offset:49408
  ds_read_b64_tr_b16 a[234:235], v45 offset:57600
  s_waitcnt lgkmcnt(12)
  v_mfma_f32_16x16x32_bf16 a[16:19], a[208:211], v[108:111], a[16:19]
  v_cvt_pk_bf16_f32 v176, v242, v243
  v_lshlrev_b32 v244, 16, v177
  v_mfma_f32_16x16x32_bf16 a[80:83], a[208:211], v[172:175], a[80:83]
  v_and_b32 v245, 0xffff0000, v177
  v_fma_f32 v244, v244, s30, -v38
  ds_read_b64_tr_b16 a[236:237], v47 offset:49408
  ds_read_b64_tr_b16 a[238:239], v47 offset:57600
  s_waitcnt lgkmcnt(12)
  v_mfma_f32_16x16x32_bf16 a[20:23], a[212:215], v[108:111], a[20:23]
  v_fma_f32 v245, v245, s30, -v38
  v_exp_f32 v246, v244
  v_mfma_f32_16x16x32_bf16 a[84:87], a[212:215], v[172:175], a[84:87]
  v_exp_f32 v247, v245
  v_add_f32 v35, v35, v246
  ds_read_b64_tr_b16 a[240:241], v49 offset:49408
  ds_read_b64_tr_b16 a[242:243], v49 offset:57600
  s_waitcnt lgkmcnt(12)
  v_mfma_f32_16x16x32_bf16 a[24:27], a[216:219], v[108:111], a[24:27]
  v_add_f32 v35, v35, v247
  v_cvt_pk_bf16_f32 v177, v246, v247
  v_mfma_f32_16x16x32_bf16 a[88:91], a[216:219], v[172:175], a[88:91]
  v_lshlrev_b32 v248, 16, v178
  v_and_b32 v249, 0xffff0000, v178
  ds_read_b64_tr_b16 a[244:245], v51 offset:49408
  ds_read_b64_tr_b16 a[246:247], v51 offset:57600
  s_waitcnt lgkmcnt(12)
  v_mfma_f32_16x16x32_bf16 a[28:31], a[220:223], v[108:111], a[28:31]
  v_fma_f32 v248, v248, s30, -v38
  v_fma_f32 v249, v249, s30, -v38
  v_mfma_f32_16x16x32_bf16 a[92:95], a[220:223], v[172:175], a[92:95]
  v_exp_f32 v250, v248
  v_exp_f32 v251, v249
  s_add_u32 m0, s29, 69632
  s_nop 0
  buffer_load_dwordx4 v20, s[12:15], s31 offen nt lds
  ds_read_b64_tr_b16 a[248:249], v53 offset:49408
  ds_read_b64_tr_b16 a[250:251], v53 offset:57600
  s_waitcnt lgkmcnt(12)
  v_mfma_f32_16x16x32_bf16 a[32:35], a[224:227], v[108:111], a[32:35]
  v_add_f32 v35, v35, v250
  v_add_f32 v35, v35, v251
  v_mfma_f32_16x16x32_bf16 a[96:99], a[224:227], v[172:175], a[96:99]
  v_cvt_pk_bf16_f32 v178, v250, v251
  v_lshlrev_b32 v252, 16, v179
  ds_read_b64_tr_b16 a[252:253], v55 offset:49408
  ds_read_b64_tr_b16 a[254:255], v55 offset:57600
  s_waitcnt lgkmcnt(12)
  v_mfma_f32_16x16x32_bf16 a[36:39], a[228:231], v[108:111], a[36:39]
  v_and_b32 v253, 0xffff0000, v179
  v_fma_f32 v252, v252, s30, -v38
  v_mfma_f32_16x16x32_bf16 a[100:103], a[228:231], v[172:175], a[100:103]
  v_fma_f32 v253, v253, s30, -v38
  v_exp_f32 v254, v252
  ds_read_b64_tr_b16 a[192:193], v57 offset:32768
  s_waitcnt lgkmcnt(11)
  v_mfma_f32_16x16x32_bf16 a[40:43], a[232:235], v[108:111], a[40:43]
  v_exp_f32 v255, v253
  v_add_f32 v35, v35, v254
  v_mfma_f32_16x16x32_bf16 a[104:107], a[232:235], v[172:175], a[104:107]
  v_add_f32 v35, v35, v255
  v_cvt_pk_bf16_f32 v179, v254, v255
  ds_read_b64_tr_b16 a[196:197], v59 offset:32768
  s_waitcnt lgkmcnt(10)
  v_mfma_f32_16x16x32_bf16 a[44:47], a[236:239], v[108:111], a[44:47]
  v_lshlrev_b32 v240, 16, v180
  v_and_b32 v241, 0xffff0000, v180
  v_mfma_f32_16x16x32_bf16 a[108:111], a[236:239], v[172:175], a[108:111]
  v_fma_f32 v240, v240, s30, -v38
  v_fma_f32 v241, v241, s30, -v38
  s_add_u32 m0, s29, 70656
  s_nop 0
  buffer_load_dwordx4 v21, s[12:15], s31 offen nt lds
  ds_read_b64_tr_b16 a[200:201], v61 offset:32768
  s_waitcnt lgkmcnt(9)
  v_mfma_f32_16x16x32_bf16 a[48:51], a[240:243], v[108:111], a[48:51]
  v_exp_f32 v242, v240
  v_exp_f32 v243, v241
  v_mfma_f32_16x16x32_bf16 a[112:115], a[240:243], v[172:175], a[112:115]
  v_add_f32 v35, v35, v242
  v_add_f32 v35, v35, v243
  ds_read_b64_tr_b16 a[204:205], v63 offset:32768
  s_waitcnt lgkmcnt(8)
  v_mfma_f32_16x16x32_bf16 a[52:55], a[244:247], v[108:111], a[52:55]
  v_cvt_pk_bf16_f32 v180, v242, v243
  v_lshlrev_b32 v244, 16, v181
  v_mfma_f32_16x16x32_bf16 a[116:119], a[244:247], v[172:175], a[116:119]
  v_and_b32 v245, 0xffff0000, v181
  v_fma_f32 v244, v244, s30, -v38
  ds_read_b64_tr_b16 a[208:209], v65 offset:32768
  s_waitcnt lgkmcnt(7)
  v_mfma_f32_16x16x32_bf16 a[56:59], a[248:251], v[108:111], a[56:59]
  v_fma_f32 v245, v245, s30, -v38
  v_exp_f32 v246, v244
  v_mfma_f32_16x16x32_bf16 a[120:123], a[248:251], v[172:175], a[120:123]
  v_exp_f32 v247, v245
  v_add_f32 v35, v35, v246
  ds_read_b64_tr_b16 a[212:213], v67 offset:32768
  s_waitcnt lgkmcnt(6)
  v_mfma_f32_16x16x32_bf16 a[60:63], a[252:255], v[108:111], a[60:63]
  v_add_f32 v35, v35, v247
  v_cvt_pk_bf16_f32 v181, v246, v247
  v_mfma_f32_16x16x32_bf16 a[124:127], a[252:255], v[172:175], a[124:127]
  v_lshlrev_b32 v248, 16, v182
  v_and_b32 v249, 0xffff0000, v182
  s_add_u32 m0, s29, 71680
  s_nop 0
  buffer_load_dwordx4 v22, s[12:15], s31 offen nt lds
  ds_read_b64_tr_b16 a[216:217], v69 offset:32768
  s_waitcnt lgkmcnt(6)
  v_mfma_f32_16x16x16_bf16 a[128:131], a[192:193], v[208:209], a[128:131]
  v_fma_f32 v248, v248, s30, -v38
  v_fma_f32 v249, v249, s30, -v38
  ds_read_b64_tr_b16 a[220:221], v71 offset:32768
  s_waitcnt lgkmcnt(6)
  v_mfma_f32_16x16x16_bf16 a[132:135], a[196:197], v[208:209], a[132:135]
  v_exp_f32 v250, v248
  v_exp_f32 v251, v249
  ds_read_b64_tr_b16 a[224:225], v57 offset:33024
  s_waitcnt lgkmcnt(6)
  v_mfma_f32_16x16x16_bf16 a[136:139], a[200:201], v[208:209], a[136:139]
  v_add_f32 v35, v35, v250
  v_add_f32 v35, v35, v251
  ds_read_b64_tr_b16 a[228:229], v59 offset:33024
  s_waitcnt lgkmcnt(6)
  v_mfma_f32_16x16x16_bf16 a[140:143], a[204:205], v[208:209], a[140:143]
  v_cvt_pk_bf16_f32 v182, v250, v251
  v_lshlrev_b32 v252, 16, v183
  ds_read_b64_tr_b16 a[232:233], v61 offset:33024
  s_waitcnt lgkmcnt(6)
  v_mfma_f32_16x16x16_bf16 a[144:147], a[208:209], v[208:209], a[144:147]
  v_and_b32 v253, 0xffff0000, v183
  v_fma_f32 v252, v252, s30, -v38
  ds_read_b64_tr_b16 a[236:237], v63 offset:33024
  s_waitcnt lgkmcnt(6)
  v_mfma_f32_16x16x16_bf16 a[148:151], a[212:213], v[208:209], a[148:151]
  v_fma_f32 v253, v253, s30, -v38
  v_exp_f32 v254, v252
  ds_read_b64_tr_b16 a[240:241], v65 offset:33024
  s_waitcnt lgkmcnt(6)
  v_mfma_f32_16x16x16_bf16 a[152:155], a[216:217], v[208:209], a[152:155]
  v_exp_f32 v255, v253
  v_add_f32 v35, v35, v254
  ds_read_b64_tr_b16 a[244:245], v67 offset:33024
  s_waitcnt lgkmcnt(6)
  v_mfma_f32_16x16x16_bf16 a[156:159], a[220:221], v[208:209], a[156:159]
  v_add_f32 v35, v35, v255
  v_cvt_pk_bf16_f32 v183, v254, v255
  s_add_u32 m0, s29, 72704
  s_nop 0
  buffer_load_dwordx4 v23, s[12:15], s31 offen nt lds
  ds_read_b64_tr_b16 a[248:249], v69 offset:33024
  s_waitcnt lgkmcnt(6)
  v_mfma_f32_16x16x16_bf16 a[160:163], a[224:225], v[208:209], a[160:163]
  v_lshlrev_b32 v240, 16, v210
  v_and_b32 v241, 0xffff0000, v210
  ds_read_b64_tr_b16 a[252:253], v71 offset:33024
  s_waitcnt lgkmcnt(6)
  v_mfma_f32_16x16x16_bf16 a[164:167], a[228:229], v[208:209], a[164:167]
  v_fma_f32 v240, v240, s30, -v39
  v_fma_f32 v241, v241, s30, -v39
  s_waitcnt lgkmcnt(5)
  v_mfma_f32_16x16x16_bf16 a[168:171], a[232:233], v[208:209], a[168:171]
  v_exp_f32 v242, v240
  v_exp_f32 v243, v241
  s_waitcnt lgkmcnt(4)
  v_mfma_f32_16x16x16_bf16 a[172:175], a[236:237], v[208:209], a[172:175]
  v_add_f32 v36, v36, v242
  v_add_f32 v36, v36, v243
  s_waitcnt lgkmcnt(3)
  v_mfma_f32_16x16x16_bf16 a[176:179], a[240:241], v[208:209], a[176:179]
  v_cvt_pk_bf16_f32 v210, v242, v243
  v_lshlrev_b32 v244, 16, v211
  s_waitcnt lgkmcnt(2)
  v_mfma_f32_16x16x16_bf16 a[180:183], a[244:245], v[208:209], a[180:183]
  v_and_b32 v245, 0xffff0000, v211
  v_fma_f32 v244, v244, s30, -v39
  s_waitcnt lgkmcnt(1)
  v_mfma_f32_16x16x16_bf16 a[184:187], a[248:249], v[208:209], a[184:187]
  v_fma_f32 v245, v245, s30, -v39
  v_exp_f32 v246, v244
  s_waitcnt lgkmcnt(0)
  v_mfma_f32_16x16x16_bf16 a[188:191], a[252:253], v[208:209], a[188:191]
  v_exp_f32 v247, v245
  v_add_f32 v36, v36, v246
  v_add_f32 v36, v36, v247
  v_cvt_pk_bf16_f32 v211, v246, v247
  s_waitcnt vmcnt(16)
  s_barrier
  ds_read_b64_tr_b16 a[192:193], v40 offset:0
  ds_read_b64_tr_b16 a[194:195], v40 offset:8192
  ds_read_b64_tr_b16 a[196:197], v42 offset:0
  ds_read_b64_tr_b16 a[198:199], v42 offset:8192
  ds_read_b64_tr_b16 a[200:201], v44 offset:0
  ds_read_b64_tr_b16 a[202:203], v44 offset:8192
  ds_read_b64_tr_b16 a[204:205], v46 offset:0
  ds_read_b64_tr_b16 a[206:207], v46 offset:8192
  ds_read_b64_tr_b16 a[208:209], v48 offset:0
  ds_read_b64_tr_b16 a[210:211], v48 offset:8192
  ds_read_b64_tr_b16 a[212:213], v50 offset:0
  ds_read_b64_tr_b16 a[214:215], v50 offset:8192
  ds_read_b64_tr_b16 a[216:217], v52 offset:0
  ds_read_b64_tr_b16 a[218:219], v52 offset:8192
  s_waitcnt lgkmcnt(12)
  v_mfma_f32_16x16x32_bf16 a[0:3], a[192:195], v[112:115], a[0:3]
  v_lshlrev_b32 v240, 16, v120
  v_and_b32 v241, 0xffff0000, v120
  v_mfma_f32_16x16x32_bf16 a[64:67], a[192:195], v[176:179], a[64:67]
  v_fma_f32 v240, v240, s30, -v37
  v_fma_f32 v241, v241, s30, -v37
  ds_read_b64_tr_b16 a[220:221], v54 offset:0
  ds_read_b64_tr_b16 a[222:223], v54 offset:8192
  s_waitcnt lgkmcnt(12)
  v_mfma_f32_16x16x32_bf16 a[4:7], a[196:199], v[112:115], a[4:7]
  v_exp_f32 v242, v240
  v_exp_f32 v243, v241
  v_mfma_f32_16x16x32_bf16 a[68:71], a[196:199], v[176:179], a[68:71]
  v_add_f32 v34, v34, v242
  v_add_f32 v34, v34, v243
  ds_read_b64_tr_b16 a[224:225], v40 offset:256
  ds_read_b64_tr_b16 a[226:227], v40 offset:8448
  s_waitcnt lgkmcnt(12)
  v_mfma_f32_16x16x32_bf16 a[8:11], a[200:203], v[112:115], a[8:11]
  v_cvt_pk_bf16_f32 v120, v242, v243
  v_lshlrev_b32 v244, 16, v121
  v_mfma_f32_16x16x32_bf16 a[72:75], a[200:203], v[176:179], a[72:75]
  v_and_b32 v245, 0xffff0000, v121
  v_fma_f32 v244, v244, s30, -v37
  ds_read_b64_tr_b16 a[228:229], v42 offset:256
  ds_read_b64_tr_b16 a[230:231], v42 offset:8448
  s_waitcnt lgkmcnt(12)
  v_mfma_f32_16x16x32_bf16 a[12:15], a[204:207], v[112:115], a[12:15]
  v_fma_f32 v245, v245, s30, -v37
  v_exp_f32 v246, v244
  v_mfma_f32_16x16x32_bf16 a[76:79], a[204:207], v[176:179], a[76:79]
  v_exp_f32 v247, v245
  v_add_f32 v34, v34, v246
  ds_read_b64_tr_b16 a[232:233], v44 offset:256
  ds_read_b64_tr_b16 a[234:235], v44 offset:8448
  s_waitcnt lgkmcnt(12)
  v_mfma_f32_16x16x32_bf16 a[16:19], a[208:211], v[112:115], a[16:19]
  v_add_f32 v34, v34, v247
  v_cvt_pk_bf16_f32 v121, v246, v247
  v_mfma_f32_16x16x32_bf16 a[80:83], a[208:211], v[176:179], a[80:83]
  v_lshlrev_b32 v248, 16, v122
  v_and_b32 v249, 0xffff0000, v122
  ds_read_b64_tr_b16 a[236:237], v46 offset:256
  ds_read_b64_tr_b16 a[238:239], v46 offset:8448
  s_waitcnt lgkmcnt(12)
  v_mfma_f32_16x16x32_bf16 a[20:23], a[212:215], v[112:115], a[20:23]
  v_fma_f32 v248, v248, s30, -v37
  v_fma_f32 v249, v249, s30, -v37
  v_mfma_f32_16x16x32_bf16 a[84:87], a[212:215], v[176:179], a[84:87]
  v_exp_f32 v250, v248
  v_exp_f32 v251, v249
  ds_read_b64_tr_b16 a[240:241], v48 offset:256
  ds_read_b64_tr_b16 a[242:243], v48 offset:8448
  s_waitcnt lgkmcnt(12)
  v_mfma_f32_16x16x32_bf16 a[24:27], a[216:219], v[112:115], a[24:27]
  v_add_f32 v34, v34, v250
  v_add_f32 v34, v34, v251
  v_mfma_f32_16x16x32_bf16 a[88:91], a[216:219], v[176:179], a[88:91]
  v_cvt_pk_bf16_f32 v122, v250, v251
  v_lshlrev_b32 v252, 16, v123
  ds_read_b64_tr_b16 a[244:245], v50 offset:256
  ds_read_b64_tr_b16 a[246:247], v50 offset:8448
  s_waitcnt lgkmcnt(12)
  v_mfma_f32_16x16x32_bf16 a[28:31], a[220:223], v[112:115], a[28:31]
  v_and_b32 v253, 0xffff0000, v123
  v_fma_f32 v252, v252, s30, -v37
  v_mfma_f32_16x16x32_bf16 a[92:95], a[220:223], v[176:179], a[92:95]
  v_fma_f32 v253, v253, s30, -v37
  v_exp_f32 v254, v252
  ds_read_b64_tr_b16 a[248:249], v52 offset:256
  ds_read_b64_tr_b16 a[250:251], v52 offset:8448
  s_waitcnt lgkmcnt(12)
  v_mfma_f32_16x16x32_bf16 a[32:35], a[224:227], v[112:115], a[32:35]
  v_exp_f32 v255, v253
  v_add_f32 v34, v34, v254
  v_mfma_f32_16x16x32_bf16 a[96:99], a[224:227], v[176:179], a[96:99]
  v_add_f32 v34, v34, v255
  v_cvt_pk_bf16_f32 v123, v254, v255
  ds_read_b64_tr_b16 a[252:253], v54 offset:256
  ds_read_b64_tr_b16 a[254:255], v54 offset:8448
  s_waitcnt lgkmcnt(12)
  v_mfma_f32_16x16x32_bf16 a[36:39], a[228:231], v[112:115], a[36:39]
  v_lshlrev_b32 v240, 16, v124
  v_and_b32 v241, 0xffff0000, v124
  v_mfma_f32_16x16x32_bf16 a[100:103], a[228:231], v[176:179], a[100:103]
  v_fma_f32 v240, v240, s30, -v37
  v_fma_f32 v241, v241, s30, -v37
  ds_read_b64_tr_b16 a[192:193], v40 offset:16384
  ds_read_b64_tr_b16 a[194:195], v40 offset:24576
  s_waitcnt lgkmcnt(12)
  v_mfma_f32_16x16x32_bf16 a[40:43], a[232:235], v[112:115], a[40:43]
  v_exp_f32 v242, v240
  v_exp_f32 v243, v241
  v_mfma_f32_16x16x32_bf16 a[104:107], a[232:235], v[176:179], a[104:107]
  v_add_f32 v34, v34, v242
  v_add_f32 v34, v34, v243
  ds_read_b64_tr_b16 a[196:197], v42 offset:16384
  ds_read_b64_tr_b16 a[198:199], v42 offset:24576
  s_waitcnt lgkmcnt(12)
  v_mfma_f32_16x16x32_bf16 a[44:47], a[236:239], v[112:115], a[44:47]
  v_cvt_pk_bf16_f32 v124, v242, v243
  v_lshlrev_b32 v244, 16, v125
  v_mfma_f32_16x16x32_bf16 a[108:111], a[236:239], v[176:179], a[108:111]
  v_and_b32 v245, 0xffff0000, v125
  v_fma_f32 v244, v244, s30, -v37
  ds_read_b64_tr_b16 a[200:201], v44 offset:16384
  ds_read_b64_tr_b16 a[202:203], v44 offset:24576
  s_waitcnt lgkmcnt(12)
  v_mfma_f32_16x16x32_bf16 a[48:51], a[240:243], v[112:115], a[48:51]
  v_fma_f32 v245, v245, s30, -v37
  v_exp_f32 v246, v244
  v_mfma_f32_16x16x32_bf16 a[112:115], a[240:243], v[176:179], a[112:115]
  v_exp_f32 v247, v245
  v_add_f32 v34, v34, v246
  ds_read_b64_tr_b16 a[204:205], v46 offset:16384
  ds_read_b64_tr_b16 a[206:207], v46 offset:24576
  s_waitcnt lgkmcnt(12)
  v_mfma_f32_16x16x32_bf16 a[52:55], a[244:247], v[112:115], a[52:55]
  v_add_f32 v34, v34, v247
  v_cvt_pk_bf16_f32 v125, v246, v247
  v_mfma_f32_16x16x32_bf16 a[116:119], a[244:247], v[176:179], a[116:119]
  v_lshlrev_b32 v248, 16, v126
  v_and_b32 v249, 0xffff0000, v126
  ds_read_b64_tr_b16 a[208:209], v48 offset:16384
  ds_read_b64_tr_b16 a[210:211], v48 offset:24576
  s_waitcnt lgkmcnt(12)
  v_mfma_f32_16x16x32_bf16 a[56:59], a[248:251], v[112:115], a[56:59]
  v_fma_f32 v248, v248, s30, -v37
  v_fma_f32 v249, v249, s30, -v37
  v_mfma_f32_16x16x32_bf16 a[120:123], a[248:251], v[176:179], a[120:123]
  v_exp_f32 v250, v248
  v_exp_f32 v251, v249
  ds_read_b64_tr_b16 a[212:213], v50 offset:16384
  ds_read_b64_tr_b16 a[214:215], v50 offset:24576
  s_waitcnt lgkmcnt(12)
  v_mfma_f32_16x16x32_bf16 a[60:63], a[252:255], v[112:115], a[60:63]
  v_add_f32 v34, v34, v250
  v_add_f32 v34, v34, v251
  v_mfma_f32_16x16x32_bf16 a[124:127], a[252:255], v[176:179], a[124:127]
  v_cvt_pk_bf16_f32 v126, v250, v251
  v_lshlrev_b32 v252, 16, v127
  ds_read_b64_tr_b16 a[216:217], v52 offset:16384
  ds_read_b64_tr_b16 a[218:219], v52 offset:24576
  s_waitcnt lgkmcnt(12)
  v_mfma_f32_16x16x32_bf16 a[0:3], a[192:195], v[116:119], a[0:3]
  v_and_b32 v253, 0xffff0000, v127
  v_fma_f32 v252, v252, s30, -v37
  v_mfma_f32_16x16x32_bf16 a[64:67], a[192:195], v[180:183], a[64:67]
  v_fma_f32 v253, v253, s30, -v37
  v_exp_f32 v254, v252
  ds_read_b64_tr_b16 a[220:221], v54 offset:16384
  ds_read_b64_tr_b16 a[222:223], v54 offset:24576
  s_waitcnt lgkmcnt(12)
  v_mfma_f32_16x16x32_bf16 a[4:7], a[196:199], v[116:119], a[4:7]
  v_exp_f32 v255, v253
  v_add_f32 v34, v34, v254
  v_mfma_f32_16x16x32_bf16 a[68:71], a[196:199], v[180:183], a[68:71]
  v_add_f32 v34, v34, v255
  v_cvt_pk_bf16_f32 v127, v254, v255
  ds_read_b64_tr_b16 a[224:225], v40 offset:16640
  ds_read_b64_tr_b16 a[226:227], v40 offset:24832
  s_waitcnt lgkmcnt(12)
  v_mfma_f32_16x16x32_bf16 a[8:11], a[200:203], v[116:119], a[8:11]
  v_lshlrev_b32 v240, 16, v184
  v_and_b32 v241, 0xffff0000, v184
  v_mfma_f32_16x16x32_bf16 a[72:75], a[200:203], v[180:183], a[72:75]
  v_fma_f32 v240, v240, s30, -v38
  v_fma_f32 v241, v241, s30, -v38
  ds_read_b64_tr_b16 a[228:229], v42 offset:16640
  ds_read_b64_tr_b16 a[230:231], v42 offset:24832
  s_waitcnt lgkmcnt(12)
  v_mfma_f32_16x16x32_bf16 a[12:15], a[204:207], v[116:119], a[12:15]
  v_exp_f32 v242, v240
  v_exp_f32 v243, v241
  v_mfma_f32_16x16x32_bf16 a[76:79], a[204:207], v[180:183], a[76:79]
  v_add_f32 v35, v35, v242
  v_add_f32 v35, v35, v243
  ds_read_b64_tr_b16 a[232:233], v44 offset:16640
  ds_read_b64_tr_b16 a[234:235], v44 offset:24832
  s_waitcnt lgkmcnt(12)
  v_mfma_f32_16x16x32_bf16 a[16:19], a[208:211], v[116:119], a[16:19]
  v_cvt_pk_bf16_f32 v184, v242, v243
  v_lshlrev_b32 v244, 16, v185
  v_mfma_f32_16x16x32_bf16 a[80:83], a[208:211], v[180:183], a[80:83]
  v_and_b32 v245, 0xffff0000, v185
  v_fma_f32 v244, v244, s30, -v38
  ds_read_b64_tr_b16 a[236:237], v46 offset:16640
  ds_read_b64_tr_b16 a[238:239], v46 offset:24832
  s_waitcnt lgkmcnt(12)
  v_mfma_f32_16x16x32_bf16 a[20:23], a[212:215], v[116:119], a[20:23]
  v_fma_f32 v245, v245, s30, -v38
  v_exp_f32 v246, v244
  v_mfma_f32_16x16x32_bf16 a[84:87], a[212:215], v[180:183], a[84:87]
  v_exp_f32 v247, v245
  v_add_f32 v35, v35, v246
  ds_read_b64_tr_b16 a[240:241], v48 offset:16640
  ds_read_b64_tr_b16 a[242:243], v48 offset:24832
  s_waitcnt lgkmcnt(12)
  v_mfma_f32_16x16x32_bf16 a[24:27], a[216:219], v[116:119], a[24:27]
  v_add_f32 v35, v35, v247
  v_cvt_pk_bf16_f32 v185, v246, v247
  v_mfma_f32_16x16x32_bf16 a[88:91], a[216:219], v[180:183], a[88:91]
  v_lshlrev_b32 v248, 16, v186
  v_and_b32 v249, 0xffff0000, v186
  ds_read_b64_tr_b16 a[244:245], v50 offset:16640
  ds_read_b64_tr_b16 a[246:247], v50 offset:24832
  s_waitcnt lgkmcnt(12)
  v_mfma_f32_16x16x32_bf16 a[28:31], a[220:223], v[116:119], a[28:31]
  v_fma_f32 v248, v248, s30, -v38
  v_fma_f32 v249, v249, s30, -v38
  v_mfma_f32_16x16x32_bf16 a[92:95], a[220:223], v[180:183], a[92:95]
  v_exp_f32 v250, v248
  v_exp_f32 v251, v249
  ds_read_b64_tr_b16 a[248:249], v52 offset:16640
  ds_read_b64_tr_b16 a[250:251], v52 offset:24832
  s_waitcnt lgkmcnt(12)
  v_mfma_f32_16x16x32_bf16 a[32:35], a[224:227], v[116:119], a[32:35]
  v_add_f32 v35, v35, v250
  v_add_f32 v35, v35, v251
  v_mfma_f32_16x16x32_bf16 a[96:99], a[224:227], v[180:183], a[96:99]
  v_cvt_pk_bf16_f32 v186, v250, v251
  v_lshlrev_b32 v252, 16, v187
  ds_read_b64_tr_b16 a[252:253], v54 offset:16640
  ds_read_b64_tr_b16 a[254:255], v54 offset:24832
  s_waitcnt lgkmcnt(12)
  v_mfma_f32_16x16x32_bf16 a[36:39], a[228:231], v[116:119], a[36:39]
  v_and_b32 v253, 0xffff0000, v187
  v_fma_f32 v252, v252, s30, -v38
  v_mfma_f32_16x16x32_bf16 a[100:103], a[228:231], v[180:183], a[100:103]
  v_fma_f32 v253, v253, s30, -v38
  v_exp_f32 v254, v252
  ds_read_b64_tr_b16 a[192:193], v56 offset:0
  s_waitcnt lgkmcnt(11)
  v_mfma_f32_16x16x32_bf16 a[40:43], a[232:235], v[116:119], a[40:43]
  v_exp_f32 v255, v253
  v_add_f32 v35, v35, v254
  v_mfma_f32_16x16x32_bf16 a[104:107], a[232:235], v[180:183], a[104:107]
  v_add_f32 v35, v35, v255
  v_cvt_pk_bf16_f32 v187, v254, v255
  ds_read_b64_tr_b16 a[196:197], v58 offset:0
  s_waitcnt lgkmcnt(10)
  v_mfma_f32_16x16x32_bf16 a[44:47], a[236:239], v[116:119], a[44:47]
  v_lshlrev_b32 v240, 16, v188
  v_and_b32 v241, 0xffff0000, v188
  v_mfma_f32_16x16x32_bf16 a[108:111], a[236:239], v[180:183], a[108:111]
  v_fma_f32 v240, v240, s30, -v38
  v_fma_f32 v241, v241, s30, -v38
  ds_read_b64_tr_b16 a[200:201], v60 offset:0
  s_waitcnt lgkmcnt(9)
  v_mfma_f32_16x16x32_bf16 a[48:51], a[240:243], v[116:119], a[48:51]
  v_exp_f32 v242, v240
  v_exp_f32 v243, v241
  v_mfma_f32_16x16x32_bf16 a[112:115], a[240:243], v[180:183], a[112:115]
  v_add_f32 v35, v35, v242
  v_add_f32 v35, v35, v243
  ds_read_b64_tr_b16 a[204:205], v62 offset:0
  s_waitcnt lgkmcnt(8)
  v_mfma_f32_16x16x32_bf16 a[52:55], a[244:247], v[116:119], a[52:55]
  v_cvt_pk_bf16_f32 v188, v242, v243
  v_lshlrev_b32 v244, 16, v189
  v_mfma_f32_16x16x32_bf16 a[116:119], a[244:247], v[180:183], a[116:119]
  v_and_b32 v245, 0xffff0000, v189
  v_fma_f32 v244, v244, s30, -v38
  ds_read_b64_tr_b16 a[208:209], v64 offset:0
  s_waitcnt lgkmcnt(7)
  v_mfma_f32_16x16x32_bf16 a[56:59], a[248:251], v[116:119], a[56:59]
  v_fma_f32 v245, v245, s30, -v38
  v_exp_f32 v246, v244
  v_mfma_f32_16x16x32_bf16 a[120:123], a[248:251], v[180:183], a[120:123]
  v_exp_f32 v247, v245
  v_add_f32 v35, v35, v246
  ds_read_b64_tr_b16 a[212:213], v66 offset:0
  s_waitcnt lgkmcnt(6)
  v_mfma_f32_16x16x32_bf16 a[60:63], a[252:255], v[116:119], a[60:63]
  v_add_f32 v35, v35, v247
  v_cvt_pk_bf16_f32 v189, v246, v247
  v_mfma_f32_16x16x32_bf16 a[124:127], a[252:255], v[180:183], a[124:127]
  v_lshlrev_b32 v248, 16, v190
  v_and_b32 v249, 0xffff0000, v190
  ds_read_b64_tr_b16 a[216:217], v68 offset:0
  s_waitcnt lgkmcnt(6)
  v_mfma_f32_16x16x16_bf16 a[128:131], a[192:193], v[210:211], a[128:131]
  v_fma_f32 v248, v248, s30, -v38
  v_fma_f32 v249, v249, s30, -v38
  ds_read_b64_tr_b16 a[220:221], v70 offset:0
  s_waitcnt lgkmcnt(6)
  v_mfma_f32_16x16x16_bf16 a[132:135], a[196:197], v[210:211], a[132:135]
  v_exp_f32 v250, v248
  v_exp_f32 v251, v249
  ds_read_b64_tr_b16 a[224:225], v56 offset:256
  s_waitcnt lgkmcnt(6)
  v_mfma_f32_16x16x16_bf16 a[136:139], a[200:201], v[210:211], a[136:139]
  v_add_f32 v35, v35, v250
  v_add_f32 v35, v35, v251
  ds_read_b64_tr_b16 a[228:229], v58 offset:256
  s_waitcnt lgkmcnt(6)
  v_mfma_f32_16x16x16_bf16 a[140:143], a[204:205], v[210:211], a[140:143]
  v_cvt_pk_bf16_f32 v190, v250, v251
  v_lshlrev_b32 v252, 16, v191
  ds_read_b64_tr_b16 a[232:233], v60 offset:256
  s_waitcnt lgkmcnt(6)
  v_mfma_f32_16x16x16_bf16 a[144:147], a[208:209], v[210:211], a[144:147]
  v_and_b32 v253, 0xffff0000, v191
  v_fma_f32 v252, v252, s30, -v38
  ds_read_b64_tr_b16 a[236:237], v62 offset:256
  s_waitcnt lgkmcnt(6)
  v_mfma_f32_16x16x16_bf16 a[148:151], a[212:213], v[210:211], a[148:151]
  v_fma_f32 v253, v253, s30, -v38
  v_exp_f32 v254, v252
  ds_read_b64_tr_b16 a[240:241], v64 offset:256
  s_waitcnt lgkmcnt(6)
  v_mfma_f32_16x16x16_bf16 a[152:155], a[216:217], v[210:211], a[152:155]
  v_exp_f32 v255, v253
  v_add_f32 v35, v35, v254
  ds_read_b64_tr_b16 a[244:245], v66 offset:256
  s_waitcnt lgkmcnt(6)
  v_mfma_f32_16x16x16_bf16 a[156:159], a[220:221], v[210:211], a[156:159]
  v_add_f32 v35, v35, v255
  v_cvt_pk_bf16_f32 v191, v254, v255
  ds_read_b64_tr_b16 a[248:249], v68 offset:256
  s_waitcnt lgkmcnt(6)
  v_mfma_f32_16x16x16_bf16 a[160:163], a[224:225], v[210:211], a[160:163]
  v_lshlrev_b32 v240, 16, v212
  v_and_b32 v241, 0xffff0000, v212
  ds_read_b64_tr_b16 a[252:253], v70 offset:256
  s_waitcnt lgkmcnt(6)
  v_mfma_f32_16x16x16_bf16 a[164:167], a[228:229], v[210:211], a[164:167]
  v_fma_f32 v240, v240, s30, -v39
  v_fma_f32 v241, v241, s30, -v39
  s_waitcnt lgkmcnt(5)
  v_mfma_f32_16x16x16_bf16 a[168:171], a[232:233], v[210:211], a[168:171]
  v_exp_f32 v242, v240
  v_exp_f32 v243, v241
  s_waitcnt lgkmcnt(4)
  v_mfma_f32_16x16x16_bf16 a[172:175], a[236:237], v[210:211], a[172:175]
  v_add_f32 v36, v36, v242
  v_add_f32 v36, v36, v243
  s_waitcnt lgkmcnt(3)
  v_mfma_f32_16x16x16_bf16 a[176:179], a[240:241], v[210:211], a[176:179]
  v_cvt_pk_bf16_f32 v212, v242, v243
  v_lshlrev_b32 v244, 16, v213
  s_waitcnt lgkmcnt(2)
  v_mfma_f32_16x16x16_bf16 a[180:183], a[244:245], v[210:211], a[180:183]
  v_and_b32 v245, 0xffff0000, v213
  v_fma_f32 v244, v244, s30, -v39
  s_waitcnt lgkmcnt(1)
  v_mfma_f32_16x16x16_bf16 a[184:187], a[248:249], v[210:211], a[184:187]
  v_fma_f32 v245, v245, s30, -v39
  v_exp_f32 v246, v244
  s_waitcnt lgkmcnt(0)
  v_mfma_f32_16x16x16_bf16 a[188:191], a[252:253], v[210:211], a[188:191]
  v_exp_f32 v247, v245
  v_add_f32 v36, v36, v246
  v_add_f32 v36, v36, v247
  v_cvt_pk_bf16_f32 v213, v246, v247
  s_waitcnt vmcnt(8)
  s_barrier
  ds_read_b64_tr_b16 a[192:193], v40 offset:32768
  ds_read_b64_tr_b16 a[194:195], v40 offset:40960
  ds_read_b64_tr_b16 a[196:197], v42 offset:32768
  ds_read_b64_tr_b16 a[198:199], v42 offset:40960
  ds_read_b64_tr_b16 a[200:201], v44 offset:32768
  ds_read_b64_tr_b16 a[202:203], v44 offset:40960
  ds_read_b64_tr_b16 a[204:205], v46 offset:32768
  ds_read_b64_tr_b16 a[206:207], v46 offset:40960
  ds_read_b64_tr_b16 a[208:209], v48 offset:32768
  ds_read_b64_tr_b16 a[210:211], v48 offset:40960
  ds_read_b64_tr_b16 a[212:213], v50 offset:32768
  ds_read_b64_tr_b16 a[214:215], v50 offset:40960
  ds_read_b64_tr_b16 a[216:217], v52 offset:32768
  ds_read_b64_tr_b16 a[218:219], v52 offset:40960
  s_waitcnt lgkmcnt(12)
  v_mfma_f32_16x16x32_bf16 a[0:3], a[192:195], v[120:123], a[0:3]
  v_lshlrev_b32 v240, 16, v128
  v_and_b32 v241, 0xffff0000, v128
  v_mfma_f32_16x16x32_bf16 a[64:67], a[192:195], v[184:187], a[64:67]
  v_fma_f32 v240, v240, s30, -v37
  v_fma_f32 v241, v241, s30, -v37
  ds_read_b64_tr_b16 a[220:221], v54 offset:32768
  ds_read_b64_tr_b16 a[222:223], v54 offset:40960
  s_waitcnt lgkmcnt(12)
  v_mfma_f32_16x16x32_bf16 a[4:7], a[196:199], v[120:123], a[4:7]
  v_exp_f32 v242, v240
  v_exp_f32 v243, v241
  v_mfma_f32_16x16x32_bf16 a[68:71], a[196:199], v[184:187], a[68:71]
  v_add_f32 v34, v34, v242
  v_add_f32 v34, v34, v243
  ds_read_b64_tr_b16 a[224:225], v40 offset:33024
  ds_read_b64_tr_b16 a[226:227], v40 offset:41216
  s_waitcnt lgkmcnt(12)
  v_mfma_f32_16x16x32_bf16 a[8:11], a[200:203], v[120:123], a[8:11]
  v_cvt_pk_bf16_f32 v128, v242, v243
  v_lshlrev_b32 v244, 16, v129
  v_mfma_f32_16x16x32_bf16 a[72:75], a[200:203], v[184:187], a[72:75]
  v_and_b32 v245, 0xffff0000, v129
  v_fma_f32 v244, v244, s30, -v37
  ds_read_b64_tr_b16 a[228:229], v42 offset:33024
  ds_read_b64_tr_b16 a[230:231], v42 offset:41216
  s_waitcnt lgkmcnt(12)
  v_mfma_f32_16x16x32_bf16 a[12:15], a[204:207], v[120:123], a[12:15]
  v_fma_f32 v245, v245, s30, -v37
  v_exp_f32 v246, v244
  v_mfma_f32_16x16x32_bf16 a[76:79], a[204:207], v[184:187], a[76:79]
  v_exp_f32 v247, v245
  v_add_f32 v34, v34, v246
  ds_read_b64_tr_b16 a[232:233], v44 offset:33024
  ds_read_b64_tr_b16 a[234:235], v44 offset:41216
  s_waitcnt lgkmcnt(12)
  v_mfma_f32_16x16x32_bf16 a[16:19], a[208:211], v[120:123], a[16:19]
  v_add_f32 v34, v34, v247
  v_cvt_pk_bf16_f32 v129, v246, v247
  v_mfma_f32_16x16x32_bf16 a[80:83], a[208:211], v[184:187], a[80:83]
  v_lshlrev_b32 v248, 16, v130
  v_and_b32 v249, 0xffff0000, v130
  ds_read_b64_tr_b16 a[236:237], v46 offset:33024
  ds_read_b64_tr_b16 a[238:239], v46 offset:41216
  s_waitcnt lgkmcnt(12)
  v_mfma_f32_16x16x32_bf16 a[20:23], a[212:215], v[120:123], a[20:23]
  v_fma_f32 v248, v248, s30, -v37
  v_fma_f32 v249, v249, s30, -v37
  v_mfma_f32_16x16x32_bf16 a[84:87], a[212:215], v[184:187], a[84:87]
  v_exp_f32 v250, v248
  v_exp_f32 v251, v249
  ds_read_b64_tr_b16 a[240:241], v48 offset:33024
  ds_read_b64_tr_b16 a[242:243], v48 offset:41216
  s_waitcnt lgkmcnt(12)
  v_mfma_f32_16x16x32_bf16 a[24:27], a[216:219], v[120:123], a[24:27]
  v_add_f32 v34, v34, v250
  v_add_f32 v34, v34, v251
  v_mfma_f32_16x16x32_bf16 a[88:91], a[216:219], v[184:187], a[88:91]
  v_cvt_pk_bf16_f32 v130, v250, v251
  v_lshlrev_b32 v252, 16, v131
  ds_read_b64_tr_b16 a[244:245], v50 offset:33024
  ds_read_b64_tr_b16 a[246:247], v50 offset:41216
  s_waitcnt lgkmcnt(12)
  v_mfma_f32_16x16x32_bf16 a[28:31], a[220:223], v[120:123], a[28:31]
  v_and_b32 v253, 0xffff0000, v131
  v_fma_f32 v252, v252, s30, -v37
  v_mfma_f32_16x16x32_bf16 a[92:95], a[220:223], v[184:187], a[92:95]
  v_fma_f32 v253, v253, s30, -v37
  v_exp_f32 v254, v252
  ds_read_b64_tr_b16 a[248:249], v52 offset:33024
  ds_read_b64_tr_b16 a[250:251], v52 offset:41216
  s_waitcnt lgkmcnt(12)
  v_mfma_f32_16x16x32_bf16 a[32:35], a[224:227], v[120:123], a[32:35]
  v_exp_f32 v255, v253
  v_add_f32 v34, v34, v254
  v_mfma_f32_16x16x32_bf16 a[96:99], a[224:227], v[184:187], a[96:99]
  v_add_f32 v34, v34, v255
  v_cvt_pk_bf16_f32 v131, v254, v255
  ds_read_b64_tr_b16 a[252:253], v54 offset:33024
  ds_read_b64_tr_b16 a[254:255], v54 offset:41216
  s_waitcnt lgkmcnt(12)
  v_mfma_f32_16x16x32_bf16 a[36:39], a[228:231], v[120:123], a[36:39]
  v_lshlrev_b32 v240, 16, v132
  v_and_b32 v241, 0xffff0000, v132
  v_mfma_f32_16x16x32_bf16 a[100:103], a[228:231], v[184:187], a[100:103]
  v_fma_f32 v240, v240, s30, -v37
  v_fma_f32 v241, v241, s30, -v37
  ds_read_b64_tr_b16 a[192:193], v40 offset:49152
  ds_read_b64_tr_b16 a[194:195], v40 offset:57344
  s_waitcnt lgkmcnt(12)
  v_mfma_f32_16x16x32_bf16 a[40:43], a[232:235], v[120:123], a[40:43]
  v_exp_f32 v242, v240
  v_exp_f32 v243, v241
  v_mfma_f32_16x16x32_bf16 a[104:107], a[232:235], v[184:187], a[104:107]
  v_add_f32 v34, v34, v242
  v_add_f32 v34, v34, v243
  ds_read_b64_tr_b16 a[196:197], v42 offset:49152
  ds_read_b64_tr_b16 a[198:199], v42 offset:57344
  s_waitcnt lgkmcnt(12)
  v_mfma_f32_16x16x32_bf16 a[44:47], a[236:239], v[120:123], a[44:47]
  v_cvt_pk_bf16_f32 v132, v242, v243
  v_lshlrev_b32 v244, 16, v133
  v_mfma_f32_16x16x32_bf16 a[108:111], a[236:239], v[184:187], a[108:111]
  v_and_b32 v245, 0xffff0000, v133
  v_fma_f32 v244, v244, s30, -v37
  ds_read_b64_tr_b16 a[200:201], v44 offset:49152
  ds_read_b64_tr_b16 a[202:203], v44 offset:57344
  s_waitcnt lgkmcnt(12)
  v_mfma_f32_16x16x32_bf16 a[48:51], a[240:243], v[120:123], a[48:51]
  v_fma_f32 v245, v245, s30, -v37
  v_exp_f32 v246, v244
  v_mfma_f32_16x16x32_bf16 a[112:115], a[240:243], v[184:187], a[112:115]
  v_exp_f32 v247, v245
  v_add_f32 v34, v34, v246
  ds_read_b64_tr_b16 a[204:205], v46 offset:49152
  ds_read_b64_tr_b16 a[206:207], v46 offset:57344
  s_waitcnt lgkmcnt(12)
  v_mfma_f32_16x16x32_bf16 a[52:55], a[244:247], v[120:123], a[52:55]
  v_add_f32 v34, v34, v247
  v_cvt_pk_bf16_f32 v133, v246, v247
  v_mfma_f32_16x16x32_bf16 a[116:119], a[244:247], v[184:187], a[116:119]
  v_lshlrev_b32 v248, 16, v134
  v_and_b32 v249, 0xffff0000, v134
  ds_read_b64_tr_b16 a[208:209], v48 offset:49152
  ds_read_b64_tr_b16 a[210:211], v48 offset:57344
  s_waitcnt lgkmcnt(12)
  v_mfma_f32_16x16x32_bf16 a[56:59], a[248:251], v[120:123], a[56:59]
  v_fma_f32 v248, v248, s30, -v37
  v_fma_f32 v249, v249, s30, -v37
  v_mfma_f32_16x16x32_bf16 a[120:123], a[248:251], v[184:187], a[120:123]
  v_exp_f32 v250, v248
  v_exp_f32 v251, v249
  ds_read_b64_tr_b16 a[212:213], v50 offset:49152
  ds_read_b64_tr_b16 a[214:215], v50 offset:57344
  s_waitcnt lgkmcnt(12)
  v_mfma_f32_16x16x32_bf16 a[60:63], a[252:255], v[120:123], a[60:63]
  v_add_f32 v34, v34, v250
  v_add_f32 v34, v34, v251
  v_mfma_f32_16x16x32_bf16 a[124:127], a[252:255], v[184:187], a[124:127]
  v_cvt_pk_bf16_f32 v134, v250, v251
  v_lshlrev_b32 v252, 16, v135
  ds_read_b64_tr_b16 a[216:217], v52 offset:49152
  ds_read_b64_tr_b16 a[218:219], v52 offset:57344
  s_waitcnt lgkmcnt(12)
  v_mfma_f32_16x16x32_bf16 a[0:3], a[192:195], v[124:127], a[0:3]
  v_and_b32 v253, 0xffff0000, v135
  v_fma_f32 v252, v252, s30, -v37
  v_mfma_f32_16x16x32_bf16 a[64:67], a[192:195], v[188:191], a[64:67]
  v_fma_f32 v253, v253, s30, -v37
  v_exp_f32 v254, v252
  ds_read_b64_tr_b16 a[220:221], v54 offset:49152
  ds_read_b64_tr_b16 a[222:223], v54 offset:57344
  s_waitcnt lgkmcnt(12)
  v_mfma_f32_16x16x32_bf16 a[4:7], a[196:199], v[124:127], a[4:7]
  v_exp_f32 v255, v253
  v_add_f32 v34, v34, v254
  v_mfma_f32_16x16x32_bf16 a[68:71], a[196:199], v[188:191], a[68:71]
  v_add_f32 v34, v34, v255
  v_cvt_pk_bf16_f32 v135, v254, v255
  ds_read_b64_tr_b16 a[224:225], v40 offset:49408
  ds_read_b64_tr_b16 a[226:227], v40 offset:57600
  s_waitcnt lgkmcnt(12)
  v_mfma_f32_16x16x32_bf16 a[8:11], a[200:203], v[124:127], a[8:11]
  v_lshlrev_b32 v240, 16, v192
  v_and_b32 v241, 0xffff0000, v192
  v_mfma_f32_16x16x32_bf16 a[72:75], a[200:203], v[188:191], a[72:75]
  v_fma_f32 v240, v240, s30, -v38
  v_fma_f32 v241, v241, s30, -v38
  ds_read_b64_tr_b16 a[228:229], v42 offset:49408
  ds_read_b64_tr_b16 a[230:231], v42 offset:57600
  s_waitcnt lgkmcnt(12)
  v_mfma_f32_16x16x32_bf16 a[12:15], a[204:207], v[124:127], a[12:15]
  v_exp_f32 v242, v240
  v_exp_f32 v243, v241
  v_mfma_f32_16x16x32_bf16 a[76:79], a[204:207], v[188:191], a[76:79]
  v_add_f32 v35, v35, v242
  v_add_f32 v35, v35, v243
  ds_read_b64_tr_b16 a[232:233], v44 offset:49408
  ds_read_b64_tr_b16 a[234:235], v44 offset:57600
  s_waitcnt lgkmcnt(12)
  v_mfma_f32_16x16x32_bf16 a[16:19], a[208:211], v[124:127], a[16:19]
  v_cvt_pk_bf16_f32 v192, v242, v243
  v_lshlrev_b32 v244, 16, v193
  v_mfma_f32_16x16x32_bf16 a[80:83], a[208:211], v[188:191], a[80:83]
  v_and_b32 v245, 0xffff0000, v193
  v_fma_f32 v244, v244, s30, -v38
  ds_read_b64_tr_b16 a[236:237], v46 offset:49408
  ds_read_b64_tr_b16 a[238:239], v46 offset:57600
  s_waitcnt lgkmcnt(12)
  v_mfma_f32_16x16x32_bf16 a[20:23], a[212:215], v[124:127], a[20:23]
  v_fma_f32 v245, v245, s30, -v38
  v_exp_f32 v246, v244
  v_mfma_f32_16x16x32_bf16 a[84:87], a[212:215], v[188:191], a[84:87]
  v_exp_f32 v247, v245
  v_add_f32 v35, v35, v246
  ds_read_b64_tr_b16 a[240:241], v48 offset:49408
  ds_read_b64_tr_b16 a[242:243], v48 offset:57600
  s_waitcnt lgkmcnt(12)
  v_mfma_f32_16x16x32_bf16 a[24:27], a[216:219], v[124:127], a[24:27]
  v_add_f32 v35, v35, v247
  v_cvt_pk_bf16_f32 v193, v246, v247
  v_mfma_f32_16x16x32_bf16 a[88:91], a[216:219], v[188:191], a[88:91]
  v_lshlrev_b32 v248, 16, v194
  v_and_b32 v249, 0xffff0000, v194
  ds_read_b64_tr_b16 a[244:245], v50 offset:49408
  ds_read_b64_tr_b16 a[246:247], v50 offset:57600
  s_waitcnt lgkmcnt(12)
  v_mfma_f32_16x16x32_bf16 a[28:31], a[220:223], v[124:127], a[28:31]
  v_fma_f32 v248, v248, s30, -v38
  v_fma_f32 v249, v249, s30, -v38
  v_mfma_f32_16x16x32_bf16 a[92:95], a[220:223], v[188:191], a[92:95]
  v_exp_f32 v250, v248
  v_exp_f32 v251, v249
  ds_read_b64_tr_b16 a[248:249], v52 offset:49408
  ds_read_b64_tr_b16 a[250:251], v52 offset:57600
  s_waitcnt lgkmcnt(12)
  v_mfma_f32_16x16x32_bf16 a[32:35], a[224:227], v[124:127], a[32:35]
  v_add_f32 v35, v35, v250
  v_add_f32 v35, v35, v251
  v_mfma_f32_16x16x32_bf16 a[96:99], a[224:227], v[188:191], a[96:99]
  v_cvt_pk_bf16_f32 v194, v250, v251
  v_lshlrev_b32 v252, 16, v195
  ds_read_b64_tr_b16 a[252:253], v54 offset:49408
  ds_read_b64_tr_b16 a[254:255], v54 offset:57600
  s_waitcnt lgkmcnt(12)
  v_mfma_f32_16x16x32_bf16 a[36:39], a[228:231], v[124:127], a[36:39]
  v_and_b32 v253, 0xffff0000, v195
  v_fma_f32 v252, v252, s30, -v38
  v_mfma_f32_16x16x32_bf16 a[100:103], a[228:231], v[188:191], a[100:103]
  v_fma_f32 v253, v253, s30, -v38
  v_exp_f32 v254, v252
  ds_read_b64_tr_b16 a[192:193], v56 offset:32768
  s_waitcnt lgkmcnt(11)
  v_mfma_f32_16x16x32_bf16 a[40:43], a[232:235], v[124:127], a[40:43]
  v_exp_f32 v255, v253
  v_add_f32 v35, v35, v254
  v_mfma_f32_16x16x32_bf16 a[104:107], a[232:235], v[188:191], a[104:107]
  v_add_f32 v35, v35, v255
  v_cvt_pk_bf16_f32 v195, v254, v255
  ds_read_b64_tr_b16 a[196:197], v58 offset:32768
  s_waitcnt lgkmcnt(10)
  v_mfma_f32_16x16x32_bf16 a[44:47], a[236:239], v[124:127], a[44:47]
  v_lshlrev_b32 v240, 16, v196
  v_and_b32 v241, 0xffff0000, v196
  v_mfma_f32_16x16x32_bf16 a[108:111], a[236:239], v[188:191], a[108:111]
  v_fma_f32 v240, v240, s30, -v38
  v_fma_f32 v241, v241, s30, -v38
  ds_read_b64_tr_b16 a[200:201], v60 offset:32768
  s_waitcnt lgkmcnt(9)
  v_mfma_f32_16x16x32_bf16 a[48:51], a[240:243], v[124:127], a[48:51]
  v_exp_f32 v242, v240
  v_exp_f32 v243, v241
  v_mfma_f32_16x16x32_bf16 a[112:115], a[240:243], v[188:191], a[112:115]
  v_add_f32 v35, v35, v242
  v_add_f32 v35, v35, v243
  ds_read_b64_tr_b16 a[204:205], v62 offset:32768
  s_waitcnt lgkmcnt(8)
  v_mfma_f32_16x16x32_bf16 a[52:55], a[244:247], v[124:127], a[52:55]
  v_cvt_pk_bf16_f32 v196, v242, v243
  v_lshlrev_b32 v244, 16, v197
  v_mfma_f32_16x16x32_bf16 a[116:119], a[244:247], v[188:191], a[116:119]
  v_and_b32 v245, 0xffff0000, v197
  v_fma_f32 v244, v244, s30, -v38
  ds_read_b64_tr_b16 a[208:209], v64 offset:32768
  s_waitcnt lgkmcnt(7)
  v_mfma_f32_16x16x32_bf16 a[56:59], a[248:251], v[124:127], a[56:59]
  v_fma_f32 v245, v245, s30, -v38
  v_exp_f32 v246, v244
  v_mfma_f32_16x16x32_bf16 a[120:123], a[248:251], v[188:191], a[120:123]
  v_exp_f32 v247, v245
  v_add_f32 v35, v35, v246
  ds_read_b64_tr_b16 a[212:213], v66 offset:32768
  s_waitcnt lgkmcnt(6)
  v_mfma_f32_16x16x32_bf16 a[60:63], a[252:255], v[124:127], a[60:63]
  v_add_f32 v35, v35, v247
  v_cvt_pk_bf16_f32 v197, v246, v247
  v_mfma_f32_16x16x32_bf16 a[124:127], a[252:255], v[188:191], a[124:127]
  v_lshlrev_b32 v248, 16, v198
  v_and_b32 v249, 0xffff0000, v198
  ds_read_b64_tr_b16 a[216:217], v68 offset:32768
  s_waitcnt lgkmcnt(6)
  v_mfma_f32_16x16x16_bf16 a[128:131], a[192:193], v[212:213], a[128:131]
  v_fma_f32 v248, v248, s30, -v38
  v_fma_f32 v249, v249, s30, -v38
  ds_read_b64_tr_b16 a[220:221], v70 offset:32768
  s_waitcnt lgkmcnt(6)
  v_mfma_f32_16x16x16_bf16 a[132:135], a[196:197], v[212:213], a[132:135]
  v_exp_f32 v250, v248
  v_exp_f32 v251, v249
  ds_read_b64_tr_b16 a[224:225], v56 offset:33024
  s_waitcnt lgkmcnt(6)
  v_mfma_f32_16x16x16_bf16 a[136:139], a[200:201], v[212:213], a[136:139]
  v_add_f32 v35, v35, v250
  v_add_f32 v35, v35, v251
  ds_read_b64_tr_b16 a[228:229], v58 offset:33024
  s_waitcnt lgkmcnt(6)
  v_mfma_f32_16x16x16_bf16 a[140:143], a[204:205], v[212:213], a[140:143]
  v_cvt_pk_bf16_f32 v198, v250, v251
  v_lshlrev_b32 v252, 16, v199
  ds_read_b64_tr_b16 a[232:233], v60 offset:33024
  s_waitcnt lgkmcnt(6)
  v_mfma_f32_16x16x16_bf16 a[144:147], a[208:209], v[212:213], a[144:147]
  v_and_b32 v253, 0xffff0000, v199
  v_fma_f32 v252, v252, s30, -v38
  ds_read_b64_tr_b16 a[236:237], v62 offset:33024
  s_waitcnt lgkmcnt(6)
  v_mfma_f32_16x16x16_bf16 a[148:151], a[212:213], v[212:213], a[148:151]
  v_fma_f32 v253, v253, s30, -v38
  v_exp_f32 v254, v252
  ds_read_b64_tr_b16 a[240:241], v64 offset:33024
  s_waitcnt lgkmcnt(6)
  v_mfma_f32_16x16x16_bf16 a[152:155], a[216:217], v[212:213], a[152:155]
  v_exp_f32 v255, v253
  v_add_f32 v35, v35, v254
  ds_read_b64_tr_b16 a[244:245], v66 offset:33024
  s_waitcnt lgkmcnt(6)
  v_mfma_f32_16x16x16_bf16 a[156:159], a[220:221], v[212:213], a[156:159]
  v_add_f32 v35, v35, v255
  v_cvt_pk_bf16_f32 v199, v254, v255
  ds_read_b64_tr_b16 a[248:249], v68 offset:33024
  s_waitcnt lgkmcnt(6)
  v_mfma_f32_16x16x16_bf16 a[160:163], a[224:225], v[212:213], a[160:163]
  v_lshlrev_b32 v240, 16, v214
  v_and_b32 v241, 0xffff0000, v214
  ds_read_b64_tr_b16 a[252:253], v70 offset:33024
  s_waitcnt lgkmcnt(6)
  v_mfma_f32_16x16x16_bf16 a[164:167], a[228:229], v[212:213], a[164:167]
  v_fma_f32 v240, v240, s30, -v39
  v_fma_f32 v241, v241, s30, -v39
  s_waitcnt lgkmcnt(5)
  v_mfma_f32_16x16x16_bf16 a[168:171], a[232:233], v[212:213], a[168:171]
  v_exp_f32 v242, v240
  v_exp_f32 v243, v241
  s_waitcnt lgkmcnt(4)
  v_mfma_f32_16x16x16_bf16 a[172:175], a[236:237], v[212:213], a[172:175]
  v_add_f32 v36, v36, v242
  v_add_f32 v36, v36, v243
  s_waitcnt lgkmcnt(3)
  v_mfma_f32_16x16x16_bf16 a[176:179], a[240:241], v[212:213], a[176:179]
  v_cvt_pk_bf16_f32 v214, v242, v243
  v_lshlrev_b32 v244, 16, v215
  s_waitcnt lgkmcnt(2)
  v_mfma_f32_16x16x16_bf16 a[180:183], a[244:245], v[212:213], a[180:183]
  v_and_b32 v245, 0xffff0000, v215
  v_fma_f32 v244, v244, s30, -v39
  s_waitcnt lgkmcnt(1)
  v_mfma_f32_16x16x16_bf16 a[184:187], a[248:249], v[212:213], a[184:187]
  v_fma_f32 v245, v245, s30, -v39
  v_exp_f32 v246, v244
  s_waitcnt lgkmcnt(0)
  v_mfma_f32_16x16x16_bf16 a[188:191], a[252:253], v[212:213], a[188:191]
  v_exp_f32 v247, v245
  v_add_f32 v36, v36, v246
  v_add_f32 v36, v36, v247
  v_cvt_pk_bf16_f32 v215, v246, v247
  s_waitcnt vmcnt(0)
  s_barrier
  ds_read_b64_tr_b16 a[192:193], v41 offset:0
  ds_read_b64_tr_b16 a[194:195], v41 offset:8192
  ds_read_b64_tr_b16 a[196:197], v43 offset:0
  ds_read_b64_tr_b16 a[198:199], v43 offset:8192
  ds_read_b64_tr_b16 a[200:201], v45 offset:0
  ds_read_b64_tr_b16 a[202:203], v45 offset:8192
  ds_read_b64_tr_b16 a[204:205], v47 offset:0
  ds_read_b64_tr_b16 a[206:207], v47 offset:8192
  ds_read_b64_tr_b16 a[208:209], v49 offset:0
  ds_read_b64_tr_b16 a[210:211], v49 offset:8192
  ds_read_b64_tr_b16 a[212:213], v51 offset:0
  ds_read_b64_tr_b16 a[214:215], v51 offset:8192
  ds_read_b64_tr_b16 a[216:217], v53 offset:0
  ds_read_b64_tr_b16 a[218:219], v53 offset:8192
  s_waitcnt lgkmcnt(12)
  v_mfma_f32_16x16x32_bf16 a[0:3], a[192:195], v[128:131], a[0:3]
  v_mfma_f32_16x16x32_bf16 a[64:67], a[192:195], v[192:195], a[64:67]
  ds_read_b64_tr_b16 a[220:221], v55 offset:0
  ds_read_b64_tr_b16 a[222:223], v55 offset:8192
  s_waitcnt lgkmcnt(12)
  v_mfma_f32_16x16x32_bf16 a[4:7], a[196:199], v[128:131], a[4:7]
  v_mfma_f32_16x16x32_bf16 a[68:71], a[196:199], v[192:195], a[68:71]
  ds_read_b64_tr_b16 a[224:225], v41 offset:256
  ds_read_b64_tr_b16 a[226:227], v41 offset:8448
  s_waitcnt lgkmcnt(12)
  v_mfma_f32_16x16x32_bf16 a[8:11], a[200:203], v[128:131], a[8:11]
  v_mfma_f32_16x16x32_bf16 a[72:75], a[200:203], v[192:195], a[72:75]
  ds_read_b64_tr_b16 a[228:229], v43 offset:256
  ds_read_b64_tr_b16 a[230:231], v43 offset:8448
  s_waitcnt lgkmcnt(12)
  v_mfma_f32_16x16x32_bf16 a[12:15], a[204:207], v[128:131], a[12:15]
  v_mfma_f32_16x16x32_bf16 a[76:79], a[204:207], v[192:195], a[76:79]
  ds_read_b64_tr_b16 a[232:233], v45 offset:256
  ds_read_b64_tr_b16 a[234:235], v45 offset:8448
  s_waitcnt lgkmcnt(12)
  v_mfma_f32_16x16x32_bf16 a[16:19], a[208:211], v[128:131], a[16:19]
  v_mfma_f32_16x16x32_bf16 a[80:83], a[208:211], v[192:195], a[80:83]
  ds_read_b64_tr_b16 a[236:237], v47 offset:256
  ds_read_b64_tr_b16 a[238:239], v47 offset:8448
  s_waitcnt lgkmcnt(12)
  v_mfma_f32_16x16x32_bf16 a[20:23], a[212:215], v[128:131], a[20:23]
  v_mfma_f32_16x16x32_bf16 a[84:87], a[212:215], v[192:195], a[84:87]
  ds_read_b64_tr_b16 a[240:241], v49 offset:256
  ds_read_b64_tr_b16 a[242:243], v49 offset:8448
  s_waitcnt lgkmcnt(12)
  v_mfma_f32_16x16x32_bf16 a[24:27], a[216:219], v[128:131], a[24:27]
  v_mfma_f32_16x16x32_bf16 a[88:91], a[216:219], v[192:195], a[88:91]
  ds_read_b64_tr_b16 a[244:245], v51 offset:256
  ds_read_b64_tr_b16 a[246:247], v51 offset:8448
  s_waitcnt lgkmcnt(12)
  v_mfma_f32_16x16x32_bf16 a[28:31], a[220:223], v[128:131], a[28:31]
  v_mfma_f32_16x16x32_bf16 a[92:95], a[220:223], v[192:195], a[92:95]
  ds_read_b64_tr_b16 a[248:249], v53 offset:256
  ds_read_b64_tr_b16 a[250:251], v53 offset:8448
  s_waitcnt lgkmcnt(12)
  v_mfma_f32_16x16x32_bf16 a[32:35], a[224:227], v[128:131], a[32:35]
  v_mfma_f32_16x16x32_bf16 a[96:99], a[224:227], v[192:195], a[96:99]
  ds_read_b64_tr_b16 a[252:253], v55 offset:256
  ds_read_b64_tr_b16 a[254:255], v55 offset:8448
  s_waitcnt lgkmcnt(12)
  v_mfma_f32_16x16x32_bf16 a[36:39], a[228:231], v[128:131], a[36:39]
  v_mfma_f32_16x16x32_bf16 a[100:103], a[228:231], v[192:195], a[100:103]
  ds_read_b64_tr_b16 a[192:193], v41 offset:16384
  ds_read_b64_tr_b16 a[194:195], v41 offset:24576
  s_waitcnt lgkmcnt(12)
  v_mfma_f32_16x16x32_bf16 a[40:43], a[232:235], v[128:131], a[40:43]
  v_mfma_f32_16x16x32_bf16 a[104:107], a[232:235], v[192:195], a[104:107]
  ds_read_b64_tr_b16 a[196:197], v43 offset:16384
  ds_read_b64_tr_b16 a[198:199], v43 offset:24576
  s_waitcnt lgkmcnt(12)
  v_mfma_f32_16x16x32_bf16 a[44:47], a[236:239], v[128:131], a[44:47]
  v_mfma_f32_16x16x32_bf16 a[108:111], a[236:239], v[192:195], a[108:111]
  ds_read_b64_tr_b16 a[200:201], v45 offset:16384
  ds_read_b64_tr_b16 a[202:203], v45 offset:24576
  s_waitcnt lgkmcnt(12)
  v_mfma_f32_16x16x32_bf16 a[48:51], a[240:243], v[128:131], a[48:51]
  v_mfma_f32_16x16x32_bf16 a[112:115], a[240:243], v[192:195], a[112:115]
  ds_read_b64_tr_b16 a[204:205], v47 offset:16384
  ds_read_b64_tr_b16 a[206:207], v47 offset:24576
  s_waitcnt lgkmcnt(12)
  v_mfma_f32_16x16x32_bf16 a[52:55], a[244:247], v[128:131], a[52:55]
  v_mfma_f32_16x16x32_bf16 a[116:119], a[244:247], v[192:195], a[116:119]
  ds_read_b64_tr_b16 a[208:209], v49 offset:16384
  ds_read_b64_tr_b16 a[210:211], v49 offset:24576
  s_waitcnt lgkmcnt(12)
  v_mfma_f32_16x16x32_bf16 a[56:59], a[248:251], v[128:131], a[56:59]
  v_mfma_f32_16x16x32_bf16 a[120:123], a[248:251], v[192:195], a[120:123]
  ds_read_b64_tr_b16 a[212:213], v51 offset:16384
  ds_read_b64_tr_b16 a[214:215], v51 offset:24576
  s_waitcnt lgkmcnt(12)
  v_mfma_f32_16x16x32_bf16 a[60:63], a[252:255], v[128:131], a[60:63]
  v_mfma_f32_16x16x32_bf16 a[124:127], a[252:255], v[192:195], a[124:127]
  ds_read_b64_tr_b16 a[216:217], v53 offset:16384
  ds_read_b64_tr_b16 a[218:219], v53 offset:24576
  s_waitcnt lgkmcnt(12)
  v_mfma_f32_16x16x32_bf16 a[0:3], a[192:195], v[132:135], a[0:3]
  v_mfma_f32_16x16x32_bf16 a[64:67], a[192:195], v[196:199], a[64:67]
  ds_read_b64_tr_b16 a[220:221], v55 offset:16384
  ds_read_b64_tr_b16 a[222:223], v55 offset:24576
  s_waitcnt lgkmcnt(12)
  v_mfma_f32_16x16x32_bf16 a[4:7], a[196:199], v[132:135], a[4:7]
  v_mfma_f32_16x16x32_bf16 a[68:71], a[196:199], v[196:199], a[68:71]
  ds_read_b64_tr_b16 a[224:225], v41 offset:16640
  ds_read_b64_tr_b16 a[226:227], v41 offset:24832
  s_waitcnt lgkmcnt(12)
  v_mfma_f32_16x16x32_bf16 a[8:11], a[200:203], v[132:135], a[8:11]
  v_mfma_f32_16x16x32_bf16 a[72:75], a[200:203], v[196:199], a[72:75]
  ds_read_b64_tr_b16 a[228:229], v43 offset:16640
  ds_read_b64_tr_b16 a[230:231], v43 offset:24832
  s_waitcnt lgkmcnt(12)
  v_mfma_f32_16x16x32_bf16 a[12:15], a[204:207], v[132:135], a[12:15]
  v_mfma_f32_16x16x32_bf16 a[76:79], a[204:207], v[196:199], a[76:79]
  ds_read_b64_tr_b16 a[232:233], v45 offset:16640
  ds_read_b64_tr_b16 a[234:235], v45 offset:24832
  s_waitcnt lgkmcnt(12)
  v_mfma_f32_16x16x32_bf16 a[16:19], a[208:211], v[132:135], a[16:19]
  v_mfma_f32_16x16x32_bf16 a[80:83], a[208:211], v[196:199], a[80:83]
  ds_read_b64_tr_b16 a[236:237], v47 offset:16640
  ds_read_b64_tr_b16 a[238:239], v47 offset:24832
  s_waitcnt lgkmcnt(12)
  v_mfma_f32_16x16x32_bf16 a[20:23], a[212:215], v[132:135], a[20:23]
  v_mfma_f32_16x16x32_bf16 a[84:87], a[212:215], v[196:199], a[84:87]
  ds_read_b64_tr_b16 a[240:241], v49 offset:16640
  ds_read_b64_tr_b16 a[242:243], v49 offset:24832
  s_waitcnt lgkmcnt(12)
  v_mfma_f32_16x16x32_bf16 a[24:27], a[216:219], v[132:135], a[24:27]
  v_mfma_f32_16x16x32_bf16 a[88:91], a[216:219], v[196:199], a[88:91]
  ds_read_b64_tr_b16 a[244:245], v51 offset:16640
  ds_read_b64_tr_b16 a[246:247], v51 offset:24832
  s_waitcnt lgkmcnt(12)
  v_mfma_f32_16x16x32_bf16 a[28:31], a[220:223], v[132:135], a[28:31]
  v_mfma_f32_16x16x32_bf16 a[92:95], a[220:223], v[196:199], a[92:95]
  ds_read_b64_tr_b16 a[248:249], v53 offset:16640
  ds_read_b64_tr_b16 a[250:251], v53 offset:24832
  s_waitcnt lgkmcnt(12)
  v_mfma_f32_16x16x32_bf16 a[32:35], a[224:227], v[132:135], a[32:35]
  v_mfma_f32_16x16x32_bf16 a[96:99], a[224:227], v[196:199], a[96:99]
  ds_read_b64_tr_b16 a[252:253], v55 offset:16640
  ds_read_b64_tr_b16 a[254:255], v55 offset:24832
  s_waitcnt lgkmcnt(12)
  v_mfma_f32_16x16x32_bf16 a[36:39], a[228:231], v[132:135], a[36:39]
  v_mfma_f32_16x16x32_bf16 a[100:103], a[228:231], v[196:199], a[100:103]
  ds_read_b64_tr_b16 a[192:193], v57 offset:0
  s_waitcnt lgkmcnt(11)
  v_mfma_f32_16x16x32_bf16 a[40:43], a[232:235], v[132:135], a[40:43]
  v_mfma_f32_16x16x32_bf16 a[104:107], a[232:235], v[196:199], a[104:107]
  ds_read_b64_tr_b16 a[196:197], v59 offset:0
  s_waitcnt lgkmcnt(10)
  v_mfma_f32_16x16x32_bf16 a[44:47], a[236:239], v[132:135], a[44:47]
  v_mfma_f32_16x16x32_bf16 a[108:111], a[236:239], v[196:199], a[108:111]
  ds_read_b64_tr_b16 a[200:201], v61 offset:0
  s_waitcnt lgkmcnt(9)
  v_mfma_f32_16x16x32_bf16 a[48:51], a[240:243], v[132:135], a[48:51]
  v_mfma_f32_16x16x32_bf16 a[112:115], a[240:243], v[196:199], a[112:115]
  ds_read_b64_tr_b16 a[204:205], v63 offset:0
  s_waitcnt lgkmcnt(8)
  v_mfma_f32_16x16x32_bf16 a[52:55], a[244:247], v[132:135], a[52:55]
  v_mfma_f32_16x16x32_bf16 a[116:119], a[244:247], v[196:199], a[116:119]
  ds_read_b64_tr_b16 a[208:209], v65 offset:0
  s_waitcnt lgkmcnt(7)
  v_mfma_f32_16x16x32_bf16 a[56:59], a[248:251], v[132:135], a[56:59]
  v_mfma_f32_16x16x32_bf16 a[120:123], a[248:251], v[196:199], a[120:123]
  ds_read_b64_tr_b16 a[212:213], v67 offset:0
  s_waitcnt lgkmcnt(6)
  v_mfma_f32_16x16x32_bf16 a[60:63], a[252:255], v[132:135], a[60:63]
  v_mfma_f32_16x16x32_bf16 a[124:127], a[252:255], v[196:199], a[124:127]
  ds_read_b64_tr_b16 a[216:217], v69 offset:0
  s_waitcnt lgkmcnt(6)
  v_mfma_f32_16x16x16_bf16 a[128:131], a[192:193], v[214:215], a[128:131]
  ds_read_b64_tr_b16 a[220:221], v71 offset:0
  s_waitcnt lgkmcnt(6)
  v_mfma_f32_16x16x16_bf16 a[132:135], a[196:197], v[214:215], a[132:135]
  ds_read_b64_tr_b16 a[224:225], v57 offset:256
  s_waitcnt lgkmcnt(6)
  v_mfma_f32_16x16x16_bf16 a[136:139], a[200:201], v[214:215], a[136:139]
  ds_read_b64_tr_b16 a[228:229], v59 offset:256
  s_waitcnt lgkmcnt(6)
  v_mfma_f32_16x16x16_bf16 a[140:143], a[204:205], v[214:215], a[140:143]
  ds_read_b64_tr_b16 a[232:233], v61 offset:256
  s_waitcnt lgkmcnt(6)
  v_mfma_f32_16x16x16_bf16 a[144:147], a[208:209], v[214:215], a[144:147]
  ds_read_b64_tr_b16 a[236:237], v63 offset:256
  s_waitcnt lgkmcnt(6)
  v_mfma_f32_16x16x16_bf16 a[148:151], a[212:213], v[214:215], a[148:151]
  ds_read_b64_tr_b16 a[240:241], v65 offset:256
  s_waitcnt lgkmcnt(6)
  v_mfma_f32_16x16x16_bf16 a[152:155], a[216:217], v[214:215], a[152:155]
  ds_read_b64_tr_b16 a[244:245], v67 offset:256
  s_waitcnt lgkmcnt(6)
  v_mfma_f32_16x16x16_bf16 a[156:159], a[220:221], v[214:215], a[156:159]
  ds_read_b64_tr_b16 a[248:249], v69 offset:256
  s_waitcnt lgkmcnt(6)
  v_mfma_f32_16x16x16_bf16 a[160:163], a[224:225], v[214:215], a[160:163]
  ds_read_b64_tr_b16 a[252:253], v71 offset:256
  s_waitcnt lgkmcnt(6)
  v_mfma_f32_16x16x16_bf16 a[164:167], a[228:229], v[214:215], a[164:167]
  s_waitcnt lgkmcnt(5)
  v_mfma_f32_16x16x16_bf16 a[168:171], a[232:233], v[214:215], a[168:171]
  s_waitcnt lgkmcnt(4)
  v_mfma_f32_16x16x16_bf16 a[172:175], a[236:237], v[214:215], a[172:175]
  s_waitcnt lgkmcnt(3)
  v_mfma_f32_16x16x16_bf16 a[176:179], a[240:241], v[214:215], a[176:179]
  s_waitcnt lgkmcnt(2)
  v_mfma_f32_16x16x16_bf16 a[180:183], a[244:245], v[214:215], a[180:183]
  s_waitcnt lgkmcnt(1)
  v_mfma_f32_16x16x16_bf16 a[184:187], a[248:249], v[214:215], a[184:187]
  s_waitcnt lgkmcnt(0)
  v_mfma_f32_16x16x16_bf16 a[188:191], a[252:253], v[214:215], a[188:191]
  ds_bpermute_b32 v4, v29, v34
  s_waitcnt lgkmcnt(0)
  v_add_f32 v34, v34, v4
  ds_bpermute_b32 v4, v30, v34
  s_waitcnt lgkmcnt(0)
  v_add_f32 v34, v34, v4
  ds_bpermute_b32 v4, v29, v35
  s_waitcnt lgkmcnt(0)
  v_add_f32 v35, v35, v4
  ds_bpermute_b32 v4, v30, v35
  s_waitcnt lgkmcnt(0)
  v_add_f32 v35, v35, v4
  ds_bpermute_b32 v4, v29, v36
  s_waitcnt lgkmcnt(0)
  v_add_f32 v36, v36, v4
  ds_bpermute_b32 v4, v30, v36
  s_waitcnt lgkmcnt(0)
  v_add_f32 v36, v36, v4
  v_rcp_f32 v34, v34
  v_rcp_f32 v35, v35
  s_mul_i32 s5, s7, 144
  s_lshl_b32 s3, s28, 5
  s_add_u32 s3, s3, s5
  s_lshl_b32 s4, s6, 9
  v_add_u32 v5, s3, v3
  s_mov_b32 s42, 8448
  v_mul_lo_u32 v5, v5, s42
  v_lshl_add_u32 v5, v2, 3, v5
  v_add_u32 v6, s4, v5
  v_add_u32 v5, s3, v3
  v_add_u32 v5, 16, v5
  s_mov_b32 s42, 8448
  v_mul_lo_u32 v5, v5, s42
  v_lshl_add_u32 v5, v2, 3, v5
  v_add_u32 v7, s4, v5
  s_barrier
  s_mul_i32 s3, s28, 16896
  s_add_u32 s3, s3, 65536
  s_movk_i32 s5, 528
  v_mul_lo_u32 v12, v3, s5
  v_lshl_add_u32 v12, v2, 3, v12
  v_add_u32 v12, s3, v12
  v_accvgpr_read_b32 v240, a0
  v_accvgpr_read_b32 v241, a1
  v_accvgpr_read_b32 v242, a2
  v_accvgpr_read_b32 v243, a3
  v_mul_f32 v240, v240, v34
  v_mul_f32 v241, v241, v34
  v_mul_f32 v242, v242, v34
  v_mul_f32 v243, v243, v34
  v_cvt_pk_bf16_f32 v244, v240, v241
  v_cvt_pk_bf16_f32 v245, v242, v243
  ds_write_b64 v12, v[244:245] offset:0
  v_accvgpr_read_b32 v246, a4
  v_accvgpr_read_b32 v247, a5
  v_accvgpr_read_b32 v248, a6
  v_accvgpr_read_b32 v249, a7
  v_mul_f32 v246, v246, v34
  v_mul_f32 v247, v247, v34
  v_mul_f32 v248, v248, v34
  v_mul_f32 v249, v249, v34
  v_cvt_pk_bf16_f32 v250, v246, v247
  v_cvt_pk_bf16_f32 v251, v248, v249
  ds_write_b64 v12, v[250:251] offset:32
  v_accvgpr_read_b32 v240, a8
  v_accvgpr_read_b32 v241, a9
  v_accvgpr_read_b32 v242, a10
  v_accvgpr_read_b32 v243, a11
  v_mul_f32 v240, v240, v34
  v_mul_f32 v241, v241, v34
  v_mul_f32 v242, v242, v34
  v_mul_f32 v243, v243, v34
  v_cvt_pk_bf16_f32 v244, v240, v241
  v_cvt_pk_bf16_f32 v245, v242, v243
  ds_write_b64 v12, v[244:245] offset:64
  v_accvgpr_read_b32 v246, a12
  v_accvgpr_read_b32 v247, a13
  v_accvgpr_read_b32 v248, a14
  v_accvgpr_read_b32 v249, a15
  v_mul_f32 v246, v246, v34
  v_mul_f32 v247, v247, v34
  v_mul_f32 v248, v248, v34
  v_mul_f32 v249, v249, v34
  v_cvt_pk_bf16_f32 v250, v246, v247
  v_cvt_pk_bf16_f32 v251, v248, v249
  ds_write_b64 v12, v[250:251] offset:96
  v_accvgpr_read_b32 v240, a16
  v_accvgpr_read_b32 v241, a17
  v_accvgpr_read_b32 v242, a18
  v_accvgpr_read_b32 v243, a19
  v_mul_f32 v240, v240, v34
  v_mul_f32 v241, v241, v34
  v_mul_f32 v242, v242, v34
  v_mul_f32 v243, v243, v34
  v_cvt_pk_bf16_f32 v244, v240, v241
  v_cvt_pk_bf16_f32 v245, v242, v243
  ds_write_b64 v12, v[244:245] offset:128
  v_accvgpr_read_b32 v246, a20
  v_accvgpr_read_b32 v247, a21
  v_accvgpr_read_b32 v248, a22
  v_accvgpr_read_b32 v249, a23
  v_mul_f32 v246, v246, v34
  v_mul_f32 v247, v247, v34
  v_mul_f32 v248, v248, v34
  v_mul_f32 v249, v249, v34
  v_cvt_pk_bf16_f32 v250, v246, v247
  v_cvt_pk_bf16_f32 v251, v248, v249
  ds_write_b64 v12, v[250:251] offset:160
  v_accvgpr_read_b32 v240, a24
  v_accvgpr_read_b32 v241, a25
  v_accvgpr_read_b32 v242, a26
  v_accvgpr_read_b32 v243, a27
  v_mul_f32 v240, v240, v34
  v_mul_f32 v241, v241, v34
  v_mul_f32 v242, v242, v34
  v_mul_f32 v243, v243, v34
  v_cvt_pk_bf16_f32 v244, v240, v241
  v_cvt_pk_bf16_f32 v245, v242, v243
  ds_write_b64 v12, v[244:245] offset:192
  v_accvgpr_read_b32 v246, a28
  v_accvgpr_read_b32 v247, a29
  v_accvgpr_read_b32 v248, a30
  v_accvgpr_read_b32 v249, a31
  v_mul_f32 v246, v246, v34
  v_mul_f32 v247, v247, v34
  v_mul_f32 v248, v248, v34
  v_mul_f32 v249, v249, v34
  v_cvt_pk_bf16_f32 v250, v246, v247
  v_cvt_pk_bf16_f32 v251, v248, v249
  ds_write_b64 v12, v[250:251] offset:224
  v_accvgpr_read_b32 v240, a32
  v_accvgpr_read_b32 v241, a33
  v_accvgpr_read_b32 v242, a34
  v_accvgpr_read_b32 v243, a35
  v_mul_f32 v240, v240, v34
  v_mul_f32 v241, v241, v34
  v_mul_f32 v242, v242, v34
  v_mul_f32 v243, v243, v34
  v_cvt_pk_bf16_f32 v244, v240, v241
  v_cvt_pk_bf16_f32 v245, v242, v243
  ds_write_b64 v12, v[244:245] offset:256
  v_accvgpr_read_b32 v246, a36
  v_accvgpr_read_b32 v247, a37
  v_accvgpr_read_b32 v248, a38
  v_accvgpr_read_b32 v249, a39
  v_mul_f32 v246, v246, v34
  v_mul_f32 v247, v247, v34
  v_mul_f32 v248, v248, v34
  v_mul_f32 v249, v249, v34
  v_cvt_pk_bf16_f32 v250, v246, v247
  v_cvt_pk_bf16_f32 v251, v248, v249
  ds_write_b64 v12, v[250:251] offset:288
  v_accvgpr_read_b32 v240, a40
  v_accvgpr_read_b32 v241, a41
  v_accvgpr_read_b32 v242, a42
  v_accvgpr_read_b32 v243, a43
  v_mul_f32 v240, v240, v34
  v_mul_f32 v241, v241, v34
  v_mul_f32 v242, v242, v34
  v_mul_f32 v243, v243, v34
  v_cvt_pk_bf16_f32 v244, v240, v241
  v_cvt_pk_bf16_f32 v245, v242, v243
  ds_write_b64 v12, v[244:245] offset:320
  v_accvgpr_read_b32 v246, a44
  v_accvgpr_read_b32 v247, a45
  v_accvgpr_read_b32 v248, a46
  v_accvgpr_read_b32 v249, a47
  v_mul_f32 v246, v246, v34
  v_mul_f32 v247, v247, v34
  v_mul_f32 v248, v248, v34
  v_mul_f32 v249, v249, v34
  v_cvt_pk_bf16_f32 v250, v246, v247
  v_cvt_pk_bf16_f32 v251, v248, v249
  ds_write_b64 v12, v[250:251] offset:352
  v_accvgpr_read_b32 v240, a48
  v_accvgpr_read_b32 v241, a49
  v_accvgpr_read_b32 v242, a50
  v_accvgpr_read_b32 v243, a51
  v_mul_f32 v240, v240, v34
  v_mul_f32 v241, v241, v34
  v_mul_f32 v242, v242, v34
  v_mul_f32 v243, v243, v34
  v_cvt_pk_bf16_f32 v244, v240, v241
  v_cvt_pk_bf16_f32 v245, v242, v243
  ds_write_b64 v12, v[244:245] offset:384
  v_accvgpr_read_b32 v246, a52
  v_accvgpr_read_b32 v247, a53
  v_accvgpr_read_b32 v248, a54
  v_accvgpr_read_b32 v249, a55
  v_mul_f32 v246, v246, v34
  v_mul_f32 v247, v247, v34
  v_mul_f32 v248, v248, v34
  v_mul_f32 v249, v249, v34
  v_cvt_pk_bf16_f32 v250, v246, v247
  v_cvt_pk_bf16_f32 v251, v248, v249
  ds_write_b64 v12, v[250:251] offset:416
  v_accvgpr_read_b32 v240, a56
  v_accvgpr_read_b32 v241, a57
  v_accvgpr_read_b32 v242, a58
  v_accvgpr_read_b32 v243, a59
  v_mul_f32 v240, v240, v34
  v_mul_f32 v241, v241, v34
  v_mul_f32 v242, v242, v34
  v_mul_f32 v243, v243, v34
  v_cvt_pk_bf16_f32 v244, v240, v241
  v_cvt_pk_bf16_f32 v245, v242, v243
  ds_write_b64 v12, v[244:245] offset:448
  v_accvgpr_read_b32 v246, a60
  v_accvgpr_read_b32 v247, a61
  v_accvgpr_read_b32 v248, a62
  v_accvgpr_read_b32 v249, a63
  v_mul_f32 v246, v246, v34
  v_mul_f32 v247, v247, v34
  v_mul_f32 v248, v248, v34
  v_mul_f32 v249, v249, v34
  v_cvt_pk_bf16_f32 v250, v246, v247
  v_cvt_pk_bf16_f32 v251, v248, v249
  ds_write_b64 v12, v[250:251] offset:480
  v_accvgpr_read_b32 v240, a64
  v_accvgpr_read_b32 v241, a65
  v_accvgpr_read_b32 v242, a66
  v_accvgpr_read_b32 v243, a67
  v_mul_f32 v240, v240, v35
  v_mul_f32 v241, v241, v35
  v_mul_f32 v242, v242, v35
  v_mul_f32 v243, v243, v35
  v_cvt_pk_bf16_f32 v244, v240, v241
  v_cvt_pk_bf16_f32 v245, v242, v243
  ds_write_b64 v12, v[244:245] offset:8448
  v_accvgpr_read_b32 v246, a68
  v_accvgpr_read_b32 v247, a69
  v_accvgpr_read_b32 v248, a70
  v_accvgpr_read_b32 v249, a71
  v_mul_f32 v246, v246, v35
  v_mul_f32 v247, v247, v35
  v_mul_f32 v248, v248, v35
  v_mul_f32 v249, v249, v35
  v_cvt_pk_bf16_f32 v250, v246, v247
  v_cvt_pk_bf16_f32 v251, v248, v249
  ds_write_b64 v12, v[250:251] offset:8480
  v_accvgpr_read_b32 v240, a72
  v_accvgpr_read_b32 v241, a73
  v_accvgpr_read_b32 v242, a74
  v_accvgpr_read_b32 v243, a75
  v_mul_f32 v240, v240, v35
  v_mul_f32 v241, v241, v35
  v_mul_f32 v242, v242, v35
  v_mul_f32 v243, v243, v35
  v_cvt_pk_bf16_f32 v244, v240, v241
  v_cvt_pk_bf16_f32 v245, v242, v243
  ds_write_b64 v12, v[244:245] offset:8512
  v_accvgpr_read_b32 v246, a76
  v_accvgpr_read_b32 v247, a77
  v_accvgpr_read_b32 v248, a78
  v_accvgpr_read_b32 v249, a79
  v_mul_f32 v246, v246, v35
  v_mul_f32 v247, v247, v35
  v_mul_f32 v248, v248, v35
  v_mul_f32 v249, v249, v35
  v_cvt_pk_bf16_f32 v250, v246, v247
  v_cvt_pk_bf16_f32 v251, v248, v249
  ds_write_b64 v12, v[250:251] offset:8544
  v_accvgpr_read_b32 v240, a80
  v_accvgpr_read_b32 v241, a81
  v_accvgpr_read_b32 v242, a82
  v_accvgpr_read_b32 v243, a83
  v_mul_f32 v240, v240, v35
  v_mul_f32 v241, v241, v35
  v_mul_f32 v242, v242, v35
  v_mul_f32 v243, v243, v35
  v_cvt_pk_bf16_f32 v244, v240, v241
  v_cvt_pk_bf16_f32 v245, v242, v243
  ds_write_b64 v12, v[244:245] offset:8576
  v_accvgpr_read_b32 v246, a84
  v_accvgpr_read_b32 v247, a85
  v_accvgpr_read_b32 v248, a86
  v_accvgpr_read_b32 v249, a87
  v_mul_f32 v246, v246, v35
  v_mul_f32 v247, v247, v35
  v_mul_f32 v248, v248, v35
  v_mul_f32 v249, v249, v35
  v_cvt_pk_bf16_f32 v250, v246, v247
  v_cvt_pk_bf16_f32 v251, v248, v249
  ds_write_b64 v12, v[250:251] offset:8608
  v_accvgpr_read_b32 v240, a88
  v_accvgpr_read_b32 v241, a89
  v_accvgpr_read_b32 v242, a90
  v_accvgpr_read_b32 v243, a91
  v_mul_f32 v240, v240, v35
  v_mul_f32 v241, v241, v35
  v_mul_f32 v242, v242, v35
  v_mul_f32 v243, v243, v35
  v_cvt_pk_bf16_f32 v244, v240, v241
  v_cvt_pk_bf16_f32 v245, v242, v243
  ds_write_b64 v12, v[244:245] offset:8640
  v_accvgpr_read_b32 v246, a92
  v_accvgpr_read_b32 v247, a93
  v_accvgpr_read_b32 v248, a94
  v_accvgpr_read_b32 v249, a95
  v_mul_f32 v246, v246, v35
  v_mul_f32 v247, v247, v35
  v_mul_f32 v248, v248, v35
  v_mul_f32 v249, v249, v35
  v_cvt_pk_bf16_f32 v250, v246, v247
  v_cvt_pk_bf16_f32 v251, v248, v249
  ds_write_b64 v12, v[250:251] offset:8672
  v_accvgpr_read_b32 v240, a96
  v_accvgpr_read_b32 v241, a97
  v_accvgpr_read_b32 v242, a98
  v_accvgpr_read_b32 v243, a99
  v_mul_f32 v240, v240, v35
  v_mul_f32 v241, v241, v35
  v_mul_f32 v242, v242, v35
  v_mul_f32 v243, v243, v35
  v_cvt_pk_bf16_f32 v244, v240, v241
  v_cvt_pk_bf16_f32 v245, v242, v243
  ds_write_b64 v12, v[244:245] offset:8704
  v_accvgpr_read_b32 v246, a100
  v_accvgpr_read_b32 v247, a101
  v_accvgpr_read_b32 v248, a102
  v_accvgpr_read_b32 v249, a103
  v_mul_f32 v246, v246, v35
  v_mul_f32 v247, v247, v35
  v_mul_f32 v248, v248, v35
  v_mul_f32 v249, v249, v35
  v_cvt_pk_bf16_f32 v250, v246, v247
  v_cvt_pk_bf16_f32 v251, v248, v249
  ds_write_b64 v12, v[250:251] offset:8736
  v_accvgpr_read_b32 v240, a104
  v_accvgpr_read_b32 v241, a105
  v_accvgpr_read_b32 v242, a106
  v_accvgpr_read_b32 v243, a107
  v_mul_f32 v240, v240, v35
  v_mul_f32 v241, v241, v35
  v_mul_f32 v242, v242, v35
  v_mul_f32 v243, v243, v35
  v_cvt_pk_bf16_f32 v244, v240, v241
  v_cvt_pk_bf16_f32 v245, v242, v243
  ds_write_b64 v12, v[244:245] offset:8768
  v_accvgpr_read_b32 v246, a108
  v_accvgpr_read_b32 v247, a109
  v_accvgpr_read_b32 v248, a110
  v_accvgpr_read_b32 v249, a111
  v_mul_f32 v246, v246, v35
  v_mul_f32 v247, v247, v35
  v_mul_f32 v248, v248, v35
  v_mul_f32 v249, v249, v35
  v_cvt_pk_bf16_f32 v250, v246, v247
  v_cvt_pk_bf16_f32 v251, v248, v249
  ds_write_b64 v12, v[250:251] offset:8800
  v_accvgpr_read_b32 v240, a112
  v_accvgpr_read_b32 v241, a113
  v_accvgpr_read_b32 v242, a114
  v_accvgpr_read_b32 v243, a115
  v_mul_f32 v240, v240, v35
  v_mul_f32 v241, v241, v35
  v_mul_f32 v242, v242, v35
  v_mul_f32 v243, v243, v35
  v_cvt_pk_bf16_f32 v244, v240, v241
  v_cvt_pk_bf16_f32 v245, v242, v243
  ds_write_b64 v12, v[244:245] offset:8832
  v_accvgpr_read_b32 v246, a116
  v_accvgpr_read_b32 v247, a117
  v_accvgpr_read_b32 v248, a118
  v_accvgpr_read_b32 v249, a119
  v_mul_f32 v246, v246, v35
  v_mul_f32 v247, v247, v35
  v_mul_f32 v248, v248, v35
  v_mul_f32 v249, v249, v35
  v_cvt_pk_bf16_f32 v250, v246, v247
  v_cvt_pk_bf16_f32 v251, v248, v249
  ds_write_b64 v12, v[250:251] offset:8864
  v_accvgpr_read_b32 v240, a120
  v_accvgpr_read_b32 v241, a121
  v_accvgpr_read_b32 v242, a122
  v_accvgpr_read_b32 v243, a123
  v_mul_f32 v240, v240, v35
  v_mul_f32 v241, v241, v35
  v_mul_f32 v242, v242, v35
  v_mul_f32 v243, v243, v35
  v_cvt_pk_bf16_f32 v244, v240, v241
  v_cvt_pk_bf16_f32 v245, v242, v243
  ds_write_b64 v12, v[244:245] offset:8896
  v_accvgpr_read_b32 v246, a124
  v_accvgpr_read_b32 v247, a125
  v_accvgpr_read_b32 v248, a126
  v_accvgpr_read_b32 v249, a127
  v_mul_f32 v246, v246, v35
  v_mul_f32 v247, v247, v35
  v_mul_f32 v248, v248, v35
  v_mul_f32 v249, v249, v35
  v_cvt_pk_bf16_f32 v250, v246, v247
  v_cvt_pk_bf16_f32 v251, v248, v249
  ds_write_b64 v12, v[250:251] offset:8928
  s_waitcnt lgkmcnt(0)
  v_lshrrev_b32 v13, 5, v1
  v_and_b32 v14, 31, v1
  v_mul_lo_u32 v12, v13, s5
  v_lshl_add_u32 v12, v14, 4, v12
  v_add_u32 v12, s3, v12
  s_mul_i32 s5, s7, 144
  s_lshl_b32 s3, s28, 5
  s_add_u32 s3, s3, s5
  v_add_u32 v15, s3, v13
  s_mov_b32 s42, 8448
  v_mul_lo_u32 v15, v15, s42
  v_lshl_add_u32 v15, v14, 4, v15
  s_lshl_b32 s4, s6, 9
  v_add_u32 v15, s4, v15
  ds_read_b128 v[72:75], v12 offset:0
  ds_read_b128 v[76:79], v12 offset:1056
  ds_read_b128 v[80:83], v12 offset:2112
  ds_read_b128 v[84:87], v12 offset:3168
  ds_read_b128 v[88:91], v12 offset:4224
  ds_read_b128 v[92:95], v12 offset:5280
  ds_read_b128 v[96:99], v12 offset:6336
  ds_read_b128 v[100:103], v12 offset:7392
  ds_read_b128 v[104:107], v12 offset:8448
  ds_read_b128 v[108:111], v12 offset:9504
  ds_read_b128 v[112:115], v12 offset:10560
  ds_read_b128 v[116:119], v12 offset:11616
  ds_read_b128 v[120:123], v12 offset:12672
  ds_read_b128 v[124:127], v12 offset:13728
  ds_read_b128 v[128:131], v12 offset:14784
  ds_read_b128 v[132:135], v12 offset:15840
  s_waitcnt lgkmcnt(15)
  buffer_store_dwordx4 v[72:75], v15, s[24:27], 0 offen
  s_nop 1
  v_add_u32 v15, 16896, v15
  s_waitcnt lgkmcnt(14)
  buffer_store_dwordx4 v[76:79], v15, s[24:27], 0 offen
  s_nop 1
  v_add_u32 v15, 16896, v15
  s_waitcnt lgkmcnt(13)
  buffer_store_dwordx4 v[80:83], v15, s[24:27], 0 offen
  s_nop 1
  v_add_u32 v15, 16896, v15
  s_waitcnt lgkmcnt(12)
  buffer_store_dwordx4 v[84:87], v15, s[24:27], 0 offen
  s_nop 1
  v_add_u32 v15, 16896, v15
  s_waitcnt lgkmcnt(11)
  buffer_store_dwordx4 v[88:91], v15, s[24:27], 0 offen
  s_nop 1
  v_add_u32 v15, 16896, v15
  s_waitcnt lgkmcnt(10)
  buffer_store_dwordx4 v[92:95], v15, s[24:27], 0 offen
  s_nop 1
  v_add_u32 v15, 16896, v15
  s_waitcnt lgkmcnt(9)
  buffer_store_dwordx4 v[96:99], v15, s[24:27], 0 offen
  s_nop 1
  v_add_u32 v15, 16896, v15
  s_waitcnt lgkmcnt(8)
  buffer_store_dwordx4 v[100:103], v15, s[24:27], 0 offen
  s_nop 1
  v_add_u32 v15, 16896, v15
  s_waitcnt lgkmcnt(7)
  buffer_store_dwordx4 v[104:107], v15, s[24:27], 0 offen
  s_nop 1
  v_add_u32 v15, 16896, v15
  s_waitcnt lgkmcnt(6)
  buffer_store_dwordx4 v[108:111], v15, s[24:27], 0 offen
  s_nop 1
  v_add_u32 v15, 16896, v15
  s_waitcnt lgkmcnt(5)
  buffer_store_dwordx4 v[112:115], v15, s[24:27], 0 offen
  s_nop 1
  v_add_u32 v15, 16896, v15
  s_waitcnt lgkmcnt(4)
  buffer_store_dwordx4 v[116:119], v15, s[24:27], 0 offen
  s_nop 1
  v_add_u32 v15, 16896, v15
  s_waitcnt lgkmcnt(3)
  buffer_store_dwordx4 v[120:123], v15, s[24:27], 0 offen
  s_nop 1
  v_add_u32 v15, 16896, v15
  s_waitcnt lgkmcnt(2)
  buffer_store_dwordx4 v[124:127], v15, s[24:27], 0 offen
  s_nop 1
  v_add_u32 v15, 16896, v15
  s_waitcnt lgkmcnt(1)
  buffer_store_dwordx4 v[128:131], v15, s[24:27], 0 offen
  s_nop 1
  v_add_u32 v15, 16896, v15
  s_waitcnt lgkmcnt(0)
  buffer_store_dwordx4 v[132:135], v15, s[24:27], 0 offen
  v_lshlrev_b32 v5, 4, v1
  s_lshl_b32 s3, s28, 14
  v_add_u32 v5, s3, v5
  v_accvgpr_read_b32 v240, a128
  v_accvgpr_read_b32 v241, a129
  v_accvgpr_read_b32 v242, a130
  v_accvgpr_read_b32 v243, a131
  ds_write_b128 v5, v[240:243] offset:0
  v_accvgpr_read_b32 v244, a132
  v_accvgpr_read_b32 v245, a133
  v_accvgpr_read_b32 v246, a134
  v_accvgpr_read_b32 v247, a135
  ds_write_b128 v5, v[244:247] offset:1024
  v_accvgpr_read_b32 v248, a136
  v_accvgpr_read_b32 v249, a137
  v_accvgpr_read_b32 v250, a138
  v_accvgpr_read_b32 v251, a139
  ds_write_b128 v5, v[248:251] offset:2048
  v_accvgpr_read_b32 v240, a140
  v_accvgpr_read_b32 v241, a141
  v_accvgpr_read_b32 v242, a142
  v_accvgpr_read_b32 v243, a143
  ds_write_b128 v5, v[240:243] offset:3072
  v_accvgpr_read_b32 v244, a144
  v_accvgpr_read_b32 v245, a145
  v_accvgpr_read_b32 v246, a146
  v_accvgpr_read_b32 v247, a147
  ds_write_b128 v5, v[244:247] offset:4096
  v_accvgpr_read_b32 v248, a148
  v_accvgpr_read_b32 v249, a149
  v_accvgpr_read_b32 v250, a150
  v_accvgpr_read_b32 v251, a151
  ds_write_b128 v5, v[248:251] offset:5120
  v_accvgpr_read_b32 v240, a152
  v_accvgpr_read_b32 v241, a153
  v_accvgpr_read_b32 v242, a154
  v_accvgpr_read_b32 v243, a155
  ds_write_b128 v5, v[240:243] offset:6144
  v_accvgpr_read_b32 v244, a156
  v_accvgpr_read_b32 v245, a157
  v_accvgpr_read_b32 v246, a158
  v_accvgpr_read_b32 v247, a159
  ds_write_b128 v5, v[244:247] offset:7168
  v_accvgpr_read_b32 v248, a160
  v_accvgpr_read_b32 v249, a161
  v_accvgpr_read_b32 v250, a162
  v_accvgpr_read_b32 v251, a163
  ds_write_b128 v5, v[248:251] offset:8192
  v_accvgpr_read_b32 v240, a164
  v_accvgpr_read_b32 v241, a165
  v_accvgpr_read_b32 v242, a166
  v_accvgpr_read_b32 v243, a167
  ds_write_b128 v5, v[240:243] offset:9216
  v_accvgpr_read_b32 v244, a168
  v_accvgpr_read_b32 v245, a169
  v_accvgpr_read_b32 v246, a170
  v_accvgpr_read_b32 v247, a171
  ds_write_b128 v5, v[244:247] offset:10240
  v_accvgpr_read_b32 v248, a172
  v_accvgpr_read_b32 v249, a173
  v_accvgpr_read_b32 v250, a174
  v_accvgpr_read_b32 v251, a175
  ds_write_b128 v5, v[248:251] offset:11264
  v_accvgpr_read_b32 v240, a176
  v_accvgpr_read_b32 v241, a177
  v_accvgpr_read_b32 v242, a178
  v_accvgpr_read_b32 v243, a179
  ds_write_b128 v5, v[240:243] offset:12288
  v_accvgpr_read_b32 v244, a180
  v_accvgpr_read_b32 v245, a181
  v_accvgpr_read_b32 v246, a182
  v_accvgpr_read_b32 v247, a183
  ds_write_b128 v5, v[244:247] offset:13312
  v_accvgpr_read_b32 v248, a184
  v_accvgpr_read_b32 v249, a185
  v_accvgpr_read_b32 v250, a186
  v_accvgpr_read_b32 v251, a187
  ds_write_b128 v5, v[248:251] offset:14336
  v_accvgpr_read_b32 v240, a188
  v_accvgpr_read_b32 v241, a189
  v_accvgpr_read_b32 v242, a190
  v_accvgpr_read_b32 v243, a191
  ds_write_b128 v5, v[240:243] offset:15360
  v_lshlrev_b32 v8, 2, v1
  v_add_u32 v8, 131072, v8
  s_lshl_b32 s3, s28, 8
  v_add_u32 v9, s3, v8
  ds_write_b32 v9, v36 offset:1024
  s_waitcnt lgkmcnt(0)
  s_barrier
  v_lshlrev_b32 v5, 4, v1
  s_lshl_b32 s3, s28, 12
  v_add_u32 v5, s3, v5
  ds_read_b32 v240, v8 offset:1024
  ds_read_b32 v241, v8 offset:1280
  ds_read_b32 v242, v8 offset:1536
  ds_read_b32 v243, v8 offset:1792
  s_waitcnt lgkmcnt(2)
  v_add_f32 v240, v240, v241
  s_waitcnt lgkmcnt(0)
  v_add_f32 v242, v242, v243
  v_add_f32 v240, v240, v242
  v_rcp_f32 v10, v240
  s_mul_i32 s5, s7, 144
  s_add_u32 s5, s5, 128
  v_add_u32 v11, s5, v3
  s_mov_b32 s42, 8448
  v_mul_lo_u32 v11, v11, s42
  v_lshl_add_u32 v11, v2, 3, v11
  s_lshl_b32 s4, s6, 9
  s_lshl_b32 s3, s28, 7
  s_add_u32 s4, s4, s3
  v_add_u32 v11, s4, v11
  ds_read_b128 v[72:75], v5 offset:0
  ds_read_b128 v[76:79], v5 offset:16384
  ds_read_b128 v[80:83], v5 offset:32768
  ds_read_b128 v[84:87], v5 offset:49152
  ds_read_b128 v[88:91], v5 offset:1024
  ds_read_b128 v[92:95], v5 offset:17408
  ds_read_b128 v[96:99], v5 offset:33792
  ds_read_b128 v[100:103], v5 offset:50176
  ds_read_b128 v[104:107], v5 offset:2048
  ds_read_b128 v[108:111], v5 offset:18432
  ds_read_b128 v[112:115], v5 offset:34816
  ds_read_b128 v[116:119], v5 offset:51200
  ds_read_b128 v[120:123], v5 offset:3072
  ds_read_b128 v[124:127], v5 offset:19456
  ds_read_b128 v[128:131], v5 offset:35840
  ds_read_b128 v[132:135], v5 offset:52224
  s_waitcnt lgkmcnt(14)
  v_add_f32 v72, v72, v76
  s_waitcnt lgkmcnt(12)
  v_add_f32 v80, v80, v84
  v_add_f32 v72, v72, v80
  v_mul_f32 v72, v72, v10
  v_add_f32 v73, v73, v77
  v_add_f32 v81, v81, v85
  v_add_f32 v73, v73, v81
  v_mul_f32 v73, v73, v10
  v_add_f32 v74, v74, v78
  v_add_f32 v82, v82, v86
  v_add_f32 v74, v74, v82
  v_mul_f32 v74, v74, v10
  v_add_f32 v75, v75, v79
  v_add_f32 v83, v83, v87
  v_add_f32 v75, v75, v83
  v_mul_f32 v75, v75, v10
  v_cvt_pk_bf16_f32 v76, v72, v73
  v_cvt_pk_bf16_f32 v77, v74, v75
  buffer_store_dwordx2 v[76:77], v11, s[24:27], 0 offen
  s_waitcnt lgkmcnt(10)
  v_add_f32 v88, v88, v92
  s_waitcnt lgkmcnt(8)
  v_add_f32 v96, v96, v100
  v_add_f32 v88, v88, v96
  v_mul_f32 v88, v88, v10
  v_add_f32 v89, v89, v93
  v_add_f32 v97, v97, v101
  v_add_f32 v89, v89, v97
  v_mul_f32 v89, v89, v10
  v_add_f32 v90, v90, v94
  v_add_f32 v98, v98, v102
  v_add_f32 v90, v90, v98
  v_mul_f32 v90, v90, v10
  v_add_f32 v91, v91, v95
  v_add_f32 v99, v99, v103
  v_add_f32 v91, v91, v99
  v_mul_f32 v91, v91, v10
  v_cvt_pk_bf16_f32 v92, v88, v89
  v_cvt_pk_bf16_f32 v93, v90, v91
  buffer_store_dwordx2 v[92:93], v11, s[24:27], 0 offen offset:32
  s_waitcnt lgkmcnt(6)
  v_add_f32 v104, v104, v108
  s_waitcnt lgkmcnt(4)
  v_add_f32 v112, v112, v116
  v_add_f32 v104, v104, v112
  v_mul_f32 v104, v104, v10
  v_add_f32 v105, v105, v109
  v_add_f32 v113, v113, v117
  v_add_f32 v105, v105, v113
  v_mul_f32 v105, v105, v10
  v_add_f32 v106, v106, v110
  v_add_f32 v114, v114, v118
  v_add_f32 v106, v106, v114
  v_mul_f32 v106, v106, v10
  v_add_f32 v107, v107, v111
  v_add_f32 v115, v115, v119
  v_add_f32 v107, v107, v115
  v_mul_f32 v107, v107, v10
  v_cvt_pk_bf16_f32 v108, v104, v105
  v_cvt_pk_bf16_f32 v109, v106, v107
  buffer_store_dwordx2 v[108:109], v11, s[24:27], 0 offen offset:64
  s_waitcnt lgkmcnt(2)
  v_add_f32 v120, v120, v124
  s_waitcnt lgkmcnt(0)
  v_add_f32 v128, v128, v132
  v_add_f32 v120, v120, v128
  v_mul_f32 v120, v120, v10
  v_add_f32 v121, v121, v125
  v_add_f32 v129, v129, v133
  v_add_f32 v121, v121, v129
  v_mul_f32 v121, v121, v10
  v_add_f32 v122, v122, v126
  v_add_f32 v130, v130, v134
  v_add_f32 v122, v122, v130
  v_mul_f32 v122, v122, v10
  v_add_f32 v123, v123, v127
  v_add_f32 v131, v131, v135
  v_add_f32 v123, v123, v131
  v_mul_f32 v123, v123, v10
  v_cvt_pk_bf16_f32 v124, v120, v121
  v_cvt_pk_bf16_f32 v125, v122, v123
  buffer_store_dwordx2 v[124:125], v11, s[24:27], 0 offen offset:96
L_k2_end:
  s_endpgm
.globl oproj_kernel
.p2align 8
.type oproj_kernel,@function
oproj_kernel:
  s_cmp_ge_u32 s2, 256
  s_cbranch_scc1 L_k3_end
  s_load_dwordx2 s[40:41], s[0:1], 96
  s_load_dwordx2 s[42:43], s[0:1], 80
  s_and_b32 s3, s2, 7
  s_lshl_b32 s3, s3, 5
  s_lshr_b32 s5, s2, 3
  s_add_u32 s3, s3, s5
  s_cmp_ge_u32 s3, 252
  s_cbranch_scc1 L_k3_end
  s_cmp_ge_u32 s3, 126
  s_cselect_b32 s4, 1, 0
  s_mul_i32 s5, s4, 126
  s_sub_u32 s5, s3, s5
  s_mul_hi_u32 s6, s5, 613566757
  s_mul_i32 s7, s6, 7
  s_sub_u32 s7, s5, s7
  s_mul_i32 s3, s4, 40
  s_add_u32 s3, s3, 32
  s_load_dwordx2 s[44:45], s[0:1], s3
  v_and_b32 v1, 63, v0
  v_lshrrev_b32 v4, 6, v0
  s_nop 1
  v_readfirstlane_b32 s28, v4
  v_lshrrev_b32 v2, 4, v1
  v_and_b32 v3, 15, v1
  s_nop 3
  s_lshl_b32 s23, s28, 12
  s_waitcnt lgkmcnt(0)
  s_mul_i32 s3, s4, 9732096
  s_mul_i32 s5, s6, 540672
  s_add_u32 s3, s3, s5
  s_add_u32 s8, s40, s3
  s_addc_u32 s9, s41, 0
  s_and_b32 s9, s9, 0xffff
  s_mov_b32 s10, 540672
  s_mov_b32 s11, 0x00020000
  s_lshl_b32 s3, s7, 7
  s_add_u32 s12, s44, s3
  s_addc_u32 s13, s45, 0
  s_and_b32 s13, s13, 0xffff
  s_sub_u32 s14, 3670016, s3
  s_mov_b32 s15, 0x00020000
  s_mov_b32 s16, s42
  s_and_b32 s17, s43, 0xffff
  s_mov_b32 s18, 2064384
  s_mov_b32 s19, 0x00020000
  v_lshrrev_b32 v4, 3, v1
  v_lshrrev_b32 v5, 4, v1
  v_and_b32 v6, 7, v1
  v_and_b32 v10, 15, v1
  s_lshl_b32 s3, s28, 4
  v_add_u32 v7, s3, v5
  v_add_u32 v8, 0, v5
  v_xor_b32 v8, v8, v10
  s_movk_i32 s5, 8448
  v_mul_lo_u32 v9, v7, s5
  v_lshl_add_u32 v14, v8, 4, v9
  s_lshl_b32 s3, s28, 5
  v_add_u32 v7, s3, v4
  v_and_b32 v8, 1, v5
  v_lshrrev_b32 v9, 1, v6
  v_xor_b32 v8, v8, v9
  v_and_b32 v9, 1, v6
  v_lshl_add_u32 v8, v8, 1, v9
  s_movk_i32 s5, 896
  v_mul_lo_u32 v9, v7, s5
  v_lshl_add_u32 v18, v8, 4, v9
  s_lshl_b32 s3, s28, 4
  v_add_u32 v7, s3, v5
  v_add_u32 v7, 4, v7
  v_add_u32 v8, 4, v5
  v_xor_b32 v8, v8, v10
  s_movk_i32 s5, 8448
  v_mul_lo_u32 v9, v7, s5
  v_lshl_add_u32 v15, v8, 4, v9
  s_lshl_b32 s3, s28, 5
  v_add_u32 v7, s3, v4
  v_add_u32 v7, 8, v7
  v_and_b32 v8, 1, v5
  v_or_b32 v8, 2, v8
  v_lshrrev_b32 v9, 1, v6
  v_xor_b32 v8, v8, v9
  v_and_b32 v9, 1, v6
  v_lshl_add_u32 v8, v8, 1, v9
  s_movk_i32 s5, 896
  v_mul_lo_u32 v9, v7, s5
  v_lshl_add_u32 v19, v8, 4, v9
  s_lshl_b32 s3, s28, 4
  v_add_u32 v7, s3, v5
  v_add_u32 v7, 8, v7
  v_add_u32 v8, 8, v5
  v_xor_b32 v8, v8, v10
  s_movk_i32 s5, 8448
  v_mul_lo_u32 v9, v7, s5
  v_lshl_add_u32 v16, v8, 4, v9
  s_lshl_b32 s3, s28, 5
  v_add_u32 v7, s3, v4
  v_add_u32 v7, 16, v7
  v_and_b32 v8, 1, v5
  v_lshrrev_b32 v9, 1, v6
  v_xor_b32 v8, v8, v9
  v_and_b32 v9, 1, v6
  v_lshl_add_u32 v8, v8, 1, v9
  s_movk_i32 s5, 896
  v_mul_lo_u32 v9, v7, s5
  v_lshl_add_u32 v20, v8, 4, v9
  s_lshl_b32 s3, s28, 4
  v_add_u32 v7, s3, v5
  v_add_u32 v7, 12, v7
  v_add_u32 v8, 12, v5
  v_xor_b32 v8, v8, v10
  s_movk_i32 s5, 8448
  v_mul_lo_u32 v9, v7, s5
  v_lshl_add_u32 v17, v8, 4, v9
  s_lshl_b32 s3, s28, 5
  v_add_u32 v7, s3, v4
  v_add_u32 v7, 24, v7
  v_and_b32 v8, 1, v5
  v_or_b32 v8, 2, v8
  v_lshrrev_b32 v9, 1, v6
  v_xor_b32 v8, v8, v9
  v_and_b32 v9, 1, v6
  v_lshl_add_u32 v8, v8, 1, v9
  s_movk_i32 s5, 896
  v_mul_lo_u32 v9, v7, s5
  v_lshl_add_u32 v21, v8, 4, v9
  v_lshrrev_b32 v4, 2, v3
  v_and_b32 v5, 3, v3
  v_lshl_add_u32 v6, v2, 3, v4
  v_lshlrev_b32 v6, 7, v6
  v_lshrrev_b32 v7, 1, v5
  v_lshl_add_u32 v6, v7, 4, v6
  v_and_b32 v7, 1, v5
  v_lshl_add_u32 v6, v7, 3, v6
  v_add_u32 v6, 16384, v6
  v_lshrrev_b32 v7, 1, v4
  v_and_b32 v7, 1, v7
  v_and_b32 v8, 1, v2
  v_lshl_or_b32 v7, v8, 1, v7
  s_and_b32 s3, s28, 1
  s_lshl_b32 s3, s3, 1
  v_xor_b32 v8, s3, v7
  v_lshl_add_u32 v22, v8, 5, v6
  v_add_u32 v23, 0x10000, v22
  v_xor_b32 v8, s3, v7
  v_xor_b32 v8, 1, v8
  v_lshl_add_u32 v24, v8, 5, v6
  v_add_u32 v25, 0x10000, v24
  s_lshr_b32 s3, s28, 1
  s_lshl_b32 s3, s3, 5
  v_add_u32 v6, s3, v3
  v_lshlrev_b32 v6, 8, v6
  v_add_u32 v8, 0, v2
  v_xor_b32 v8, v8, v3
  v_lshl_add_u32 v26, v8, 4, v6
  v_add_u32 v27, 0x10000, v26
  v_add_u32 v8, 4, v2
  v_xor_b32 v8, v8, v3
  v_lshl_add_u32 v28, v8, 4, v6
  v_add_u32 v29, 0x10000, v28
  v_add_u32 v8, 8, v2
  v_xor_b32 v8, v8, v3
  v_lshl_add_u32 v30, v8, 4, v6
  v_add_u32 v31, 0x10000, v30
  v_add_u32 v8, 12, v2
  v_xor_b32 v8, v8, v3
  v_lshl_add_u32 v32, v8, 4, v6
  v_add_u32 v33, 0x10000, v32
  s_cmp_lt_u32 s28, 2
  s_cselect_b32 s24, s8, s12
  s_cselect_b32 s25, s9, s13
  s_cselect_b32 s26, s10, s14
  s_mov_b32 s27, 0x00020000
  s_mov_b32 s5, 114688
  s_cselect_b32 s30, 256, s5
  s_mul_i32 s29, s30, 3
  s_lshl_b32 s3, s28, 5
  v_lshrrev_b32 v4, 1, v1
  v_add_u32 v4, s3, v4
  s_movk_i32 s5, 8448
  v_mul_lo_u32 v4, v4, s5
  v_and_b32 v5, 1, v1
  v_lshl_add_u32 v4, v5, 7, v4
  s_sub_u32 s3, s28, 2
  s_lshl_b32 s3, s3, 6
  v_add_u32 v5, s3, v1
  s_movk_i32 s5, 896
  v_mul_lo_u32 v5, v5, s5
  s_nop 1
  v_mov_b32 v116, v4
  s_cmp_lt_u32 s28, 2
  s_cbranch_scc1 L_k3_pfsel
  v_mov_b32 v116, v5
L_k3_pfsel:
  v_mov_b32 v36, 0
  v_mov_b32 v37, 0
  v_mov_b32 v38, 0
  v_mov_b32 v39, 0
  v_mov_b32 v40, 0
  v_mov_b32 v41, 0
  v_mov_b32 v42, 0
  v_mov_b32 v43, 0
  v_mov_b32 v44, 0
  v_mov_b32 v45, 0
  v_mov_b32 v46, 0
  v_mov_b32 v47, 0
  v_mov_b32 v48, 0
  v_mov_b32 v49, 0
  v_mov_b32 v50, 0
  v_mov_b32 v51, 0
  s_mov_b32 s20, 0
  s_mov_b32 s21, 0
  s_add_u32 m0, s23, 0
  s_nop 0
  buffer_load_dwordx4 v14, s[8:11], s20 offen nt lds
  s_add_u32 m0, s23, 1024
  s_nop 0
  buffer_load_dwordx4 v15, s[8:11], s20 offen nt lds
  s_add_u32 m0, s23, 2048
  s_nop 0
  buffer_load_dwordx4 v16, s[8:11], s20 offen nt lds
  s_add_u32 m0, s23, 3072
  s_nop 0
  buffer_load_dwordx4 v17, s[8:11], s20 offen nt lds
  s_add_u32 m0, s23, 16384
  s_nop 0
  buffer_load_dwordx4 v18, s[12:15], s21 offen nt lds
  s_add_u32 m0, s23, 17408
  s_nop 0
  buffer_load_dwordx4 v19, s[12:15], s21 offen nt lds
  s_add_u32 m0, s23, 18432
  s_nop 0
  buffer_load_dwordx4 v20, s[12:15], s21 offen nt lds
  s_add_u32 m0, s23, 19456
  s_nop 0
  buffer_load_dwordx4 v21, s[12:15], s21 offen nt lds
  s_add_u32 s20, s20, 256
  s_add_u32 s21, s21, 114688
  s_add_u32 m0, s23, 32768
  s_nop 0
  buffer_load_dwordx4 v14, s[8:11], s20 offen nt lds
  s_add_u32 m0, s23, 33792
  s_nop 0
  buffer_load_dwordx4 v15, s[8:11], s20 offen nt lds
  s_add_u32 m0, s23, 34816
  s_nop 0
  buffer_load_dwordx4 v16, s[8:11], s20 offen nt lds
  s_add_u32 m0, s23, 35840
  s_nop 0
  buffer_load_dwordx4 v17, s[8:11], s20 offen nt lds
  s_add_u32 m0, s23, 49152
  s_nop 0
  buffer_load_dwordx4 v18, s[12:15], s21 offen nt lds
  s_add_u32 m0, s23, 50176
  s_nop 0
  buffer_load_dwordx4 v19, s[12:15], s21 offen nt lds
  s_add_u32 m0, s23, 51200
  s_nop 0
  buffer_load_dwordx4 v20, s[12:15], s21 offen nt lds
  s_add_u32 m0, s23, 52224
  s_nop 0
  buffer_load_dwordx4 v21, s[12:15], s21 offen nt lds
  s_add_u32 s20, s20, 256
  s_add_u32 s21, s21, 114688
  s_add_u32 m0, s23, 65536
  s_nop 0
  buffer_load_dwordx4 v14, s[8:11], s20 offen nt lds
  s_add_u32 m0, s23, 66560
  s_nop 0
  buffer_load_dwordx4 v15, s[8:11], s20 offen nt lds
  s_add_u32 m0, s23, 67584
  s_nop 0
  buffer_load_dwordx4 v16, s[8:11], s20 offen nt lds
  s_add_u32 m0, s23, 68608
  s_nop 0
  buffer_load_dwordx4 v17, s[8:11], s20 offen nt lds
  s_add_u32 m0, s23, 81920
  s_nop 0
  buffer_load_dwordx4 v18, s[12:15], s21 offen nt lds
  s_add_u32 m0, s23, 82944
  s_nop 0
  buffer_load_dwordx4 v19, s[12:15], s21 offen nt lds
  s_add_u32 m0, s23, 83968
  s_nop 0
  buffer_load_dwordx4 v20, s[12:15], s21 offen nt lds
  s_add_u32 m0, s23, 84992
  s_nop 0
  buffer_load_dwordx4 v21, s[12:15], s21 offen nt lds
  s_add_u32 s20, s20, 256
  s_add_u32 s21, s21, 114688
  s_mov_b32 s22, 0
  s_nop 7
L_k3_loop:
  s_waitcnt vmcnt(16)
  s_barrier
  ds_read_b64_tr_b16 v[52:53], v22 offset:0
  ds_read_b64_tr_b16 v[54:55], v22 offset:512
  ds_read_b64_tr_b16 v[56:57], v24 offset:0
  ds_read_b64_tr_b16 v[58:59], v24 offset:512
  ds_read_b128 v[84:87], v26 offset:0
  ds_read_b128 v[88:91], v26 offset:4096
  s_add_u32 m0, s23, 98304
  s_nop 0
  buffer_load_dwordx4 v14, s[8:11], s20 offen nt lds
  s_add_u32 m0, s23, 99328
  s_nop 0
  buffer_load_dwordx4 v15, s[8:11], s20 offen nt lds
  ds_read_b64_tr_b16 v[60:61], v22 offset:4096
  ds_read_b64_tr_b16 v[62:63], v22 offset:4608
  ds_read_b64_tr_b16 v[64:65], v24 offset:4096
  ds_read_b64_tr_b16 v[66:67], v24 offset:4608
  ds_read_b128 v[92:95], v28 offset:0
  ds_read_b128 v[96:99], v28 offset:4096
  s_add_u32 m0, s23, 100352
  s_nop 0
  buffer_load_dwordx4 v16, s[8:11], s20 offen nt lds
  s_add_u32 m0, s23, 101376
  s_nop 0
  buffer_load_dwordx4 v17, s[8:11], s20 offen nt lds
  ds_read_b64_tr_b16 v[68:69], v22 offset:8192
  ds_read_b64_tr_b16 v[70:71], v22 offset:8704
  ds_read_b64_tr_b16 v[72:73], v24 offset:8192
  ds_read_b64_tr_b16 v[74:75], v24 offset:8704
  ds_read_b128 v[100:103], v30 offset:0
  ds_read_b128 v[104:107], v30 offset:4096
  s_add_u32 m0, s23, 114688
  s_nop 0
  buffer_load_dwordx4 v18, s[12:15], s21 offen nt lds
  s_add_u32 m0, s23, 115712
  s_nop 0
  buffer_load_dwordx4 v19, s[12:15], s21 offen nt lds
  ds_read_b64_tr_b16 v[76:77], v22 offset:12288
  ds_read_b64_tr_b16 v[78:79], v22 offset:12800
  ds_read_b64_tr_b16 v[80:81], v24 offset:12288
  ds_read_b64_tr_b16 v[82:83], v24 offset:12800
  ds_read_b128 v[108:111], v32 offset:0
  ds_read_b128 v[112:115], v32 offset:4096
  s_add_u32 m0, s23, 116736
  s_nop 0
  buffer_load_dwordx4 v20, s[12:15], s21 offen nt lds
  s_add_u32 m0, s23, 117760
  s_nop 0
  buffer_load_dwordx4 v21, s[12:15], s21 offen nt lds
  s_waitcnt lgkmcnt(15)
  v_mfma_f32_16x16x32_bf16 v[36:39], v[52:55], v[84:87], v[36:39]
  v_mfma_f32_16x16x32_bf16 v[40:43], v[52:55], v[88:91], v[40:43]
  s_add_u32 s20, s20, 256
  s_add_u32 s21, s21, 114688
  v_mfma_f32_16x16x32_bf16 v[44:47], v[56:59], v[84:87], v[44:47]
  v_mfma_f32_16x16x32_bf16 v[48:51], v[56:59], v[88:91], v[48:51]
  s_waitcnt lgkmcnt(13)
  v_mfma_f32_16x16x32_bf16 v[36:39], v[60:63], v[92:95], v[36:39]
  s_waitcnt lgkmcnt(12)
  v_mfma_f32_16x16x32_bf16 v[40:43], v[60:63], v[96:99], v[40:43]
  v_mfma_f32_16x16x32_bf16 v[44:47], v[64:67], v[92:95], v[44:47]
  v_mfma_f32_16x16x32_bf16 v[48:51], v[64:67], v[96:99], v[48:51]
  s_waitcnt lgkmcnt(7)
  v_mfma_f32_16x16x32_bf16 v[36:39], v[68:71], v[100:103], v[36:39]
  s_waitcnt lgkmcnt(6)
  v_mfma_f32_16x16x32_bf16 v[40:43], v[68:71], v[104:107], v[40:43]
  v_mfma_f32_16x16x32_bf16 v[44:47], v[72:75], v[100:103], v[44:47]
  v_mfma_f32_16x16x32_bf16 v[48:51], v[72:75], v[104:107], v[48:51]
  s_waitcnt lgkmcnt(1)
  v_mfma_f32_16x16x32_bf16 v[36:39], v[76:79], v[108:111], v[36:39]
  s_waitcnt lgkmcnt(0)
  v_mfma_f32_16x16x32_bf16 v[40:43], v[76:79], v[112:115], v[40:43]
  v_mfma_f32_16x16x32_bf16 v[44:47], v[80:83], v[108:111], v[44:47]
  v_mfma_f32_16x16x32_bf16 v[48:51], v[80:83], v[112:115], v[48:51]
  s_waitcnt vmcnt(16)
  s_barrier
  ds_read_b64_tr_b16 v[52:53], v22 offset:32768
  ds_read_b64_tr_b16 v[54:55], v22 offset:33280
  ds_read_b64_tr_b16 v[56:57], v24 offset:32768
  ds_read_b64_tr_b16 v[58:59], v24 offset:33280
  ds_read_b128 v[84:87], v26 offset:32768
  ds_read_b128 v[88:91], v26 offset:36864
  s_add_u32 m0, s23, 0
  s_nop 0
  buffer_load_dwordx4 v14, s[8:11], s20 offen nt lds
  s_add_u32 m0, s23, 1024
  s_nop 0
  buffer_load_dwordx4 v15, s[8:11], s20 offen nt lds
  ds_read_b64_tr_b16 v[60:61], v22 offset:36864
  ds_read_b64_tr_b16 v[62:63], v22 offset:37376
  ds_read_b64_tr_b16 v[64:65], v24 offset:36864
  ds_read_b64_tr_b16 v[66:67], v24 offset:37376
  ds_read_b128 v[92:95], v28 offset:32768
  ds_read_b128 v[96:99], v28 offset:36864
  s_add_u32 m0, s23, 2048
  s_nop 0
  buffer_load_dwordx4 v16, s[8:11], s20 offen nt lds
  s_add_u32 m0, s23, 3072
  s_nop 0
  buffer_load_dwordx4 v17, s[8:11], s20 offen nt lds
  ds_read_b64_tr_b16 v[68:69], v22 offset:40960
  ds_read_b64_tr_b16 v[70:71], v22 offset:41472
  ds_read_b64_tr_b16 v[72:73], v24 offset:40960
  ds_read_b64_tr_b16 v[74:75], v24 offset:41472
  ds_read_b128 v[100:103], v30 offset:32768
  ds_read_b128 v[104:107], v30 offset:36864
  s_add_u32 m0, s23, 16384
  s_nop 0
  buffer_load_dwordx4 v18, s[12:15], s21 offen nt lds
  s_add_u32 m0, s23, 17408
  s_nop 0
  buffer_load_dwordx4 v19, s[12:15], s21 offen nt lds
  ds_read_b64_tr_b16 v[76:77], v22 offset:45056
  ds_read_b64_tr_b16 v[78:79], v22 offset:45568
  ds_read_b64_tr_b16 v[80:81], v24 offset:45056
  ds_read_b64_tr_b16 v[82:83], v24 offset:45568
  ds_read_b128 v[108:111], v32 offset:32768
  ds_read_b128 v[112:115], v32 offset:36864
  s_add_u32 m0, s23, 18432
  s_nop 0
  buffer_load_dwordx4 v20, s[12:15], s21 offen nt lds
  s_add_u32 m0, s23, 19456
  s_nop 0
  buffer_load_dwordx4 v21, s[12:15], s21 offen nt lds
  s_waitcnt lgkmcnt(15)
  v_mfma_f32_16x16x32_bf16 v[36:39], v[52:55], v[84:87], v[36:39]
  v_mfma_f32_16x16x32_bf16 v[40:43], v[52:55], v[88:91], v[40:43]
  s_add_u32 s20, s20, 256
  s_add_u32 s21, s21, 114688
  v_mfma_f32_16x16x32_bf16 v[44:47], v[56:59], v[84:87], v[44:47]
  v_mfma_f32_16x16x32_bf16 v[48:51], v[56:59], v[88:91], v[48:51]
  s_waitcnt lgkmcnt(13)
  v_mfma_f32_16x16x32_bf16 v[36:39], v[60:63], v[92:95], v[36:39]
  s_waitcnt lgkmcnt(12)
  v_mfma_f32_16x16x32_bf16 v[40:43], v[60:63], v[96:99], v[40:43]
  v_mfma_f32_16x16x32_bf16 v[44:47], v[64:67], v[92:95], v[44:47]
  v_mfma_f32_16x16x32_bf16 v[48:51], v[64:67], v[96:99], v[48:51]
  s_waitcnt lgkmcnt(7)
  v_mfma_f32_16x16x32_bf16 v[36:39], v[68:71], v[100:103], v[36:39]
  s_waitcnt lgkmcnt(6)
  v_mfma_f32_16x16x32_bf16 v[40:43], v[68:71], v[104:107], v[40:43]
  v_mfma_f32_16x16x32_bf16 v[44:47], v[72:75], v[100:103], v[44:47]
  v_mfma_f32_16x16x32_bf16 v[48:51], v[72:75], v[104:107], v[48:51]
  s_waitcnt lgkmcnt(1)
  v_mfma_f32_16x16x32_bf16 v[36:39], v[76:79], v[108:111], v[36:39]
  s_waitcnt lgkmcnt(0)
  v_mfma_f32_16x16x32_bf16 v[40:43], v[76:79], v[112:115], v[40:43]
  v_mfma_f32_16x16x32_bf16 v[44:47], v[80:83], v[108:111], v[44:47]
  v_mfma_f32_16x16x32_bf16 v[48:51], v[80:83], v[112:115], v[48:51]
  s_waitcnt vmcnt(16)
  s_barrier
  ds_read_b64_tr_b16 v[52:53], v23 offset:0
  ds_read_b64_tr_b16 v[54:55], v23 offset:512
  ds_read_b64_tr_b16 v[56:57], v25 offset:0
  ds_read_b64_tr_b16 v[58:59], v25 offset:512
  ds_read_b128 v[84:87], v27 offset:0
  ds_read_b128 v[88:91], v27 offset:4096
  s_add_u32 m0, s23, 32768
  s_nop 0
  buffer_load_dwordx4 v14, s[8:11], s20 offen nt lds
  s_add_u32 m0, s23, 33792
  s_nop 0
  buffer_load_dwordx4 v15, s[8:11], s20 offen nt lds
  ds_read_b64_tr_b16 v[60:61], v23 offset:4096
  ds_read_b64_tr_b16 v[62:63], v23 offset:4608
  ds_read_b64_tr_b16 v[64:65], v25 offset:4096
  ds_read_b64_tr_b16 v[66:67], v25 offset:4608
  ds_read_b128 v[92:95], v29 offset:0
  ds_read_b128 v[96:99], v29 offset:4096
  s_add_u32 m0, s23, 34816
  s_nop 0
  buffer_load_dwordx4 v16, s[8:11], s20 offen nt lds
  s_add_u32 m0, s23, 35840
  s_nop 0
  buffer_load_dwordx4 v17, s[8:11], s20 offen nt lds
  ds_read_b64_tr_b16 v[68:69], v23 offset:8192
  ds_read_b64_tr_b16 v[70:71], v23 offset:8704
  ds_read_b64_tr_b16 v[72:73], v25 offset:8192
  ds_read_b64_tr_b16 v[74:75], v25 offset:8704
  ds_read_b128 v[100:103], v31 offset:0
  ds_read_b128 v[104:107], v31 offset:4096
  s_add_u32 m0, s23, 49152
  s_nop 0
  buffer_load_dwordx4 v18, s[12:15], s21 offen nt lds
  s_add_u32 m0, s23, 50176
  s_nop 0
  buffer_load_dwordx4 v19, s[12:15], s21 offen nt lds
  ds_read_b64_tr_b16 v[76:77], v23 offset:12288
  ds_read_b64_tr_b16 v[78:79], v23 offset:12800
  ds_read_b64_tr_b16 v[80:81], v25 offset:12288
  ds_read_b64_tr_b16 v[82:83], v25 offset:12800
  ds_read_b128 v[108:111], v33 offset:0
  ds_read_b128 v[112:115], v33 offset:4096
  s_add_u32 m0, s23, 51200
  s_nop 0
  buffer_load_dwordx4 v20, s[12:15], s21 offen nt lds
  s_add_u32 m0, s23, 52224
  s_nop 0
  buffer_load_dwordx4 v21, s[12:15], s21 offen nt lds
  s_waitcnt lgkmcnt(15)
  v_mfma_f32_16x16x32_bf16 v[36:39], v[52:55], v[84:87], v[36:39]
  v_mfma_f32_16x16x32_bf16 v[40:43], v[52:55], v[88:91], v[40:43]
  s_add_u32 s20, s20, 256
  s_add_u32 s21, s21, 114688
  v_mfma_f32_16x16x32_bf16 v[44:47], v[56:59], v[84:87], v[44:47]
  v_mfma_f32_16x16x32_bf16 v[48:51], v[56:59], v[88:91], v[48:51]
  s_waitcnt lgkmcnt(13)
  v_mfma_f32_16x16x32_bf16 v[36:39], v[60:63], v[92:95], v[36:39]
  s_waitcnt lgkmcnt(12)
  v_mfma_f32_16x16x32_bf16 v[40:43], v[60:63], v[96:99], v[40:43]
  v_mfma_f32_16x16x32_bf16 v[44:47], v[64:67], v[92:95], v[44:47]
  v_mfma_f32_16x16x32_bf16 v[48:51], v[64:67], v[96:99], v[48:51]
  s_waitcnt lgkmcnt(7)
  v_mfma_f32_16x16x32_bf16 v[36:39], v[68:71], v[100:103], v[36:39]
  s_waitcnt lgkmcnt(6)
  v_mfma_f32_16x16x32_bf16 v[40:43], v[68:71], v[104:107], v[40:43]
  v_mfma_f32_16x16x32_bf16 v[44:47], v[72:75], v[100:103], v[44:47]
  v_mfma_f32_16x16x32_bf16 v[48:51], v[72:75], v[104:107], v[48:51]
  s_waitcnt lgkmcnt(1)
  v_mfma_f32_16x16x32_bf16 v[36:39], v[76:79], v[108:111], v[36:39]
  s_waitcnt lgkmcnt(0)
  v_mfma_f32_16x16x32_bf16 v[40:43], v[76:79], v[112:115], v[40:43]
  v_mfma_f32_16x16x32_bf16 v[44:47], v[80:83], v[108:111], v[44:47]
  v_mfma_f32_16x16x32_bf16 v[48:51], v[80:83], v[112:115], v[48:51]
  s_waitcnt vmcnt(16)
  s_barrier
  ds_read_b64_tr_b16 v[52:53], v23 offset:32768
  ds_read_b64_tr_b16 v[54:55], v23 offset:33280
  ds_read_b64_tr_b16 v[56:57], v25 offset:32768
  ds_read_b64_tr_b16 v[58:59], v25 offset:33280
  ds_read_b128 v[84:87], v27 offset:32768
  ds_read_b128 v[88:91], v27 offset:36864
  s_add_u32 m0, s23, 65536
  s_nop 0
  buffer_load_dwordx4 v14, s[8:11], s20 offen nt lds
  s_add_u32 m0, s23, 66560
  s_nop 0
  buffer_load_dwordx4 v15, s[8:11], s20 offen nt lds
  ds_read_b64_tr_b16 v[60:61], v23 offset:36864
  ds_read_b64_tr_b16 v[62:63], v23 offset:37376
  ds_read_b64_tr_b16 v[64:65], v25 offset:36864
  ds_read_b64_tr_b16 v[66:67], v25 offset:37376
  ds_read_b128 v[92:95], v29 offset:32768
  ds_read_b128 v[96:99], v29 offset:36864
  s_add_u32 m0, s23, 67584
  s_nop 0
  buffer_load_dwordx4 v16, s[8:11], s20 offen nt lds
  s_add_u32 m0, s23, 68608
  s_nop 0
  buffer_load_dwordx4 v17, s[8:11], s20 offen nt lds
  ds_read_b64_tr_b16 v[68:69], v23 offset:40960
  ds_read_b64_tr_b16 v[70:71], v23 offset:41472
  ds_read_b64_tr_b16 v[72:73], v25 offset:40960
  ds_read_b64_tr_b16 v[74:75], v25 offset:41472
  ds_read_b128 v[100:103], v31 offset:32768
  ds_read_b128 v[104:107], v31 offset:36864
  s_add_u32 m0, s23, 81920
  s_nop 0
  buffer_load_dwordx4 v18, s[12:15], s21 offen nt lds
  s_add_u32 m0, s23, 82944
  s_nop 0
  buffer_load_dwordx4 v19, s[12:15], s21 offen nt lds
  ds_read_b64_tr_b16 v[76:77], v23 offset:45056
  ds_read_b64_tr_b16 v[78:79], v23 offset:45568
  ds_read_b64_tr_b16 v[80:81], v25 offset:45056
  ds_read_b64_tr_b16 v[82:83], v25 offset:45568
  ds_read_b128 v[108:111], v33 offset:32768
  ds_read_b128 v[112:115], v33 offset:36864
  s_add_u32 m0, s23, 83968
  s_nop 0
  buffer_load_dwordx4 v20, s[12:15], s21 offen nt lds
  s_add_u32 m0, s23, 84992
  s_nop 0
  buffer_load_dwordx4 v21, s[12:15], s21 offen nt lds
  s_waitcnt lgkmcnt(15)
  v_mfma_f32_16x16x32_bf16 v[36:39], v[52:55], v[84:87], v[36:39]
  v_mfma_f32_16x16x32_bf16 v[40:43], v[52:55], v[88:91], v[40:43]
  s_add_u32 s20, s20, 256
  s_add_u32 s21, s21, 114688
  v_mfma_f32_16x16x32_bf16 v[44:47], v[56:59], v[84:87], v[44:47]
  v_mfma_f32_16x16x32_bf16 v[48:51], v[56:59], v[88:91], v[48:51]
  s_waitcnt lgkmcnt(13)
  v_mfma_f32_16x16x32_bf16 v[36:39], v[60:63], v[92:95], v[36:39]
  s_waitcnt lgkmcnt(12)
  v_mfma_f32_16x16x32_bf16 v[40:43], v[60:63], v[96:99], v[40:43]
  v_mfma_f32_16x16x32_bf16 v[44:47], v[64:67], v[92:95], v[44:47]
  v_mfma_f32_16x16x32_bf16 v[48:51], v[64:67], v[96:99], v[48:51]
  s_waitcnt lgkmcnt(7)
  v_mfma_f32_16x16x32_bf16 v[36:39], v[68:71], v[100:103], v[36:39]
  s_waitcnt lgkmcnt(6)
  v_mfma_f32_16x16x32_bf16 v[40:43], v[68:71], v[104:107], v[40:43]
  v_mfma_f32_16x16x32_bf16 v[44:47], v[72:75], v[100:103], v[44:47]
  v_mfma_f32_16x16x32_bf16 v[48:51], v[72:75], v[104:107], v[48:51]
  s_waitcnt lgkmcnt(1)
  v_mfma_f32_16x16x32_bf16 v[36:39], v[76:79], v[108:111], v[36:39]
  s_waitcnt lgkmcnt(0)
  v_mfma_f32_16x16x32_bf16 v[40:43], v[76:79], v[112:115], v[40:43]
  v_mfma_f32_16x16x32_bf16 v[44:47], v[80:83], v[108:111], v[44:47]
  v_mfma_f32_16x16x32_bf16 v[48:51], v[80:83], v[112:115], v[48:51]
  s_add_u32 s22, s22, 1
  s_cmp_lt_u32 s22, 8
  s_nop 7
  s_cbranch_scc1 L_k3_loop
  s_nop 7
  s_lshr_b32 s3, s28, 1
  s_lshl_b32 s3, s3, 5
  s_lshl_b32 s5, s6, 6
  s_add_u32 s3, s3, s5
  v_add_u32 v4, s3, v3
  s_movk_i32 s5, 1792
  v_mul_lo_u32 v4, v4, s5
  s_mul_i32 s3, s4, 896
  s_lshl_b32 s5, s7, 7
  s_add_u32 s3, s3, s5
  s_and_b32 s5, s28, 1
  s_lshl_b32 s5, s5, 6
  s_add_u32 s3, s3, s5
  v_add_u32 v4, s3, v4
  v_lshl_add_u32 v34, v2, 3, v4
  v_add_u32 v35, 28672, v34
  v_cvt_pk_bf16_f32 v52, v36, v37
  v_cvt_pk_bf16_f32 v53, v38, v39
  buffer_store_dwordx2 v[52:53], v34, s[16:19], 0 offen
  v_cvt_pk_bf16_f32 v54, v40, v41
  v_cvt_pk_bf16_f32 v55, v42, v43
  buffer_store_dwordx2 v[54:55], v35, s[16:19], 0 offen
  v_cvt_pk_bf16_f32 v56, v44, v45
  v_cvt_pk_bf16_f32 v57, v46, v47
  buffer_store_dwordx2 v[56:57], v34, s[16:19], 0 offen offset:32
  v_cvt_pk_bf16_f32 v58, v48, v49
  v_cvt_pk_bf16_f32 v59, v50, v51
  buffer_store_dwordx2 v[58:59], v35, s[16:19], 0 offen offset:32
L_k3_end:
  s_endpgm
.section .rodata,"a"
.p2align 6
.amdhsa_kernel attn_kernel
  .amdhsa_next_free_vgpr 512
  .amdhsa_next_free_sgpr 102
  .amdhsa_accum_offset 256
  .amdhsa_group_segment_fixed_size 0
  .amdhsa_kernarg_size 104
  .amdhsa_user_sgpr_count 2
  .amdhsa_user_sgpr_kernarg_segment_ptr 1
  .amdhsa_system_sgpr_workgroup_id_x 1
.end_amdhsa_kernel
.p2align 6
.amdhsa_kernel oproj_kernel
  .amdhsa_next_free_vgpr 120
  .amdhsa_next_free_sgpr 48
  .amdhsa_accum_offset 120
  .amdhsa_group_segment_fixed_size 0
  .amdhsa_kernarg_size 104
  .amdhsa_user_sgpr_count 2
  .amdhsa_user_sgpr_kernarg_segment_ptr 1
  .amdhsa_system_sgpr_workgroup_id_x 1
.end_amdhsa_kernel
```
